```python
import torch

def _softmax(x, axis=-1):
    return torch.softmax(x, dim=axis)
def _gelu(x):
    return torch.nn.functional.gelu(x, approximate="tanh")
def _silu(x):
    return torch.nn.functional.silu(x)
def _sigmoid(x):
    return torch.sigmoid(x)
def _layernorm(x, axis=-1, eps=1e-5):
    m = x.mean(dim=axis, keepdim=True)
    v = x.var(dim=axis, keepdim=True, unbiased=False)
    return (x - m) / torch.sqrt(v + eps)
def _scatter_add(tgt, idx, src, axis=0):
    return tgt.clone().index_add_(axis, idx, src)
def _segment_sum(src, seg, n):
    out = torch.zeros((n,) + src.shape[1:], dtype=src.dtype)
    return out.index_add_(0, seg, src)
def _pad(x, pw):
    flat = tuple(v for pair in reversed(pw) for v in pair)
    return torch.nn.functional.pad(x, flat)

kernel_name = 'parallel_sum__linear_attn_block__dense_activation_silu__prompt'

def setup_inputs():

    _w = (lambda a: (lambda t: t.to(torch.bfloat16) if t.is_floating_point() else t)(torch.as_tensor(a)))
    def _A_setup():
        B, S, D = 1, 2048, 640
        return {
            "x": _w((lambda *s: torch.randn(*s, dtype=torch.bfloat16) * 0.05)(B, S, D)),
            "wqkv": _w((lambda *s: torch.randn(*s, dtype=torch.bfloat16) * 0.1)(D, 3 * D)),
            "wo": _w((lambda *s: torch.randn(*s, dtype=torch.bfloat16) * 0.05)(D, D)),
        }
    _A_in = _A_setup()

    def _B_setup():
        B, S, D, F = 1, 2048, 640, 1536
        return {
            "x": _w((lambda *s: torch.randn(*s, dtype=torch.bfloat16) * 0.05)(B, S, D)),
            "w1": _w((lambda *s: torch.randn(*s, dtype=torch.bfloat16) * 0.8)(D, F) * (D ** -0.5)),
            "w2": _w((lambda *s: torch.randn(*s, dtype=torch.bfloat16) * 0.1)(F, D) * (F ** -0.5)),
        }
    _B_in = _B_setup()

    return {
        "A_x": _A_in["x"],
        "A_wqkv": _A_in["wqkv"],
        "A_wo": _A_in["wo"],
        "B_x": _B_in["x"],
        "B_w1": _B_in["w1"],
        "B_w2": _B_in["w2"],
    }

def reference(A_x, A_wqkv, A_wo, B_x, B_w1, B_w2):
    def _A_ref(x, wqkv, wo):
        B, S, D = x.shape
        H = 32; Dh = D // H
        qkv = (lambda x, *d: x.permute(*d))((x @ wqkv).reshape(B, S, 3, H, Dh), 2, 0, 3, 1, 4)
        q, k, v = qkv[0], qkv[1], qkv[2]
        phi = lambda t: torch.where(t > 0, t + 1, torch.exp(t)) + 1e-6
        pq, pk = phi(q), phi(k)
        kv = torch.einsum("bhsd,bhse->bhde", pk, v)
        z = torch.einsum("bhsd->bhd", pk)
        num = torch.einsum("bhqd,bhde->bhqe", pq, kv)
        den = torch.einsum("bhqd,bhd->bhq", pq, z)[..., None] + 1e-6
        o = num / den
        return (lambda x, *d: x.permute(*d))(o, 0, 2, 1, 3).reshape(B, S, D) @ wo

    def _B_ref(x, w1, w2):
        h = torch.einsum("bsd,df->bsf", x, w1)
        h = _silu(h)
        out = torch.einsum("bsf,fd->bsd", h, w2)
        return out

    x = A_x
    xn = _layernorm(x, axis=-1)
    return x + _A_ref(xn, A_wqkv, A_wo) + _B_ref(xn, B_w1, B_w2)
```

```asm
; @launch grid=(256,1,1) block=(256,1,1) lds=161792
.amdgcn_target "amdgcn-amd-amdhsa--gfx950"
.text
.globl parallel_sum__linear_attn_block__dense_activation_silu__prompt_kernel
.p2align 8
.type parallel_sum__linear_attn_block__dense_activation_silu__prompt_kernel,@function
parallel_sum__linear_attn_block__dense_activation_silu__prompt_kernel:
    s_cmp_ge_u32 s2, 256
    s_cbranch_scc1 L_end
    s_load_dwordx16 s[4:19], s[0:1], 0
    s_load_dwordx2 s[20:21], s[0:1], 64
    v_and_b32 v1, 63, v0
    v_lshrrev_b32 v2, 6, v0
    v_lshlrev_b32 v254, 4, v1
    v_readfirstlane_b32 s48, v2
    s_and_b32 s66, s2, 7
    s_lshr_b32 s67, s2, 3
    v_mov_b32 v9, 1073741824
    s_getpc_b64 s[70:71]
L_pc:
    s_lshl_b32 s68, s67, 2
    s_add_u32 s68, s68, s48
    s_mul_i32 s68, s68, 384
    v_min_u32 v3, 2, v1
    v_lshl_add_u32 v3, v3, 7, s68
    v_min_u32 v3, L_end-L_pc, v3
    v_mov_b32 v5, s71
    v_add_co_u32 v4, vcc, s70, v3
    s_nop 1
    v_addc_co_u32 v5, vcc, 0, v5, vcc
    global_load_dword v250, v[4:5], off
    s_lshr_b32 s68, s66, 1
    s_lshl_b32 s69, s68, 2
    s_and_b32 s51, s67, 3
    s_add_u32 s51, s51, s69
    s_mul_i32 s3, s68, 5
    s_lshr_b32 s3, s3, 1
    s_lshl_b32 s57, s3, 7
    s_lshl_b32 s69, s51, 7
    s_lshl_b32 s70, s48, 5
    s_add_u32 s69, s69, s70
    s_mov_b32 s60, 0
    s_lshl_b32 s62, s48, 12
    v_lshrrev_b32 v2, 3, v1
    v_add_u32 v5, s69, v2
    v_mul_u32_u24 v5, 1280, v5
    v_lshrrev_b32 v3, 4, v1
    v_and_b32 v4, 7, v1
    v_xor_b32 v6, v3, v4
    v_lshl_add_u32 v188, v6, 4, v5
    v_xor_b32 v6, 4, v6
    v_lshl_add_u32 v7, v6, 4, v5
    v_add_u32 v189, 9216, v7
    v_add_u32 v190, 18432, v188
    v_add_u32 v191, 27648, v7
    s_mov_b32 s26, 2621440
    s_mov_b32 s27, 0x20000
    s_mul_i32 s58, s3, 245760
    s_mul_i32 s59, s3, 196608
    s_waitcnt lgkmcnt(0)
    s_mov_b32 s24, s4
    s_mov_b32 s25, s5
    s_add_u32 m0, s60, s62
    s_nop 0
    buffer_load_dwordx4 v188, s[24:27], s57 offen offset:0 lds
    buffer_load_dwordx4 v189, s[24:27], s57 offen offset:1024 lds
    buffer_load_dwordx4 v190, s[24:27], s57 offen offset:2048 lds
    buffer_load_dwordx4 v191, s[24:27], s57 offen offset:3072 lds
    s_add_u32 s3, s3, 1
    s_cmp_eq_u32 s3, 10
    s_cselect_b32 s3, 0, s3
    s_lshl_b32 s57, s3, 7
    s_mov_b32 s28, s6
    s_mov_b32 s29, s7
    s_mov_b32 s30, 2457600
    s_mov_b32 s31, 0x20000
    s_mov_b32 s32, s12
    s_mov_b32 s33, s13
    s_mov_b32 s34, 1966080
    s_mov_b32 s35, 0x20000
    s_and_b32 s66, s66, 1
    s_lshr_b32 s68, s67, 3
    s_lshl_b32 s52, s66, 2
    s_add_u32 s52, s52, s68
    s_bfe_u32 s53, s67, 0x10002
    s_mul_i32 s64, s66, 1536
    s_lshl_b32 s69, s68, 7
    s_lshl_b32 s69, s69, s53
    s_add_u32 s64, s64, s69
    s_lshl_b32 s69, s53, 9
    s_add_u32 s64, s64, s69
    s_mul_i32 s63, s48, 7168
    s_add_u32 s63, s63, 16384
    s_cmp_eq_u32 s53, 1
    s_cbranch_scc1 L_ty1
    s_lshl_b32 s66, s48, 4
    s_mul_i32 s67, s52, 160
    v_add_u32 v2, 0, v1
    v_mul_u32_u24 v3, 3277, v2
    v_lshrrev_b32 v3, 16, v3
    v_mul_u32_u24 v4, 20, v3
    v_sub_u32 v4, v2, v4
    v_bfe_u32 v5, v3, 2, 1
    v_and_b32 v6, 3, v3
    v_lshl_add_u32 v6, v5, 3, v6
    v_bfe_u32 v7, v3, 3, 1
    v_lshl_add_u32 v6, v7, 2, v6
    v_add_u32 v6, s66, v6
    v_lshlrev_b32 v5, 1, v5
    v_xor_b32 v4, v4, v5
    v_mul_u32_u24 v6, 3840, v6
    v_mul_u32_u24 v7, 52, v4
    v_lshrrev_b32 v7, 8, v7
    v_and_b32 v8, 1, v7
    v_mul_u32_u24 v8, 1200, v8
    v_lshrrev_b32 v7, 1, v7
    v_mul_u32_u24 v7, 80, v7
    v_lshl_add_u32 v6, v4, 4, v6
    v_add_u32 v6, v6, v8
    v_sub_u32 v6, v6, v7
    v_add_u32 v6, s67, v6
    v_add_u32 v192, 1280, v6
    s_add_u32 m0, s60, s63
    s_nop 0
    buffer_load_dwordx4 v192, s[28:31], s58 offen offset:0 lds
    v_add_u32 v2, 64, v1
    v_mul_u32_u24 v3, 3277, v2
    v_lshrrev_b32 v3, 16, v3
    v_mul_u32_u24 v4, 20, v3
    v_sub_u32 v4, v2, v4
    v_bfe_u32 v5, v3, 2, 1
    v_and_b32 v6, 3, v3
    v_lshl_add_u32 v6, v5, 3, v6
    v_bfe_u32 v7, v3, 3, 1
    v_lshl_add_u32 v6, v7, 2, v6
    v_add_u32 v6, s66, v6
    v_lshlrev_b32 v5, 1, v5
    v_xor_b32 v4, v4, v5
    v_mul_u32_u24 v6, 3840, v6
    v_mul_u32_u24 v7, 52, v4
    v_lshrrev_b32 v7, 8, v7
    v_and_b32 v8, 1, v7
    v_mul_u32_u24 v8, 1200, v8
    v_lshrrev_b32 v7, 1, v7
    v_mul_u32_u24 v7, 80, v7
    v_lshl_add_u32 v6, v4, 4, v6
    v_add_u32 v6, v6, v8
    v_sub_u32 v6, v6, v7
    v_add_u32 v6, s67, v6
    v_add_u32 v193, 256, v6
    buffer_load_dwordx4 v193, s[28:31], s58 offen offset:1024 lds
    v_add_u32 v2, 128, v1
    v_mul_u32_u24 v3, 3277, v2
    v_lshrrev_b32 v3, 16, v3
    v_mul_u32_u24 v4, 20, v3
    v_sub_u32 v4, v2, v4
    v_bfe_u32 v5, v3, 2, 1
    v_and_b32 v6, 3, v3
    v_lshl_add_u32 v6, v5, 3, v6
    v_bfe_u32 v7, v3, 3, 1
    v_lshl_add_u32 v6, v7, 2, v6
    v_add_u32 v6, s66, v6
    v_lshlrev_b32 v5, 1, v5
    v_xor_b32 v4, v4, v5
    v_mul_u32_u24 v6, 3840, v6
    v_mul_u32_u24 v7, 52, v4
    v_lshrrev_b32 v7, 8, v7
    v_and_b32 v8, 1, v7
    v_mul_u32_u24 v8, 1200, v8
    v_lshrrev_b32 v7, 1, v7
    v_mul_u32_u24 v7, 80, v7
    v_lshl_add_u32 v6, v4, 4, v6
    v_add_u32 v6, v6, v8
    v_sub_u32 v6, v6, v7
    v_add_u32 v6, s67, v6
    v_add_u32 v194, 4294966528, v6
    buffer_load_dwordx4 v194, s[28:31], s58 offen offset:2048 lds
    v_add_u32 v2, 192, v1
    v_mul_u32_u24 v3, 3277, v2
    v_lshrrev_b32 v3, 16, v3
    v_mul_u32_u24 v4, 20, v3
    v_sub_u32 v4, v2, v4
    v_bfe_u32 v5, v3, 2, 1
    v_and_b32 v6, 3, v3
    v_lshl_add_u32 v6, v5, 3, v6
    v_bfe_u32 v7, v3, 3, 1
    v_lshl_add_u32 v6, v7, 2, v6
    v_add_u32 v6, s66, v6
    v_lshlrev_b32 v5, 1, v5
    v_xor_b32 v4, v4, v5
    v_mul_u32_u24 v6, 3840, v6
    v_mul_u32_u24 v7, 52, v4
    v_lshrrev_b32 v7, 8, v7
    v_and_b32 v8, 1, v7
    v_mul_u32_u24 v8, 1200, v8
    v_lshrrev_b32 v7, 1, v7
    v_mul_u32_u24 v7, 80, v7
    v_lshl_add_u32 v6, v4, 4, v6
    v_add_u32 v6, v6, v8
    v_sub_u32 v6, v6, v7
    v_add_u32 v6, s67, v6
    v_add_u32 v195, 4294965504, v6
    buffer_load_dwordx4 v195, s[28:31], s58 offen offset:3072 lds
    v_add_u32 v2, 256, v1
    v_mul_u32_u24 v3, 3277, v2
    v_lshrrev_b32 v3, 16, v3
    v_mul_u32_u24 v4, 20, v3
    v_sub_u32 v4, v2, v4
    v_bfe_u32 v5, v3, 2, 1
    v_and_b32 v6, 3, v3
    v_lshl_add_u32 v6, v5, 3, v6
    v_bfe_u32 v7, v3, 3, 1
    v_lshl_add_u32 v6, v7, 2, v6
    v_add_u32 v6, s66, v6
    v_lshlrev_b32 v5, 1, v5
    v_xor_b32 v4, v4, v5
    v_mul_u32_u24 v6, 3840, v6
    v_mul_u32_u24 v7, 52, v4
    v_lshrrev_b32 v7, 8, v7
    v_and_b32 v8, 1, v7
    v_mul_u32_u24 v8, 1200, v8
    v_lshrrev_b32 v7, 1, v7
    v_mul_u32_u24 v7, 80, v7
    v_lshl_add_u32 v6, v4, 4, v6
    v_add_u32 v6, v6, v8
    v_sub_u32 v6, v6, v7
    v_add_u32 v6, s67, v6
    v_add_u32 v196, 1280, v6
    s_add_u32 m0, m0, 4096
    s_nop 0
    buffer_load_dwordx4 v196, s[28:31], s58 offen offset:0 lds
    v_add_u32 v2, 0, v1
    v_lshrrev_b32 v3, 3, v2
    v_and_b32 v4, 7, v2
    v_bfe_u32 v5, v3, 2, 1
    v_and_b32 v6, 3, v3
    v_lshl_add_u32 v6, v5, 3, v6
    v_bfe_u32 v7, v3, 3, 1
    v_lshl_add_u32 v6, v7, 2, v6
    v_add_u32 v6, s66, v6
    v_bfe_u32 v5, v3, 1, 2
    v_lshlrev_b32 v5, 1, v5
    v_xor_b32 v4, v4, v5
    v_mul_u32_u24 v6, 3072, v6
    v_lshl_add_u32 v6, v4, 4, v6
    v_add_u32 v6, s64, v6
    v_subrev_u32 v197, 0, v6
    s_mul_i32 s58, s3, 245760
    s_add_u32 m0, m0, 1024
    s_nop 0
    buffer_load_dwordx4 v197, s[32:35], s59 offen offset:0 lds
    v_add_u32 v2, 64, v1
    v_lshrrev_b32 v3, 3, v2
    v_and_b32 v4, 7, v2
    v_bfe_u32 v5, v3, 2, 1
    v_and_b32 v6, 3, v3
    v_lshl_add_u32 v6, v5, 3, v6
    v_bfe_u32 v7, v3, 3, 1
    v_lshl_add_u32 v6, v7, 2, v6
    v_add_u32 v6, s66, v6
    v_bfe_u32 v5, v3, 1, 2
    v_lshlrev_b32 v5, 1, v5
    v_xor_b32 v4, v4, v5
    v_mul_u32_u24 v6, 3072, v6
    v_lshl_add_u32 v6, v4, 4, v6
    v_add_u32 v6, s64, v6
    v_subrev_u32 v198, 1024, v6
    buffer_load_dwordx4 v198, s[32:35], s59 offen offset:1024 lds
    s_mul_i32 s59, s3, 196608
    s_and_b32 s66, s2, 1
    s_lshr_b32 s67, s2, 3
    s_bfe_u32 s68, s2, 0x20001
    s_mul_i32 s71, s67, 52
    s_lshr_b32 s71, s71, 8
    s_add_u32 s71, s71, s66
    s_mul_i32 s71, s71, 5
    s_mul_i32 s70, s66, 12
    s_add_u32 s70, s70, 15
    s_cmp_lt_u32 s67, 15
    s_cselect_b32 s71, s71, s70
    s_add_u32 s71, s71, s67
    s_mov_b32 s42, 1966080
    s_movk_i32 s23, 3072
    s_cmp_lt_u32 s71, 30
    s_cselect_b32 s23, 3840, s23
    s_cselect_b32 s69, 0, 30
    s_cselect_b32 s40, s6, s12
    s_cselect_b32 s41, s7, s13
    s_cselect_b32 s42, 2457600, s42
    s_mov_b32 s43, 0x20000
    s_cmp_lt_u32 s2, 216
    s_cselect_b32 s42, s42, 0
    s_sub_u32 s69, s71, s69
    s_lshl_b32 s69, s69, 7
    s_mul_i32 s70, s68, 160
    s_mul_i32 s22, s48, 40
    s_add_u32 s70, s70, s22
    s_mul_i32 s70, s70, s23
    s_add_u32 s22, s70, s69
    v_lshrrev_b32 v2, 3, v1
    v_lshrrev_b32 v3, 4, v1
    v_and_b32 v4, 7, v1
    v_lshlrev_b32 v3, 1, v3
    v_xor_b32 v4, v4, v3
    v_mul_u32_u24 v2, s23, v2
    v_lshl_add_u32 v10, v4, 4, v2
    s_lshl_b32 s23, s23, 3
    s_mov_b32 s60, 45056
    s_mul_i32 s70, s48, 5120
    s_add_u32 m0, s70, 135168
    v_mov_b32 v6, 0
    buffer_load_dwordx4 v10, s[40:43], s22 offen lds
    s_add_u32 m0, m0, 1024
    s_add_u32 s22, s22, s23
    buffer_load_dwordx4 v10, s[40:43], s22 offen lds
    s_add_u32 m0, m0, 1024
    s_add_u32 s22, s22, s23
    buffer_load_dwordx4 v10, s[40:43], s22 offen lds
    s_add_u32 m0, m0, 1024
    s_add_u32 s22, s22, s23
    buffer_load_dwordx4 v10, s[40:43], s22 offen lds
    s_add_u32 m0, m0, 1024
    s_add_u32 s22, s22, s23
    buffer_load_dwordx4 v10, s[40:43], s22 offen lds
    s_mov_b32 s36, s20
    s_mov_b32 s37, s21
    s_mov_b32 s38, 13412352
    s_mov_b32 s39, 0x20000
    s_mov_b32 s70, 13277184
    buffer_load_dword v207, v6, s[36:39], s70 offen sc1
    s_mov_b32 s44, s16
    s_mov_b32 s45, s17
    s_mov_b32 s46, 2621440
    s_mov_b32 s47, 0x20000
    s_lshl_b32 s69, s71, 8
    s_mul_i32 s70, s68, 13824
    s_add_u32 s69, s69, s70
    s_add_u32 s69, s69, 12812288
    s_cmp_lt_u32 s2, 216
    s_cselect_b32 s69, s69, 1073741824
    v_add_u32 v247, s69, v254
    s_lshl_b32 s69, s48, 6
    s_add_u32 s69, s69, 159744
    v_lshlrev_b32 v2, 2, v1
    v_add_u32 v2, s69, v2
    v_cmp_gt_u32 vcc, 16, v1
    v_mov_b32 v12, 160512
    s_and_b32 s49, s48, 1
    v_cndmask_b32 v12, v12, v2, vcc
    v_lshrrev_b32 v2, 2, v1
    v_bfe_u32 v3, v1, 3, 2
    v_xor_b32 v3, s48, v3
    v_lshlrev_b32 v3, 5, v3
    v_lshl_add_u32 v3, v2, 7, v3
    v_and_b32 v2, 3, v1
    v_lshl_add_u32 v3, v2, 3, v3
    v_add_u32 v13, 135168, v3
    v_cmp_eq_u32 vcc, 0, v0
    s_lshr_b32 s50, s48, 1
    s_mov_b32 s72, 0
    s_mov_b32 s73, -1
    v_cndmask_b32 v252, v9, 0, vcc
    v_cmp_gt_u32 vcc, 16, v0
    s_nop 1
    v_cndmask_b32 v247, v9, v247, vcc
    v_bfe_u32 v2, v1, 4, 1
    v_bfe_u32 v3, v1, 2, 2
    v_lshl_add_u32 v3, v2, 2, v3
    v_lshrrev_b32 v4, 5, v1
    v_mul_u32_u24 v4, 7168, v4
    v_and_b32 v5, 3, v1
    v_lshl_add_u32 v4, v5, 3, v4
    v_add_u32 v4, 16384, v4
    v_mul_u32_u24 v5, 320, v3
    v_add_u32 v5, v5, v4
    s_mul_i32 s68, s50, 5
    s_add_u32 s69, s68, 1
    v_xor_b32 v6, s68, v2
    v_lshl_add_u32 v201, v6, 5, v5
    v_xor_b32 v6, s69, v2
    v_lshl_add_u32 v202, v6, 5, v5
    v_mul_u32_u24 v5, 128, v3
    v_add_u32 v5, v5, v4
    v_add_u32 v5, 5120, v5
    s_mul_i32 s68, s50, 2
    v_lshrrev_b32 v6, 1, v3
    s_add_u32 m0, s60, s62
    s_nop 0
    buffer_load_dwordx4 v188, s[24:27], s57 offen offset:0 lds
    v_xor_b32 v6, s68, v6
    v_xor_b32 v7, 0, v6
    v_lshl_add_u32 v203, v7, 5, v5
    v_xor_b32 v7, 1, v6
    v_lshl_add_u32 v204, v7, 5, v5
    v_and_b32 v2, 15, v1
    v_bfe_u32 v3, v1, 1, 3
    v_lshrrev_b32 v4, 4, v1
    v_xor_b32 v3, v3, v4
    s_lshl_b32 s68, s49, 13
    v_lshlrev_b32 v5, 7, v2
    v_add_u32 v5, s68, v5
    v_lshl_add_u32 v199, v3, 4, v5
    v_xor_b32 v3, 4, v3
    buffer_load_dwordx4 v189, s[24:27], s57 offen offset:1024 lds
    v_lshl_add_u32 v200, v3, 4, v5
    v_mov_b32 v240, 0x3f803f80
    v_mov_b32 v241, 0x3f803f80
    v_mov_b32 v242, 0x3f803f80
    v_mov_b32 v243, 0x3f803f80
    v_mov_b64 v[16:17], 0
    v_mov_b64 v[18:19], 0
    v_mov_b64 v[20:21], 0
    v_mov_b64 v[22:23], 0
    v_mov_b64 v[24:25], 0
    v_mov_b64 v[26:27], 0
    v_mov_b64 v[28:29], 0
    v_mov_b64 v[30:31], 0
    v_mov_b64 v[32:33], 0
    buffer_load_dwordx4 v190, s[24:27], s57 offen offset:2048 lds
    v_mov_b64 v[34:35], 0
    v_mov_b64 v[36:37], 0
    v_mov_b64 v[38:39], 0
    v_mov_b64 v[40:41], 0
    v_mov_b64 v[42:43], 0
    v_mov_b64 v[44:45], 0
    v_mov_b64 v[46:47], 0
    v_mov_b64 v[48:49], 0
    v_mov_b64 v[50:51], 0
    v_mov_b64 v[52:53], 0
    v_mov_b64 v[54:55], 0
    v_mov_b64 v[56:57], 0
    v_mov_b64 v[58:59], 0
    v_mov_b64 v[60:61], 0
    buffer_load_dwordx4 v191, s[24:27], s57 offen offset:3072 lds
    v_mov_b64 v[62:63], 0
    v_mov_b64 v[64:65], 0
    v_mov_b64 v[66:67], 0
    v_mov_b64 v[68:69], 0
    v_mov_b64 v[70:71], 0
    v_mov_b64 v[72:73], 0
    v_mov_b64 v[74:75], 0
    v_mov_b64 v[76:77], 0
    v_mov_b64 v[78:79], 0
    v_mov_b64 v[80:81], 0
    v_mov_b64 v[82:83], 0
    v_mov_b64 v[84:85], 0
    v_mov_b64 v[86:87], 0
    v_mov_b64 v[88:89], 0
    s_add_u32 s3, s3, 1
    s_cmp_eq_u32 s3, 10
    s_cselect_b32 s3, 0, s3
    s_lshl_b32 s57, s3, 7
    s_add_u32 m0, s60, s63
    s_nop 0
    buffer_load_dwordx4 v192, s[28:31], s58 offen offset:0 lds
    v_mov_b64 v[90:91], 0
    v_mov_b64 v[92:93], 0
    v_mov_b64 v[94:95], 0
    v_mov_b64 v[96:97], 0
    v_mov_b64 v[98:99], 0
    v_mov_b64 v[100:101], 0
    v_mov_b64 v[102:103], 0
    v_mov_b64 v[104:105], 0
    v_mov_b64 v[106:107], 0
    v_mov_b64 v[108:109], 0
    v_mov_b64 v[110:111], 0
    v_mov_b64 v[112:113], 0
    v_mov_b64 v[114:115], 0
    v_mov_b64 v[116:117], 0
    buffer_load_dwordx4 v193, s[28:31], s58 offen offset:1024 lds
    v_mov_b64 v[118:119], 0
    v_mov_b64 v[120:121], 0
    v_mov_b64 v[122:123], 0
    v_mov_b64 v[124:125], 0
    v_mov_b64 v[126:127], 0
    buffer_load_dwordx4 v194, s[28:31], s58 offen offset:2048 lds
    s_waitcnt vmcnt(13)
    s_barrier
    ds_read_b128 v[128:131], v199 offset:0
    ds_read_b128 v[132:135], v199 offset:2048
    ds_read_b128 v[136:139], v199 offset:4096
    buffer_load_dwordx4 v195, s[28:31], s58 offen offset:3072 lds
    ds_read_b128 v[140:143], v199 offset:6144
    ds_read_b64_tr_b16 v[160:161], v201 offset:0
    ds_read_b64_tr_b16 v[162:163], v201 offset:2560
    s_add_u32 m0, m0, 4096
    s_nop 0
    buffer_load_dwordx4 v196, s[28:31], s58 offen offset:0 lds
    ds_read_b64_tr_b16 v[164:165], v202 offset:0
    ds_read_b64_tr_b16 v[166:167], v202 offset:2560
    ds_read_b64_tr_b16 v[168:169], v201 offset:64
    s_mul_i32 s58, s3, 245760
    s_add_u32 m0, m0, 1024
    s_nop 0
    buffer_load_dwordx4 v197, s[32:35], s59 offen offset:0 lds
    ds_read_b64_tr_b16 v[170:171], v201 offset:2624
    ds_read_b64_tr_b16 v[172:173], v202 offset:64
    ds_read_b64_tr_b16 v[174:175], v202 offset:2624
    buffer_load_dwordx4 v198, s[32:35], s59 offen offset:1024 lds
    ds_read_b64_tr_b16 v[176:177], v201 offset:128
    ds_read_b64_tr_b16 v[178:179], v201 offset:2688
    ds_read_b64_tr_b16 v[180:181], v203 offset:0
    s_mul_i32 s59, s3, 196608
    s_mov_b32 s60, 90112
    s_add_u32 m0, s60, s62
    s_nop 0
    buffer_load_dwordx4 v188, s[24:27], s57 offen offset:0 lds
    ds_read_b64_tr_b16 v[182:183], v203 offset:1024
    ds_read_b64_tr_b16 v[184:185], v204 offset:0
    ds_read_b64_tr_b16 v[186:187], v204 offset:1024
    buffer_load_dwordx4 v189, s[24:27], s57 offen offset:1024 lds
    buffer_load_dwordx4 v190, s[24:27], s57 offen offset:2048 lds
    buffer_load_dwordx4 v191, s[24:27], s57 offen offset:3072 lds
    s_add_u32 s3, s3, 1
    s_cmp_eq_u32 s3, 10
    s_cselect_b32 s3, 0, s3
    s_lshl_b32 s57, s3, 7
    s_add_u32 m0, s60, s63
    s_nop 0
    buffer_load_dwordx4 v192, s[28:31], s58 offen offset:0 lds
    buffer_load_dwordx4 v193, s[28:31], s58 offen offset:1024 lds
    s_mov_b32 s56, 0
    s_mov_b32 s55, 0
    s_mov_b32 s65, 1
    s_mov_b32 s100, 0
    s_mov_b32 s19, 12943360
L_t0_loop:
    s_waitcnt lgkmcnt(0)
    v_mfma_f32_16x16x32_bf16 v[16:19], v[160:163], v[128:131], v[16:19]
    ds_read_b64_tr_b16 a[240:241], v203 offset:14336
    v_mfma_f32_16x16x32_bf16 v[20:23], v[160:163], v[132:135], v[20:23]
    ds_read_b128 v[144:147], v200 offset:0
    v_mfma_f32_16x16x32_bf16 v[24:27], v[160:163], v[136:139], v[24:27]
    buffer_load_dwordx4 v194, s[28:31], s58 offen offset:2048 lds
    v_mfma_f32_16x16x32_bf16 v[28:31], v[160:163], v[140:143], v[28:31]
    ds_read_b64_tr_b16 v[160:161], v201 offset:14336
    v_mfma_f32_16x16x32_bf16 v[32:35], v[164:167], v[128:131], v[32:35]
    ds_read_b64_tr_b16 v[162:163], v201 offset:16896
    s_mov_b32 s61, 45056
    v_mfma_f32_16x16x32_bf16 v[36:39], v[164:167], v[132:135], v[36:39]
    ds_read_b128 v[148:151], v200 offset:2048
    v_mfma_f32_16x16x32_bf16 v[40:43], v[164:167], v[136:139], v[40:43]
    ds_read_b64_tr_b16 a[242:243], v203 offset:15360
    v_mfma_f32_16x16x32_bf16 v[44:47], v[164:167], v[140:143], v[44:47]
    ds_read_b64_tr_b16 v[164:165], v202 offset:14336
    v_mfma_f32_16x16x32_bf16 v[48:51], v[168:171], v[128:131], v[48:51]
    ds_read_b64_tr_b16 v[166:167], v202 offset:16896
    v_mfma_f32_16x16x32_bf16 v[52:55], v[168:171], v[132:135], v[52:55]
    ds_read_b128 v[152:155], v200 offset:4096
    v_mfma_f32_16x16x32_bf16 v[56:59], v[168:171], v[136:139], v[56:59]
    buffer_load_dwordx4 v195, s[28:31], s58 offen offset:3072 lds
    v_mfma_f32_16x16x32_bf16 v[60:63], v[168:171], v[140:143], v[60:63]
    ds_read_b64_tr_b16 v[168:169], v201 offset:14400
    v_mfma_f32_16x16x32_bf16 v[64:67], v[172:175], v[128:131], v[64:67]
    ds_read_b64_tr_b16 v[170:171], v201 offset:16960
    s_cmp_eq_u32 s56, 90112
    s_cmov_b32 s61, 4294877184
    v_mfma_f32_16x16x32_bf16 v[68:71], v[172:175], v[132:135], v[68:71]
    ds_read_b128 v[156:159], v200 offset:6144
    s_add_u32 m0, m0, 4096
    v_mfma_f32_16x16x32_bf16 v[72:75], v[172:175], v[136:139], v[72:75]
    buffer_load_dwordx4 v196, s[28:31], s58 offen offset:0 lds
    v_mfma_f32_16x16x32_bf16 v[76:79], v[172:175], v[140:143], v[76:79]
    ds_read_b64_tr_b16 v[172:173], v202 offset:14400
    s_mul_i32 s58, s3, 245760
    v_mfma_f32_16x16x32_bf16 v[80:83], v[176:179], v[128:131], v[80:83]
    ds_read_b64_tr_b16 v[174:175], v202 offset:16960
    s_mov_b32 s60, s56
    v_mfma_f32_16x16x32_bf16 v[84:87], v[176:179], v[132:135], v[84:87]
    ds_read_b64_tr_b16 a[244:245], v204 offset:14336
    v_add_u32 v199, s61, v199
    v_mfma_f32_16x16x32_bf16 v[88:91], v[176:179], v[136:139], v[88:91]
    ds_read_b64_tr_b16 a[246:247], v204 offset:15360
    v_mfma_f32_16x16x32_bf16 v[92:95], v[176:179], v[140:143], v[92:95]
    ds_read_b64_tr_b16 v[176:177], v201 offset:14464
    v_mfma_f32_16x16x32_bf16 v[96:99], v[180:183], v[128:131], v[96:99]
    ds_read_b64_tr_b16 v[178:179], v201 offset:17024
    v_mfma_f32_16x16x32_bf16 v[100:103], v[180:183], v[132:135], v[100:103]
    s_add_u32 m0, m0, 1024
    v_mfma_f32_16x16x32_bf16 v[104:107], v[180:183], v[136:139], v[104:107]
    buffer_load_dwordx4 v197, s[32:35], s59 offen offset:0 lds
    v_add_u32 v204, s61, v204
    v_mfma_f32_16x16x32_bf16 v[108:111], v[180:183], v[140:143], v[108:111]
    v_add_u32 v203, s61, v203
    v_mfma_f32_16x16x32_bf16 v[112:115], v[184:187], v[128:131], v[112:115]
    v_add_u32 v202, s61, v202
    v_add_u32 v201, s61, v201
    v_mfma_f32_16x16x32_bf16 v[116:119], v[184:187], v[132:135], v[116:119]
    v_add_u32 v200, s61, v200
    v_mfma_f32_16x16x32_bf16 v[120:123], v[184:187], v[136:139], v[120:123]
    buffer_load_dwordx4 v198, s[32:35], s59 offen offset:1024 lds
    v_mfma_f32_16x16x32_bf16 v[124:127], v[184:187], v[140:143], v[124:127]
    s_mul_i32 s59, s3, 196608
    s_cmp_eq_u32 s100, 0
    s_cbranch_scc0 L_t0_rlx
    s_waitcnt vmcnt(11) lgkmcnt(0)
L_t0_back:
    s_barrier
    v_mfma_f32_16x16x32_bf16 v[16:19], v[160:163], v[144:147], v[16:19]
    ds_read_b64_tr_b16 v[180:181], v203 offset:0
    v_mfma_f32_16x16x32_bf16 v[20:23], v[160:163], v[148:151], v[20:23]
    ds_read_b128 v[128:131], v199 offset:0
    s_add_u32 m0, s60, s62
    v_mfma_f32_16x16x32_bf16 v[24:27], v[160:163], v[152:155], v[24:27]
    buffer_load_dwordx4 v188, s[24:27], s57 offen offset:0 lds
    v_mfma_f32_16x16x32_bf16 v[28:31], v[160:163], v[156:159], v[28:31]
    ds_read_b64_tr_b16 v[160:161], v201 offset:0
    v_mfma_f32_16x16x32_bf16 v[32:35], v[164:167], v[144:147], v[32:35]
    ds_read_b64_tr_b16 v[162:163], v201 offset:2560
    s_add_u32 s55, s55, 1
    v_mfma_f32_16x16x32_bf16 v[36:39], v[164:167], v[148:151], v[36:39]
    s_add_u32 s56, s56, s61
    ds_read_b128 v[132:135], v199 offset:2048
    v_mfma_f32_16x16x32_bf16 v[40:43], v[164:167], v[152:155], v[40:43]
    ds_read_b64_tr_b16 v[182:183], v203 offset:1024
    v_mfma_f32_16x16x32_bf16 v[44:47], v[164:167], v[156:159], v[44:47]
    ds_read_b64_tr_b16 v[164:165], v202 offset:0
    v_mfma_f32_16x16x32_bf16 v[48:51], v[168:171], v[144:147], v[48:51]
    ds_read_b64_tr_b16 v[166:167], v202 offset:2560
    v_mfma_f32_16x16x32_bf16 v[52:55], v[168:171], v[148:151], v[52:55]
    ds_read_b128 v[136:139], v199 offset:4096
    v_mfma_f32_16x16x32_bf16 v[56:59], v[168:171], v[152:155], v[56:59]
    buffer_load_dwordx4 v189, s[24:27], s57 offen offset:1024 lds
    v_mfma_f32_16x16x32_bf16 v[60:63], v[168:171], v[156:159], v[60:63]
    ds_read_b64_tr_b16 v[168:169], v201 offset:64
    v_mfma_f32_16x16x32_bf16 v[64:67], v[172:175], v[144:147], v[64:67]
    ds_read_b64_tr_b16 v[170:171], v201 offset:2624
    v_mfma_f32_16x16x32_bf16 v[68:71], v[172:175], v[148:151], v[68:71]
    ds_read_b128 v[140:143], v199 offset:6144
    v_mfma_f32_16x16x32_bf16 v[72:75], v[172:175], v[152:155], v[72:75]
    buffer_load_dwordx4 v190, s[24:27], s57 offen offset:2048 lds
    v_mfma_f32_16x16x32_bf16 v[76:79], v[172:175], v[156:159], v[76:79]
    ds_read_b64_tr_b16 v[172:173], v202 offset:64
    v_mfma_f32_16x16x32_bf16 v[80:83], v[176:179], v[144:147], v[80:83]
    ds_read_b64_tr_b16 v[174:175], v202 offset:2624
    v_mfma_f32_16x16x32_bf16 v[84:87], v[176:179], v[148:151], v[84:87]
    ds_read_b64_tr_b16 v[184:185], v204 offset:0
    v_mfma_f32_16x16x32_bf16 v[88:91], v[176:179], v[152:155], v[88:91]
    ds_read_b64_tr_b16 v[186:187], v204 offset:1024
    v_mfma_f32_16x16x32_bf16 v[92:95], v[176:179], v[156:159], v[92:95]
    ds_read_b64_tr_b16 v[176:177], v201 offset:128
    v_mfma_f32_16x16x32_bf16 v[96:99], a[240:243], v[144:147], v[96:99]
    ds_read_b64_tr_b16 v[178:179], v201 offset:2688
    v_mfma_f32_16x16x32_bf16 v[100:103], a[240:243], v[148:151], v[100:103]
    buffer_load_dwordx4 v191, s[24:27], s57 offen offset:3072 lds
    v_mfma_f32_16x16x32_bf16 v[104:107], a[240:243], v[152:155], v[104:107]
    s_add_u32 s3, s3, 1
    s_cmp_eq_u32 s3, 10
    s_cselect_b32 s3, 0, s3
    s_lshl_b32 s57, s3, 7
    v_mfma_f32_16x16x32_bf16 v[108:111], a[240:243], v[156:159], v[108:111]
    s_add_u32 m0, s60, s63
    v_mfma_f32_16x16x32_bf16 v[112:115], a[244:247], v[144:147], v[112:115]
    buffer_load_dwordx4 v192, s[28:31], s58 offen offset:0 lds
    v_mfma_f32_16x16x32_bf16 v[116:119], a[244:247], v[148:151], v[116:119]
    v_mfma_f32_16x16x32_bf16 v[120:123], a[244:247], v[152:155], v[120:123]
    buffer_load_dwordx4 v193, s[28:31], s58 offen offset:1024 lds
    v_mfma_f32_16x16x32_bf16 v[124:127], a[244:247], v[156:159], v[124:127]
    s_cmp_lt_u32 s55, s65
    s_cbranch_scc1 L_t0_loop
    s_cmp_lg_u32 s65, 7
    s_cbranch_scc1 L_t0_exit
    s_mov_b32 s65, 1073741824
    s_waitcnt lgkmcnt(0)
    v_mfma_f32_16x16x32_bf16 v[16:19], v[160:163], v[128:131], v[16:19]
    ds_read_b64_tr_b16 a[240:241], v203 offset:14336
    v_and_b32 v10, 15, v1
    v_mfma_f32_16x16x32_bf16 v[20:23], v[160:163], v[132:135], v[20:23]
    ds_read_b128 v[144:147], v200 offset:0
    s_lshl_b32 s68, s51, 7
    v_mfma_f32_16x16x32_bf16 v[24:27], v[160:163], v[136:139], v[24:27]
    buffer_load_dwordx4 v194, s[28:31], s58 offen offset:2048 lds
    s_lshl_b32 s69, s49, 6
    v_mfma_f32_16x16x32_bf16 v[28:31], v[160:163], v[140:143], v[28:31]
    ds_read_b64_tr_b16 v[160:161], v201 offset:14336
    s_add_u32 s68, s68, s69
    v_mfma_f32_16x16x32_bf16 v[32:35], v[164:167], v[128:131], v[32:35]
    ds_read_b64_tr_b16 v[162:163], v201 offset:16896
    s_mov_b32 s61, 45056
    v_mfma_f32_16x16x32_bf16 v[36:39], v[164:167], v[132:135], v[36:39]
    ds_read_b128 v[148:151], v200 offset:2048
    buffer_load_dwordx4 v[2:5], v254, s[36:39], s19 offen sc1
    v_mfma_f32_16x16x32_bf16 v[40:43], v[164:167], v[136:139], v[40:43]
    ds_read_b64_tr_b16 a[242:243], v203 offset:15360
    v_add_u32 v10, s68, v10
    v_mfma_f32_16x16x32_bf16 v[44:47], v[164:167], v[140:143], v[44:47]
    ds_read_b64_tr_b16 v[164:165], v202 offset:14336
    v_lshlrev_b32 v10, 5, v10
    v_mfma_f32_16x16x32_bf16 v[48:51], v[168:171], v[128:131], v[48:51]
    ds_read_b64_tr_b16 v[166:167], v202 offset:16896
    v_add_u32 v248, 12877824, v10
    v_mfma_f32_16x16x32_bf16 v[52:55], v[168:171], v[132:135], v[52:55]
    ds_read_b128 v[152:155], v200 offset:4096
    v_cmp_lt_u32 vcc, 111, v0
    v_mfma_f32_16x16x32_bf16 v[56:59], v[168:171], v[136:139], v[56:59]
    buffer_load_dwordx4 v195, s[28:31], s58 offen offset:3072 lds
    s_mul_i32 s68, s52, 80
    v_mfma_f32_16x16x32_bf16 v[60:63], v[168:171], v[140:143], v[60:63]
    ds_read_b64_tr_b16 v[168:169], v201 offset:14400
    s_lshr_b32 s69, s64, 1
    v_mfma_f32_16x16x32_bf16 v[64:67], v[172:175], v[128:131], v[64:67]
    ds_read_b64_tr_b16 v[170:171], v201 offset:16960
    s_cmp_eq_u32 s56, 90112
    s_cmov_b32 s61, 4294877184
    v_mfma_f32_16x16x32_bf16 v[68:71], v[172:175], v[132:135], v[68:71]
    ds_read_b128 v[156:159], v200 offset:6144
    s_add_u32 m0, m0, 4096
    v_mfma_f32_16x16x32_bf16 v[72:75], v[172:175], v[136:139], v[72:75]
    buffer_load_dwordx4 v196, s[28:31], s58 offen offset:0 lds
    v_cndmask_b32 v10, 0, 1, vcc
    v_mfma_f32_16x16x32_bf16 v[76:79], v[172:175], v[140:143], v[76:79]
    ds_read_b64_tr_b16 v[172:173], v202 offset:14400
    s_mul_i32 s58, s3, 245760
    v_mfma_f32_16x16x32_bf16 v[80:83], v[176:179], v[128:131], v[80:83]
    ds_read_b64_tr_b16 v[174:175], v202 offset:16960
    s_mov_b32 s60, s56
    v_mfma_f32_16x16x32_bf16 v[84:87], v[176:179], v[132:135], v[84:87]
    ds_read_b64_tr_b16 a[244:245], v204 offset:14336
    v_add_u32 v199, s61, v199
    v_mfma_f32_16x16x32_bf16 v[88:91], v[176:179], v[136:139], v[88:91]
    ds_read_b64_tr_b16 a[246:247], v204 offset:15360
    v_mul_u32_u24 v11, 112, v10
    v_mfma_f32_16x16x32_bf16 v[92:95], v[176:179], v[140:143], v[92:95]
    ds_read_b64_tr_b16 v[176:177], v201 offset:14464
    v_sub_u32 v11, v0, v11
    v_mfma_f32_16x16x32_bf16 v[96:99], v[180:183], v[128:131], v[96:99]
    ds_read_b64_tr_b16 v[178:179], v201 offset:17024
    v_cmp_gt_u32 vcc, 40, v11
    v_mfma_f32_16x16x32_bf16 v[100:103], v[180:183], v[132:135], v[100:103]
    s_add_u32 m0, m0, 1024
    v_mov_b32 v12, 1240
    v_mfma_f32_16x16x32_bf16 v[104:107], v[180:183], v[136:139], v[104:107]
    buffer_load_dwordx4 v197, s[32:35], s59 offen offset:0 lds
    v_add_u32 v204, s61, v204
    v_mfma_f32_16x16x32_bf16 v[108:111], v[180:183], v[140:143], v[108:111]
    v_add_u32 v203, s61, v203
    v_mov_b32 v13, 640
    v_mfma_f32_16x16x32_bf16 v[112:115], v[184:187], v[128:131], v[112:115]
    v_add_u32 v202, s61, v202
    v_add_u32 v201, s61, v201
    v_mfma_f32_16x16x32_bf16 v[116:119], v[184:187], v[132:135], v[116:119]
    v_add_u32 v200, s61, v200
    v_cndmask_b32 v12, v12, v13, vcc
    v_mfma_f32_16x16x32_bf16 v[120:123], v[184:187], v[136:139], v[120:123]
    buffer_load_dwordx4 v198, s[32:35], s59 offen offset:1024 lds
    v_mul_u32_u24 v13, 40, v10
    v_mfma_f32_16x16x32_bf16 v[124:127], v[184:187], v[140:143], v[124:127]
    s_mul_i32 s59, s3, 196608
    v_add3_u32 v12, v12, v13, s68
    s_waitcnt vmcnt(12) lgkmcnt(0)
    s_barrier
    v_mfma_f32_16x16x32_bf16 v[16:19], v[160:163], v[144:147], v[16:19]
    ds_read_b64_tr_b16 v[180:181], v203 offset:0
    v_cmp_gt_u32 vcc, 80, v11
    v_mfma_f32_16x16x32_bf16 v[20:23], v[160:163], v[148:151], v[20:23]
    ds_read_b128 v[128:131], v199 offset:0
    v_lshlrev_b32 v13, 5, v10
    v_mfma_f32_16x16x32_bf16 v[24:27], v[160:163], v[152:155], v[24:27]
    v_add_u32 v13, s69, v13
    v_add_u32 v13, 1840, v13
    v_mfma_f32_16x16x32_bf16 v[28:31], v[160:163], v[156:159], v[28:31]
    ds_read_b64_tr_b16 v[160:161], v201 offset:0
    v_cndmask_b32 v12, v13, v12, vcc
    v_mfma_f32_16x16x32_bf16 v[32:35], v[164:167], v[144:147], v[32:35]
    ds_read_b64_tr_b16 v[162:163], v201 offset:2560
    v_add_u32 v12, v12, v11
    v_mfma_f32_16x16x32_bf16 v[36:39], v[164:167], v[148:151], v[36:39]
    s_add_u32 s56, s56, s61
    ds_read_b128 v[132:135], v199 offset:2048
    v_mfma_f32_16x16x32_bf16 v[40:43], v[164:167], v[152:155], v[40:43]
    ds_read_b64_tr_b16 v[182:183], v203 offset:1024
    v_lshlrev_b32 v12, 2, v12
    v_mfma_f32_16x16x32_bf16 v[44:47], v[164:167], v[156:159], v[44:47]
    ds_read_b64_tr_b16 v[164:165], v202 offset:0
    v_add_u32 v249, 12812288, v12
    v_mfma_f32_16x16x32_bf16 v[48:51], v[168:171], v[144:147], v[48:51]
    ds_read_b64_tr_b16 v[166:167], v202 offset:2560
    s_lshl_b32 s68, s51, 1
    v_mfma_f32_16x16x32_bf16 v[52:55], v[168:171], v[148:151], v[52:55]
    ds_read_b128 v[136:139], v199 offset:4096
    s_add_u32 s17, s68, s53
    v_mfma_f32_16x16x32_bf16 v[56:59], v[168:171], v[152:155], v[56:59]
    s_mov_b32 s18, s52
    s_mul_i32 s68, s18, 5120
    v_mfma_f32_16x16x32_bf16 v[60:63], v[168:171], v[156:159], v[60:63]
    ds_read_b64_tr_b16 v[168:169], v201 offset:64
    s_add_u32 s68, s68, 9961472
    v_mfma_f32_16x16x32_bf16 v[64:67], v[172:175], v[144:147], v[64:67]
    ds_read_b64_tr_b16 v[170:171], v201 offset:2624
    s_mul_i32 s69, s48, 491520
    v_mfma_f32_16x16x32_bf16 v[68:71], v[172:175], v[148:151], v[68:71]
    ds_read_b128 v[140:143], v199 offset:6144
    s_add_u32 s12, s68, s69
    v_mfma_f32_16x16x32_bf16 v[72:75], v[172:175], v[152:155], v[72:75]
    s_mul_i32 s69, s48, 204800
    s_add_u32 s13, s68, s69
    v_mfma_f32_16x16x32_bf16 v[76:79], v[172:175], v[156:159], v[76:79]
    ds_read_b64_tr_b16 v[172:173], v202 offset:64
    s_add_u32 s13, s13, 1966080
    v_mfma_f32_16x16x32_bf16 v[80:83], v[176:179], v[144:147], v[80:83]
    ds_read_b64_tr_b16 v[174:175], v202 offset:2624
    v_mfma_f32_16x16x32_bf16 v[84:87], v[176:179], v[148:151], v[84:87]
    ds_read_b64_tr_b16 v[184:185], v204 offset:0
    s_waitcnt vmcnt(4)
    v_mfma_f32_16x16x32_bf16 v[88:91], v[176:179], v[152:155], v[88:91]
    ds_read_b64_tr_b16 v[186:187], v204 offset:1024
    v_cmp_eq_u32 s[74:75], s54, v2
    v_mfma_f32_16x16x32_bf16 v[92:95], v[176:179], v[156:159], v[92:95]
    ds_read_b64_tr_b16 v[176:177], v201 offset:128
    v_cmp_eq_u32 vcc, s54, v3
    v_mfma_f32_16x16x32_bf16 v[96:99], a[240:243], v[144:147], v[96:99]
    ds_read_b64_tr_b16 v[178:179], v201 offset:2688
    s_and_b64 s[74:75], s[74:75], vcc
    v_mfma_f32_16x16x32_bf16 v[100:103], a[240:243], v[148:151], v[100:103]
    v_cmp_eq_u32 vcc, s54, v4
    v_mfma_f32_16x16x32_bf16 v[104:107], a[240:243], v[152:155], v[104:107]
    s_and_b64 s[74:75], s[74:75], vcc
    v_mfma_f32_16x16x32_bf16 v[108:111], a[240:243], v[156:159], v[108:111]
    v_cmp_eq_u32 vcc, s54, v5
    v_mfma_f32_16x16x32_bf16 v[112:115], a[244:247], v[144:147], v[112:115]
    s_and_b64 s[74:75], s[74:75], vcc
    v_mfma_f32_16x16x32_bf16 v[116:119], a[244:247], v[148:151], v[116:119]
    s_cmp_eq_u64 s[74:75], -1
    v_mfma_f32_16x16x32_bf16 v[120:123], a[244:247], v[152:155], v[120:123]
    s_cbranch_scc0 L_t0_slow
L_t0_fast:
    v_mfma_f32_16x16x32_bf16 v[124:127], a[244:247], v[156:159], v[124:127]
    s_mov_b32 s66, 13824
    s_mov_b32 s67, 27648
    s_waitcnt lgkmcnt(0)
    v_mfma_f32_16x16x32_bf16 v[16:19], v[160:163], v[128:131], v[16:19]
    ds_read_b64_tr_b16 a[240:241], v203 offset:14336
    s_mov_b32 s68, 41472
    v_mfma_f32_16x16x32_bf16 v[20:23], v[160:163], v[132:135], v[20:23]
    ds_read_b128 v[144:147], v200 offset:0
    buffer_load_dword v228, v249, s[36:39], 0 offen sc1
    v_mfma_f32_16x16x32_bf16 v[24:27], v[160:163], v[136:139], v[24:27]
    v_mfma_f32_16x16x32_bf16 v[28:31], v[160:163], v[140:143], v[28:31]
    ds_read_b64_tr_b16 v[160:161], v201 offset:14336
    buffer_load_dword v229, v249, s[36:39], s66 offen sc1
    v_mfma_f32_16x16x32_bf16 v[32:35], v[164:167], v[128:131], v[32:35]
    ds_read_b64_tr_b16 v[162:163], v201 offset:16896
    s_mov_b32 s61, 45056
    v_mfma_f32_16x16x32_bf16 v[36:39], v[164:167], v[132:135], v[36:39]
    ds_read_b128 v[148:151], v200 offset:2048
    buffer_load_dword v230, v249, s[36:39], s67 offen sc1
    v_mfma_f32_16x16x32_bf16 v[40:43], v[164:167], v[136:139], v[40:43]
    ds_read_b64_tr_b16 a[242:243], v203 offset:15360
    v_mfma_f32_16x16x32_bf16 v[44:47], v[164:167], v[140:143], v[44:47]
    ds_read_b64_tr_b16 v[164:165], v202 offset:14336
    buffer_load_dword v231, v249, s[36:39], s68 offen sc1
    v_mfma_f32_16x16x32_bf16 v[48:51], v[168:171], v[128:131], v[48:51]
    ds_read_b64_tr_b16 v[166:167], v202 offset:16896
    v_mfma_f32_16x16x32_bf16 v[52:55], v[168:171], v[132:135], v[52:55]
    ds_read_b128 v[152:155], v200 offset:4096
    buffer_load_dwordx4 v[208:211], v248, s[36:39], 0 offen offset:0 sc1
    v_mfma_f32_16x16x32_bf16 v[56:59], v[168:171], v[136:139], v[56:59]
    v_mfma_f32_16x16x32_bf16 v[60:63], v[168:171], v[140:143], v[60:63]
    ds_read_b64_tr_b16 v[168:169], v201 offset:14400
    v_mfma_f32_16x16x32_bf16 v[64:67], v[172:175], v[128:131], v[64:67]
    ds_read_b64_tr_b16 v[170:171], v201 offset:16960
    s_cmp_eq_u32 s56, 90112
    s_cmov_b32 s61, 4294877184
    v_mfma_f32_16x16x32_bf16 v[68:71], v[172:175], v[132:135], v[68:71]
    ds_read_b128 v[156:159], v200 offset:6144
    v_mfma_f32_16x16x32_bf16 v[72:75], v[172:175], v[136:139], v[72:75]
    buffer_load_dwordx4 v[212:215], v248, s[36:39], 0 offen offset:512 sc1
    v_mfma_f32_16x16x32_bf16 v[76:79], v[172:175], v[140:143], v[76:79]
    ds_read_b64_tr_b16 v[172:173], v202 offset:14400
    v_mfma_f32_16x16x32_bf16 v[80:83], v[176:179], v[128:131], v[80:83]
    ds_read_b64_tr_b16 v[174:175], v202 offset:16960
    s_mov_b32 s60, s56
    v_mfma_f32_16x16x32_bf16 v[84:87], v[176:179], v[132:135], v[84:87]
    ds_read_b64_tr_b16 a[244:245], v204 offset:14336
    v_add_u32 v199, s61, v199
    buffer_load_dwordx4 v[216:219], v248, s[36:39], 0 offen offset:1024 sc1
    v_mfma_f32_16x16x32_bf16 v[88:91], v[176:179], v[136:139], v[88:91]
    ds_read_b64_tr_b16 a[246:247], v204 offset:15360
    buffer_load_dwordx4 v[220:223], v248, s[36:39], 0 offen offset:1536 sc1
    v_mfma_f32_16x16x32_bf16 v[92:95], v[176:179], v[140:143], v[92:95]
    ds_read_b64_tr_b16 v[176:177], v201 offset:14464
    v_mfma_f32_16x16x32_bf16 v[96:99], v[180:183], v[128:131], v[96:99]
    ds_read_b64_tr_b16 v[178:179], v201 offset:17024
    s_lshl_b32 s69, s51, 1
    v_mfma_f32_16x16x32_bf16 v[100:103], v[180:183], v[132:135], v[100:103]
    buffer_load_dwordx4 a[0:3], v254, s[36:39], s12 offen offset:0 sc1
    s_add_u32 s69, s69, s49
    v_mfma_f32_16x16x32_bf16 v[104:107], v[180:183], v[136:139], v[104:107]
    v_add_u32 v204, s61, v204
    buffer_load_dwordx4 a[4:7], v254, s[36:39], s12 offen offset:1024 sc1
    v_mfma_f32_16x16x32_bf16 v[108:111], v[180:183], v[140:143], v[108:111]
    v_add_u32 v203, s61, v203
    s_mul_i32 s16, s69, 196608
    v_mfma_f32_16x16x32_bf16 v[112:115], v[184:187], v[128:131], v[112:115]
    v_add_u32 v202, s61, v202
    v_add_u32 v201, s61, v201
    buffer_load_dwordx4 a[8:11], v254, s[36:39], s12 offen offset:2048 sc1
    v_mfma_f32_16x16x32_bf16 v[116:119], v[184:187], v[132:135], v[116:119]
    v_add_u32 v200, s61, v200
    s_lshr_b32 s69, s52, 1
    v_mfma_f32_16x16x32_bf16 v[120:123], v[184:187], v[136:139], v[120:123]
    buffer_load_dwordx4 a[12:15], v254, s[36:39], s12 offen offset:3072 sc1
    s_add_u32 s12, s12, 4096
    v_mfma_f32_16x16x32_bf16 v[124:127], v[184:187], v[140:143], v[124:127]
    buffer_load_dwordx4 a[16:19], v254, s[36:39], s12 offen offset:0 sc1
    s_add_u32 s12, s12, 36864
    s_waitcnt vmcnt(13) lgkmcnt(0)
    s_barrier
    v_mfma_f32_16x16x32_bf16 v[16:19], v[160:163], v[144:147], v[16:19]
    ds_read_b64_tr_b16 v[180:181], v203 offset:0
    s_mul_i32 s69, s69, 12288
    v_mfma_f32_16x16x32_bf16 v[20:23], v[160:163], v[148:151], v[20:23]
    ds_read_b128 v[128:131], v199 offset:0
    s_add_u32 s16, s16, s69
    v_mfma_f32_16x16x32_bf16 v[24:27], v[160:163], v[152:155], v[24:27]
    s_and_b32 s69, s52, 1
    s_lshl_b32 s69, s69, 1
    v_mfma_f32_16x16x32_bf16 v[28:31], v[160:163], v[156:159], v[28:31]
    ds_read_b64_tr_b16 v[160:161], v201 offset:0
    s_add_u32 s69, s69, s50
    v_mfma_f32_16x16x32_bf16 v[32:35], v[164:167], v[144:147], v[32:35]
    ds_read_b64_tr_b16 v[162:163], v201 offset:2560
    s_lshl_b32 s69, s69, 10
    v_mfma_f32_16x16x32_bf16 v[36:39], v[164:167], v[148:151], v[36:39]
    s_add_u32 s56, s56, s61
    ds_read_b128 v[132:135], v199 offset:2048
    v_mfma_f32_16x16x32_bf16 v[40:43], v[164:167], v[152:155], v[40:43]
    ds_read_b64_tr_b16 v[182:183], v203 offset:1024
    s_add_u32 s16, s16, s69
    v_mfma_f32_16x16x32_bf16 v[44:47], v[164:167], v[156:159], v[44:47]
    ds_read_b64_tr_b16 v[164:165], v202 offset:0
    s_add_u32 s16, s16, 8192
    v_mfma_f32_16x16x32_bf16 v[48:51], v[168:171], v[144:147], v[48:51]
    ds_read_b64_tr_b16 v[166:167], v202 offset:2560
    s_lshl_b32 s69, s17, 2
    v_mfma_f32_16x16x32_bf16 v[52:55], v[168:171], v[148:151], v[52:55]
    ds_read_b128 v[136:139], v199 offset:4096
    s_add_u32 s69, s69, s48
    v_mfma_f32_16x16x32_bf16 v[56:59], v[168:171], v[152:155], v[56:59]
    buffer_load_dwordx4 a[20:23], v254, s[36:39], s12 offen offset:0 sc1
    s_lshl_b32 s69, s69, 4
    v_mfma_f32_16x16x32_bf16 v[60:63], v[168:171], v[156:159], v[60:63]
    ds_read_b64_tr_b16 v[168:169], v201 offset:64
    v_and_b32 v14, 15, v1
    v_mfma_f32_16x16x32_bf16 v[64:67], v[172:175], v[144:147], v[64:67]
    ds_read_b64_tr_b16 v[170:171], v201 offset:2624
    v_add_u32 v14, s69, v14
    v_mfma_f32_16x16x32_bf16 v[68:71], v[172:175], v[148:151], v[68:71]
    ds_read_b128 v[140:143], v199 offset:6144
    v_mul_u32_u24 v14, 1280, v14
    v_mfma_f32_16x16x32_bf16 v[72:75], v[172:175], v[152:155], v[72:75]
    s_cmp_eq_u32 s2, 0
    s_cselect_b32 s67, 13277184, s65
    v_lshrrev_b32 v15, 4, v1
    v_mfma_f32_16x16x32_bf16 v[76:79], v[172:175], v[156:159], v[76:79]
    ds_read_b64_tr_b16 v[172:173], v202 offset:64
    v_lshl_add_u32 v14, v15, 3, v14
    v_mfma_f32_16x16x32_bf16 v[80:83], v[176:179], v[144:147], v[80:83]
    ds_read_b64_tr_b16 v[174:175], v202 offset:2624
    s_mul_i32 s69, s18, 160
    v_mfma_f32_16x16x32_bf16 v[84:87], v[176:179], v[148:151], v[84:87]
    ds_read_b64_tr_b16 v[184:185], v204 offset:0
    buffer_store_dword v251, v252, s[36:39], s67 offen sc1
    v_mfma_f32_16x16x32_bf16 v[88:91], v[176:179], v[152:155], v[88:91]
    ds_read_b64_tr_b16 v[186:187], v204 offset:1024
    v_add_u32 v249, s69, v14
    v_mfma_f32_16x16x32_bf16 v[92:95], v[176:179], v[156:159], v[92:95]
    ds_read_b64_tr_b16 v[176:177], v201 offset:128
    v_and_b32 v2, 15, v1
    v_mfma_f32_16x16x32_bf16 v[96:99], a[240:243], v[144:147], v[96:99]
    ds_read_b64_tr_b16 v[178:179], v201 offset:2688
    s_lshl_b32 s70, s49, 6
    v_mfma_f32_16x16x32_bf16 v[100:103], a[240:243], v[148:151], v[100:103]
    buffer_load_dwordx4 a[24:27], v254, s[36:39], s12 offen offset:1024 sc1
    v_add_u32 v12, s70, v2
    v_mfma_f32_16x16x32_bf16 v[104:107], a[240:243], v[152:155], v[104:107]
    buffer_load_dwordx4 a[28:31], v254, s[36:39], s12 offen offset:2048 sc1
    v_mul_u32_u24 v12, 200, v12
    v_mfma_f32_16x16x32_bf16 v[108:111], a[240:243], v[156:159], v[108:111]
    s_mul_i32 s70, s50, 96
    v_add_u32 v12, s70, v12
    v_mfma_f32_16x16x32_bf16 v[112:115], a[244:247], v[144:147], v[112:115]
    buffer_load_dwordx4 a[32:35], v254, s[36:39], s12 offen offset:3072 sc1
    s_add_u32 s12, s12, 4096
    v_mfma_f32_16x16x32_bf16 v[116:119], a[244:247], v[148:151], v[116:119]
    v_lshrrev_b32 v13, 4, v1
    v_add_u32 v9, 0, v13
    v_mfma_f32_16x16x32_bf16 v[120:123], a[244:247], v[152:155], v[120:123]
    buffer_load_dwordx4 a[36:39], v254, s[36:39], s12 offen offset:0 sc1
    s_add_u32 s12, s12, 36864
    v_mfma_f32_16x16x32_bf16 v[124:127], a[244:247], v[156:159], v[124:127]
    v_mul_u32_u24 v10, 52, v9
    v_lshrrev_b32 v10, 8, v10
    s_waitcnt vmcnt(11) lgkmcnt(0)
    v_mfma_f32_16x16x32_bf16 v[16:19], v[160:163], v[128:131], v[16:19]
    ds_read_b64_tr_b16 a[240:241], v203 offset:14336
    v_add_f32 v228, v228, v229
    v_mfma_f32_16x16x32_bf16 v[20:23], v[160:163], v[132:135], v[20:23]
    ds_read_b128 v[144:147], v200 offset:0
    v_add_f32 v230, v230, v231
    v_mfma_f32_16x16x32_bf16 v[24:27], v[160:163], v[136:139], v[24:27]
    v_lshlrev_b32 v15, 2, v0
    buffer_load_dwordx4 a[40:43], v254, s[36:39], s12 offen offset:0 sc1
    v_mfma_f32_16x16x32_bf16 v[28:31], v[160:163], v[140:143], v[28:31]
    ds_read_b64_tr_b16 v[160:161], v201 offset:14336
    v_add_f32 v14, v228, v230
    v_mfma_f32_16x16x32_bf16 v[32:35], v[164:167], v[128:131], v[32:35]
    ds_read_b64_tr_b16 v[162:163], v201 offset:16896
    v_add_u32 v15, 159744, v15
    v_mfma_f32_16x16x32_bf16 v[36:39], v[164:167], v[132:135], v[36:39]
    ds_read_b128 v[148:151], v200 offset:2048
    v_mul_f32 v224, 897988541, v211
    v_mfma_f32_16x16x32_bf16 v[40:43], v[164:167], v[136:139], v[40:43]
    ds_read_b64_tr_b16 a[242:243], v203 offset:15360
    v_mul_f32 v225, 897988541, v215
    v_mfma_f32_16x16x32_bf16 v[44:47], v[164:167], v[140:143], v[44:47]
    ds_read_b64_tr_b16 v[164:165], v202 offset:14336
    v_mul_f32 v226, 897988541, v219
    v_mfma_f32_16x16x32_bf16 v[48:51], v[168:171], v[128:131], v[48:51]
    ds_read_b64_tr_b16 v[166:167], v202 offset:16896
    v_mul_f32 v227, 897988541, v223
    v_mfma_f32_16x16x32_bf16 v[52:55], v[168:171], v[132:135], v[52:55]
    ds_read_b128 v[152:155], v200 offset:4096
    v_lshrrev_b32 v3, 4, v1
    v_mfma_f32_16x16x32_bf16 v[56:59], v[168:171], v[136:139], v[56:59]
    v_lshlrev_b32 v3, 4, v3
    s_mul_i32 s66, s50, 448
    v_mfma_f32_16x16x32_bf16 v[60:63], v[168:171], v[140:143], v[60:63]
    ds_read_b64_tr_b16 v[168:169], v201 offset:14400
    s_add_u32 s66, s66, 159744
    v_mfma_f32_16x16x32_bf16 v[64:67], v[172:175], v[128:131], v[64:67]
    ds_read_b64_tr_b16 v[170:171], v201 offset:16960
    v_add_u32 v250, s66, v3
    v_mfma_f32_16x16x32_bf16 v[68:71], v[172:175], v[132:135], v[68:71]
    ds_read_b128 v[156:159], v200 offset:6144
    v_lshl_add_u32 v11, v9, 3, v12
    v_mfma_f32_16x16x32_bf16 v[72:75], v[172:175], v[136:139], v[72:75]
    ds_write_b32 v15, v14
    v_lshl_add_u32 v11, v10, 3, v11
    v_mfma_f32_16x16x32_bf16 v[76:79], v[172:175], v[140:143], v[76:79]
    ds_read_b64_tr_b16 v[172:173], v202 offset:14400
    v_lshrrev_b32 v10, 1, v10
    v_mfma_f32_16x16x32_bf16 v[80:83], v[176:179], v[128:131], v[80:83]
    ds_read_b64_tr_b16 v[174:175], v202 offset:16960
    v_mul_u32_u24 v10, 25504, v10
    v_mfma_f32_16x16x32_bf16 v[84:87], v[176:179], v[132:135], v[84:87]
    ds_read_b64_tr_b16 a[244:245], v204 offset:14336
    v_add_u32 v4, v10, v11
    v_mfma_f32_16x16x32_bf16 v[88:91], v[176:179], v[136:139], v[88:91]
    ds_read_b64_tr_b16 a[246:247], v204 offset:15360
    v_add_u32 v9, 4, v13
    v_mfma_f32_16x16x32_bf16 v[92:95], v[176:179], v[140:143], v[92:95]
    ds_read_b64_tr_b16 v[176:177], v201 offset:14464
    v_mul_u32_u24 v10, 52, v9
    v_mfma_f32_16x16x32_bf16 v[96:99], v[180:183], v[128:131], v[96:99]
    ds_read_b64_tr_b16 v[178:179], v201 offset:17024
    v_lshrrev_b32 v10, 8, v10
    v_mfma_f32_16x16x32_bf16 v[100:103], v[180:183], v[132:135], v[100:103]
    buffer_load_dwordx4 a[44:47], v254, s[36:39], s12 offen offset:1024 sc1
    v_lshl_add_u32 v11, v9, 3, v12
    v_mfma_f32_16x16x32_bf16 v[104:107], v[180:183], v[136:139], v[104:107]
    v_lshl_add_u32 v11, v10, 3, v11
    v_lshrrev_b32 v10, 1, v10
    v_mfma_f32_16x16x32_bf16 v[108:111], v[180:183], v[140:143], v[108:111]
    buffer_load_dwordx4 a[48:51], v254, s[36:39], s12 offen offset:2048 sc1
    v_mul_u32_u24 v10, 25504, v10
    v_mfma_f32_16x16x32_bf16 v[112:115], v[184:187], v[128:131], v[112:115]
    v_add_u32 v5, v10, v11
    v_add_u32 v9, 8, v13
    v_mfma_f32_16x16x32_bf16 v[116:119], v[184:187], v[132:135], v[116:119]
    buffer_load_dwordx4 a[52:55], v254, s[36:39], s12 offen offset:3072 sc1
    s_add_u32 s12, s12, 4096
    v_mfma_f32_16x16x32_bf16 v[120:123], v[184:187], v[136:139], v[120:123]
    v_mul_u32_u24 v10, 52, v9
    v_lshrrev_b32 v10, 8, v10
    v_mfma_f32_16x16x32_bf16 v[124:127], v[184:187], v[140:143], v[124:127]
    buffer_load_dwordx4 a[56:59], v254, s[36:39], s12 offen offset:0 sc1
    s_add_u32 s12, s12, 36864
    s_waitcnt lgkmcnt(0)
    s_barrier
    v_mfma_f32_16x16x32_bf16 v[16:19], v[160:163], v[144:147], v[16:19]
    ds_read_b128 v[228:231], v250 offset:0
    v_lshl_add_u32 v11, v9, 3, v12
    v_mfma_f32_16x16x32_bf16 v[20:23], v[160:163], v[148:151], v[20:23]
    ds_read_b128 v[232:235], v250 offset:64
    v_lshl_add_u32 v11, v10, 3, v11
    v_mfma_f32_16x16x32_bf16 v[24:27], v[160:163], v[152:155], v[24:27]
    ds_read_b128 v[236:239], v250 offset:128
    v_lshrrev_b32 v10, 1, v10
    v_mfma_f32_16x16x32_bf16 v[28:31], v[160:163], v[156:159], v[28:31]
    ds_read_b128 v[240:243], v250 offset:192
    v_mul_u32_u24 v10, 25504, v10
    v_mfma_f32_16x16x32_bf16 v[32:35], v[164:167], v[144:147], v[32:35]
    ds_read_b128 v[244:247], v250 offset:256
    v_add_u32 v6, v10, v11
    v_mfma_f32_16x16x32_bf16 v[36:39], v[164:167], v[148:151], v[36:39]
    ds_read_b128 v[188:191], v250 offset:320
    v_add_u32 v9, 12, v13
    v_mfma_f32_16x16x32_bf16 v[40:43], v[164:167], v[152:155], v[40:43]
    ds_read_b128 v[192:195], v250 offset:384
    v_mul_u32_u24 v10, 52, v9
    v_mfma_f32_16x16x32_bf16 v[44:47], v[164:167], v[156:159], v[44:47]
    v_lshrrev_b32 v10, 8, v10
    v_lshl_add_u32 v11, v9, 3, v12
    v_mfma_f32_16x16x32_bf16 v[48:51], v[168:171], v[144:147], v[48:51]
    buffer_load_dwordx4 a[60:63], v254, s[36:39], s12 offen offset:0 sc1
    v_lshl_add_u32 v11, v10, 3, v11
    v_mfma_f32_16x16x32_bf16 v[52:55], v[168:171], v[148:151], v[52:55]
    v_lshrrev_b32 v10, 1, v10
    v_mul_u32_u24 v10, 25504, v10
    v_mfma_f32_16x16x32_bf16 v[56:59], v[168:171], v[152:155], v[56:59]
    buffer_load_dwordx4 a[64:67], v254, s[36:39], s12 offen offset:1024 sc1
    v_add_u32 v7, v10, v11
    v_mfma_f32_16x16x32_bf16 v[60:63], v[168:171], v[156:159], v[60:63]
    v_add_u32 v9, 16, v13
    v_mul_u32_u24 v10, 52, v9
    v_mfma_f32_16x16x32_bf16 v[64:67], v[172:175], v[144:147], v[64:67]
    v_lshrrev_b32 v10, 8, v10
    v_lshl_add_u32 v11, v9, 3, v12
    v_mfma_f32_16x16x32_bf16 v[68:71], v[172:175], v[148:151], v[68:71]
    buffer_load_dwordx4 a[68:71], v254, s[36:39], s12 offen offset:2048 sc1
    v_lshl_add_u32 v11, v10, 3, v11
    v_mfma_f32_16x16x32_bf16 v[72:75], v[172:175], v[152:155], v[72:75]
    v_lshrrev_b32 v10, 1, v10
    v_mul_u32_u24 v10, 25504, v10
    v_mfma_f32_16x16x32_bf16 v[76:79], v[172:175], v[156:159], v[76:79]
    buffer_load_dwordx4 a[72:75], v254, s[36:39], s12 offen offset:3072 sc1
    s_add_u32 s12, s12, 4096
    v_mfma_f32_16x16x32_bf16 v[80:83], v[176:179], v[144:147], v[80:83]
    v_add_u32 v8, v10, v11
    s_mul_i32 s60, s48, 25600
    v_mfma_f32_16x16x32_bf16 v[84:87], v[176:179], v[148:151], v[84:87]
    buffer_load_dwordx4 a[76:79], v254, s[36:39], s12 offen offset:0 sc1
    s_add_u32 s12, s12, 36864
    v_mfma_f32_16x16x32_bf16 v[88:91], v[176:179], v[152:155], v[88:91]
    s_add_u32 s60, s60, 51200
    v_lshlrev_b32 v9, 5, v13
    v_mfma_f32_16x16x32_bf16 v[92:95], v[176:179], v[156:159], v[92:95]
    buffer_load_dwordx4 a[80:83], v254, s[36:39], s12 offen offset:0 sc1
    v_add_u32 v9, v9, v2
    v_mfma_f32_16x16x32_bf16 v[96:99], a[240:243], v[144:147], v[96:99]
    v_mul_u32_u24 v9, 200, v9
    s_mul_i32 s67, s48, 48
    v_mfma_f32_16x16x32_bf16 v[100:103], a[240:243], v[148:151], v[100:103]
    buffer_load_dwordx4 a[84:87], v254, s[36:39], s12 offen offset:1024 sc1
    v_add_u32 v9, s67, v9
    v_mfma_f32_16x16x32_bf16 v[104:107], a[240:243], v[152:155], v[104:107]
    v_mov_b32 v10, 0x3f80
    v_mov_b32 v11, 0
    v_mfma_f32_16x16x32_bf16 v[108:111], a[240:243], v[156:159], v[108:111]
    buffer_load_dwordx4 a[88:91], v254, s[36:39], s12 offen offset:2048 sc1
    ds_write_b64 v9, v[10:11] offset:25640
    v_mfma_f32_16x16x32_bf16 v[112:115], a[244:247], v[144:147], v[112:115]
    ds_write_b64 v9, v[10:11] offset:28840
    v_bfe_u32 v2, v1, 2, 2
    v_mfma_f32_16x16x32_bf16 v[116:119], a[244:247], v[148:151], v[116:119]
    buffer_load_dwordx4 a[92:95], v254, s[36:39], s12 offen offset:3072 sc1
    s_add_u32 s12, s12, 4096
    v_mfma_f32_16x16x32_bf16 v[120:123], a[244:247], v[152:155], v[120:123]
    v_lshlrev_b32 v2, 3, v2
    v_lshrrev_b32 v3, 5, v1
    v_mfma_f32_16x16x32_bf16 v[124:127], a[244:247], v[156:159], v[124:127]
    v_lshl_add_u32 v2, v3, 1, v2
    v_mul_u32_u24 v2, 200, v2
    v_bfe_u32 v12, v1, 4, 1
    v_lshl_add_u32 v2, v12, 5, v2
    v_and_b32 v12, 3, v1
    v_lshl_add_u32 v2, v12, 3, v2
    s_lshl_b32 s68, s50, 1
    s_add_u32 s68, s68, s49
    s_mul_i32 s67, s68, 48
    v_add_u32 v196, s67, v2
    v_and_b32 v12, 31, v1
    v_mul_u32_u24 v13, 80, v12
    v_lshl_add_u32 v13, v3, 4, v13
    v_mov_b32 v9, 1792
    v_cmp_gt_u32 vcc, 21, v1
    s_lshl_b32 s67, s52, 2
    s_add_u32 s67, s67, s68
    v_cndmask_b32 v198, v9, v13, vcc
    v_cmp_gt_u32 vcc, 21, v12
    s_mul_i32 s67, s67, 1792
    s_add_u32 s22, s67, 12746752
    v_cndmask_b32 v197, v9, v13, vcc
    v_add_u32 v198, s60, v198
    v_add_u32 v197, s60, v197
    v_lshlrev_b32 v201, 2, v1
    v_add_u32 v199, s60, v201
    v_cmp_gt_u32 vcc, 36, v1
    v_mov_b32 v9, 1073741824
    s_nop 0
    v_cndmask_b32 v200, v9, v201, vcc
    v_bfe_u32 v168, v1, 4, 1
    v_mul_u32_u24 v168, 24, v168
    v_add_u32 v168, v168, v249
    buffer_load_dwordx4 v[170:173], v168, s[24:27], 0 offen offset:0
    buffer_load_dwordx4 v[174:177], v168, s[24:27], 0 offen offset:64
    buffer_load_dwordx2 v[178:179], v249, s[24:27], 0 offen offset:128
    s_waitcnt lgkmcnt(0)
    v_mov_b32 v14, 3276275712
    v_mov_b32 v15, 0xff800000
    v_cndmask_b32 v180, v210, 0, s[72:73]
    v_cndmask_b32 v181, 0, v14, s[72:73]
    v_cndmask_b32 v9, v224, v15, s[72:73]
    v_cndmask_b32 v182, v214, 0, s[72:73]
    v_cndmask_b32 v183, 0, v14, s[72:73]
    v_cndmask_b32 v10, v225, v15, s[72:73]
    v_cndmask_b32 v184, v218, 0, s[72:73]
    v_cndmask_b32 v185, 0, v14, s[72:73]
    v_cndmask_b32 v11, v226, v15, s[72:73]
    v_cndmask_b32 v186, v222, 0, s[72:73]
    v_cndmask_b32 v187, 0, v14, s[72:73]
    v_cndmask_b32 v12, v227, v15, s[72:73]
    v_pk_fma_f32 v[152:153], v[228:229], v[208:209], v[16:17] op_sel_hi:[1,0,1]
    v_pk_fma_f32 v[154:155], v[230:231], v[208:209], v[18:19] op_sel_hi:[1,0,1]
    v_pk_fma_f32 v[156:157], v[232:233], v[208:209], v[32:33] op_sel_hi:[1,0,1]
    v_pk_fma_f32 v[158:159], v[234:235], v[208:209], v[34:35] op_sel_hi:[1,0,1]
    v_pk_mul_f32 v[160:161], v[152:153], v[210:211] op_sel_hi:[1,0]
    v_pk_mul_f32 v[162:163], v[154:155], v[210:211] op_sel_hi:[1,0]
    buffer_load_dwordx4 a[96:99], v254, s[36:39], s12 offen offset:0 sc1
    s_add_u32 s12, s12, 36864
    v_pk_mul_f32 v[164:165], v[156:157], v[210:211] op_sel_hi:[1,0]
    v_pk_mul_f32 v[166:167], v[158:159], v[210:211] op_sel_hi:[1,0]
    v_exp_f32_e64 v160, v160 clamp
    v_max_f32 v152, v224, v152
    v_exp_f32_e64 v161, v161 clamp
    v_max_f32 v153, v224, v153
    v_exp_f32_e64 v162, v162 clamp
    v_max_f32 v154, v224, v154
    v_exp_f32_e64 v163, v163 clamp
    v_max_f32 v155, v224, v155
    v_exp_f32_e64 v164, v164 clamp
    v_max_f32 v156, v224, v156
    v_exp_f32_e64 v165, v165 clamp
    v_max_f32 v157, v224, v157
    v_exp_f32_e64 v166, v166 clamp
    v_max_f32 v158, v224, v158
    v_exp_f32_e64 v167, v167 clamp
    v_max_f32 v159, v224, v159
    v_pk_fma_f32 v[152:153], v[152:153], v[208:209], v[160:161] op_sel:[0,1,0]
    v_pk_fma_f32 v[154:155], v[154:155], v[208:209], v[162:163] op_sel:[0,1,0]
    buffer_load_dwordx4 a[100:103], v254, s[36:39], s12 offen offset:0 sc1
    v_pk_fma_f32 v[156:157], v[156:157], v[208:209], v[164:165] op_sel:[0,1,0]
    v_pk_fma_f32 v[158:159], v[158:159], v[208:209], v[166:167] op_sel:[0,1,0]
    v_cvt_pk_bf16_f32 v144, v152, v153
    v_cvt_pk_bf16_f32 v145, v154, v155
    v_cvt_pk_bf16_f32 v146, v156, v157
    v_cvt_pk_bf16_f32 v147, v158, v159
    ds_write_b64 v4, v[144:145] offset:0
    ds_write_b64 v5, v[146:147] offset:0
    v_pk_fma_f32 v[128:129], v[240:241], v[208:209], v[64:65] op_sel_hi:[1,0,1]
    v_pk_fma_f32 v[130:131], v[242:243], v[208:209], v[66:67] op_sel_hi:[1,0,1]
    v_pk_fma_f32 v[132:133], v[244:245], v[208:209], v[80:81] op_sel_hi:[1,0,1]
    v_pk_fma_f32 v[134:135], v[246:247], v[208:209], v[82:83] op_sel_hi:[1,0,1]
    v_pk_mul_f32 v[128:129], v[128:129], v[208:209] op_sel:[0,1]
    v_pk_mul_f32 v[130:131], v[130:131], v[208:209] op_sel:[0,1]
    v_pk_mul_f32 v[132:133], v[132:133], v[208:209] op_sel:[0,1]
    v_pk_mul_f32 v[134:135], v[134:135], v[208:209] op_sel:[0,1]
    v_cvt_pk_bf16_f32 v148, v128, v129
    v_cvt_pk_bf16_f32 v149, v130, v131
    v_cvt_pk_bf16_f32 v150, v132, v133
    v_cvt_pk_bf16_f32 v151, v134, v135
    buffer_load_dwordx4 a[104:107], v254, s[36:39], s12 offen offset:1024 sc1
    ds_write_b64 v7, v[148:149] offset:0
    ds_write_b64 v8, v[150:151] offset:0
    v_pk_fma_f32 v[152:153], v[228:229], v[212:213], v[20:21] op_sel_hi:[1,0,1]
    v_pk_fma_f32 v[154:155], v[230:231], v[212:213], v[22:23] op_sel_hi:[1,0,1]
    v_pk_fma_f32 v[156:157], v[232:233], v[212:213], v[36:37] op_sel_hi:[1,0,1]
    v_pk_fma_f32 v[158:159], v[234:235], v[212:213], v[38:39] op_sel_hi:[1,0,1]
    v_pk_mul_f32 v[160:161], v[152:153], v[214:215] op_sel_hi:[1,0]
    v_pk_mul_f32 v[162:163], v[154:155], v[214:215] op_sel_hi:[1,0]
    v_pk_mul_f32 v[164:165], v[156:157], v[214:215] op_sel_hi:[1,0]
    v_pk_mul_f32 v[166:167], v[158:159], v[214:215] op_sel_hi:[1,0]
    v_exp_f32_e64 v160, v160 clamp
    v_max_f32 v152, v225, v152
    v_exp_f32_e64 v161, v161 clamp
    v_max_f32 v153, v225, v153
    v_exp_f32_e64 v162, v162 clamp
    v_max_f32 v154, v225, v154
    v_exp_f32_e64 v163, v163 clamp
    v_max_f32 v155, v225, v155
    v_exp_f32_e64 v164, v164 clamp
    v_max_f32 v156, v225, v156
    v_exp_f32_e64 v165, v165 clamp
    v_max_f32 v157, v225, v157
    v_exp_f32_e64 v166, v166 clamp
    v_max_f32 v158, v225, v158
    v_exp_f32_e64 v167, v167 clamp
    v_max_f32 v159, v225, v159
    v_pk_fma_f32 v[152:153], v[152:153], v[212:213], v[160:161] op_sel:[0,1,0]
    v_pk_fma_f32 v[154:155], v[154:155], v[212:213], v[162:163] op_sel:[0,1,0]
    buffer_load_dwordx4 a[108:111], v254, s[36:39], s12 offen offset:2048 sc1
    v_pk_fma_f32 v[156:157], v[156:157], v[212:213], v[164:165] op_sel:[0,1,0]
    v_pk_fma_f32 v[158:159], v[158:159], v[212:213], v[166:167] op_sel:[0,1,0]
    v_cvt_pk_bf16_f32 v144, v152, v153
    v_cvt_pk_bf16_f32 v145, v154, v155
    v_cvt_pk_bf16_f32 v146, v156, v157
    v_cvt_pk_bf16_f32 v147, v158, v159
    ds_write_b64 v4, v[144:145] offset:3200
    ds_write_b64 v5, v[146:147] offset:3200
    v_pk_fma_f32 v[128:129], v[240:241], v[212:213], v[68:69] op_sel_hi:[1,0,1]
    v_pk_fma_f32 v[130:131], v[242:243], v[212:213], v[70:71] op_sel_hi:[1,0,1]
    v_pk_fma_f32 v[132:133], v[244:245], v[212:213], v[84:85] op_sel_hi:[1,0,1]
    v_pk_fma_f32 v[134:135], v[246:247], v[212:213], v[86:87] op_sel_hi:[1,0,1]
    v_pk_mul_f32 v[128:129], v[128:129], v[212:213] op_sel:[0,1]
    v_pk_mul_f32 v[130:131], v[130:131], v[212:213] op_sel:[0,1]
    v_pk_mul_f32 v[132:133], v[132:133], v[212:213] op_sel:[0,1]
    v_pk_mul_f32 v[134:135], v[134:135], v[212:213] op_sel:[0,1]
    v_cvt_pk_bf16_f32 v148, v128, v129
    v_cvt_pk_bf16_f32 v149, v130, v131
    v_cvt_pk_bf16_f32 v150, v132, v133
    v_cvt_pk_bf16_f32 v151, v134, v135
    buffer_load_dwordx4 a[112:115], v254, s[36:39], s12 offen offset:3072 sc1
    s_add_u32 s12, s12, 4096
    ds_write_b64 v7, v[148:149] offset:3200
    ds_write_b64 v8, v[150:151] offset:3200
    v_pk_fma_f32 v[152:153], v[228:229], v[216:217], v[24:25] op_sel_hi:[1,0,1]
    v_pk_fma_f32 v[154:155], v[230:231], v[216:217], v[26:27] op_sel_hi:[1,0,1]
    v_pk_fma_f32 v[156:157], v[232:233], v[216:217], v[40:41] op_sel_hi:[1,0,1]
    v_pk_fma_f32 v[158:159], v[234:235], v[216:217], v[42:43] op_sel_hi:[1,0,1]
    v_pk_mul_f32 v[160:161], v[152:153], v[218:219] op_sel_hi:[1,0]
    v_pk_mul_f32 v[162:163], v[154:155], v[218:219] op_sel_hi:[1,0]
    v_pk_mul_f32 v[164:165], v[156:157], v[218:219] op_sel_hi:[1,0]
    v_pk_mul_f32 v[166:167], v[158:159], v[218:219] op_sel_hi:[1,0]
    v_exp_f32_e64 v160, v160 clamp
    v_max_f32 v152, v226, v152
    v_exp_f32_e64 v161, v161 clamp
    v_max_f32 v153, v226, v153
    v_exp_f32_e64 v162, v162 clamp
    v_max_f32 v154, v226, v154
    v_exp_f32_e64 v163, v163 clamp
    v_max_f32 v155, v226, v155
    v_exp_f32_e64 v164, v164 clamp
    v_max_f32 v156, v226, v156
    buffer_load_dwordx4 a[116:119], v254, s[36:39], s12 offen offset:0 sc1
    s_add_u32 s12, s12, 36864
    v_exp_f32_e64 v165, v165 clamp
    v_max_f32 v157, v226, v157
    v_exp_f32_e64 v166, v166 clamp
    v_max_f32 v158, v226, v158
    v_exp_f32_e64 v167, v167 clamp
    v_max_f32 v159, v226, v159
    v_pk_fma_f32 v[152:153], v[152:153], v[216:217], v[160:161] op_sel:[0,1,0]
    v_pk_fma_f32 v[154:155], v[154:155], v[216:217], v[162:163] op_sel:[0,1,0]
    v_pk_fma_f32 v[156:157], v[156:157], v[216:217], v[164:165] op_sel:[0,1,0]
    v_pk_fma_f32 v[158:159], v[158:159], v[216:217], v[166:167] op_sel:[0,1,0]
    v_cvt_pk_bf16_f32 v144, v152, v153
    v_cvt_pk_bf16_f32 v145, v154, v155
    v_cvt_pk_bf16_f32 v146, v156, v157
    v_cvt_pk_bf16_f32 v147, v158, v159
    ds_write_b64 v4, v[144:145] offset:6400
    ds_write_b64 v5, v[146:147] offset:6400
    v_pk_fma_f32 v[128:129], v[240:241], v[216:217], v[72:73] op_sel_hi:[1,0,1]
    v_pk_fma_f32 v[130:131], v[242:243], v[216:217], v[74:75] op_sel_hi:[1,0,1]
    v_pk_fma_f32 v[132:133], v[244:245], v[216:217], v[88:89] op_sel_hi:[1,0,1]
    v_pk_fma_f32 v[134:135], v[246:247], v[216:217], v[90:91] op_sel_hi:[1,0,1]
    v_pk_mul_f32 v[128:129], v[128:129], v[216:217] op_sel:[0,1]
    v_pk_mul_f32 v[130:131], v[130:131], v[216:217] op_sel:[0,1]
    v_pk_mul_f32 v[132:133], v[132:133], v[216:217] op_sel:[0,1]
    v_pk_mul_f32 v[134:135], v[134:135], v[216:217] op_sel:[0,1]
    v_cvt_pk_bf16_f32 v148, v128, v129
    v_cvt_pk_bf16_f32 v149, v130, v131
    v_cvt_pk_bf16_f32 v150, v132, v133
    v_cvt_pk_bf16_f32 v151, v134, v135
    ds_write_b64 v7, v[148:149] offset:6400
    buffer_load_dwordx4 a[120:123], v254, s[36:39], s12 offen offset:0 sc1
    ds_write_b64 v8, v[150:151] offset:6400
    v_pk_fma_f32 v[152:153], v[228:229], v[220:221], v[28:29] op_sel_hi:[1,0,1]
    v_pk_fma_f32 v[154:155], v[230:231], v[220:221], v[30:31] op_sel_hi:[1,0,1]
    v_pk_fma_f32 v[156:157], v[232:233], v[220:221], v[44:45] op_sel_hi:[1,0,1]
    v_pk_fma_f32 v[158:159], v[234:235], v[220:221], v[46:47] op_sel_hi:[1,0,1]
    v_pk_mul_f32 v[160:161], v[152:153], v[222:223] op_sel_hi:[1,0]
    v_pk_mul_f32 v[162:163], v[154:155], v[222:223] op_sel_hi:[1,0]
    v_pk_mul_f32 v[164:165], v[156:157], v[222:223] op_sel_hi:[1,0]
    v_pk_mul_f32 v[166:167], v[158:159], v[222:223] op_sel_hi:[1,0]
    v_exp_f32_e64 v160, v160 clamp
    v_max_f32 v152, v227, v152
    v_exp_f32_e64 v161, v161 clamp
    v_max_f32 v153, v227, v153
    v_exp_f32_e64 v162, v162 clamp
    v_max_f32 v154, v227, v154
    v_exp_f32_e64 v163, v163 clamp
    v_max_f32 v155, v227, v155
    v_exp_f32_e64 v164, v164 clamp
    v_max_f32 v156, v227, v156
    v_exp_f32_e64 v165, v165 clamp
    buffer_load_dwordx4 a[124:127], v254, s[36:39], s12 offen offset:1024 sc1
    v_max_f32 v157, v227, v157
    v_exp_f32_e64 v166, v166 clamp
    v_max_f32 v158, v227, v158
    v_exp_f32_e64 v167, v167 clamp
    v_max_f32 v159, v227, v159
    v_pk_fma_f32 v[152:153], v[152:153], v[220:221], v[160:161] op_sel:[0,1,0]
    v_pk_fma_f32 v[154:155], v[154:155], v[220:221], v[162:163] op_sel:[0,1,0]
    v_pk_fma_f32 v[156:157], v[156:157], v[220:221], v[164:165] op_sel:[0,1,0]
    v_pk_fma_f32 v[158:159], v[158:159], v[220:221], v[166:167] op_sel:[0,1,0]
    v_cvt_pk_bf16_f32 v144, v152, v153
    v_cvt_pk_bf16_f32 v145, v154, v155
    v_cvt_pk_bf16_f32 v146, v156, v157
    v_cvt_pk_bf16_f32 v147, v158, v159
    ds_write_b64 v4, v[144:145] offset:9600
    ds_write_b64 v5, v[146:147] offset:9600
    v_pk_fma_f32 v[128:129], v[240:241], v[220:221], v[76:77] op_sel_hi:[1,0,1]
    v_pk_fma_f32 v[130:131], v[242:243], v[220:221], v[78:79] op_sel_hi:[1,0,1]
    v_pk_fma_f32 v[132:133], v[244:245], v[220:221], v[92:93] op_sel_hi:[1,0,1]
    v_pk_fma_f32 v[134:135], v[246:247], v[220:221], v[94:95] op_sel_hi:[1,0,1]
    v_pk_mul_f32 v[128:129], v[128:129], v[220:221] op_sel:[0,1]
    buffer_load_dwordx4 a[128:131], v254, s[36:39], s12 offen offset:2048 sc1
    v_pk_mul_f32 v[130:131], v[130:131], v[220:221] op_sel:[0,1]
    v_pk_mul_f32 v[132:133], v[132:133], v[220:221] op_sel:[0,1]
    v_pk_mul_f32 v[134:135], v[134:135], v[220:221] op_sel:[0,1]
    v_cvt_pk_bf16_f32 v148, v128, v129
    v_cvt_pk_bf16_f32 v149, v130, v131
    v_cvt_pk_bf16_f32 v150, v132, v133
    v_cvt_pk_bf16_f32 v151, v134, v135
    ds_write_b64 v7, v[148:149] offset:9600
    ds_write_b64 v8, v[150:151] offset:9600
    v_pk_fma_f32 v[152:153], v[236:237], v[208:209], v[48:49] op_sel_hi:[1,0,1]
    v_pk_fma_f32 v[154:155], v[238:239], v[208:209], v[50:51] op_sel_hi:[1,0,1]
    v_pk_fma_f32 v[156:157], v[236:237], v[212:213], v[52:53] op_sel_hi:[1,0,1]
    v_pk_fma_f32 v[158:159], v[238:239], v[212:213], v[54:55] op_sel_hi:[1,0,1]
    v_pk_fma_f32 v[160:161], v[152:153], v[180:181], v[180:181] op_sel:[0,0,1] op_sel_hi:[1,0,1]
    v_pk_fma_f32 v[162:163], v[154:155], v[180:181], v[180:181] op_sel:[0,0,1] op_sel_hi:[1,0,1]
    v_pk_fma_f32 v[164:165], v[156:157], v[182:183], v[182:183] op_sel:[0,0,1] op_sel_hi:[1,0,1]
    v_pk_fma_f32 v[166:167], v[158:159], v[182:183], v[182:183] op_sel:[0,0,1] op_sel_hi:[1,0,1]
    v_exp_f32_e64 v160, v160 clamp
    v_max_f32 v152, v9, v152
    v_exp_f32_e64 v161, v161 clamp
    v_max_f32 v153, v9, v153
    v_exp_f32_e64 v162, v162 clamp
    v_max_f32 v154, v9, v154
    v_exp_f32_e64 v163, v163 clamp
    v_max_f32 v155, v9, v155
    v_exp_f32_e64 v164, v164 clamp
    v_max_f32 v156, v10, v156
    v_exp_f32_e64 v165, v165 clamp
    buffer_load_dwordx4 a[132:135], v254, s[36:39], s12 offen offset:3072 sc1
    s_add_u32 s12, s12, 4096
    v_max_f32 v157, v10, v157
    v_exp_f32_e64 v166, v166 clamp
    v_max_f32 v158, v10, v158
    v_exp_f32_e64 v167, v167 clamp
    v_max_f32 v159, v10, v159
    v_pk_fma_f32 v[152:153], v[152:153], v[208:209], v[160:161] op_sel:[0,1,0]
    v_pk_fma_f32 v[154:155], v[154:155], v[208:209], v[162:163] op_sel:[0,1,0]
    v_pk_fma_f32 v[156:157], v[156:157], v[212:213], v[164:165] op_sel:[0,1,0]
    v_pk_fma_f32 v[158:159], v[158:159], v[212:213], v[166:167] op_sel:[0,1,0]
    v_cvt_pk_bf16_f32 v144, v152, v153
    v_cvt_pk_bf16_f32 v145, v154, v155
    v_cvt_pk_bf16_f32 v146, v156, v157
    v_cvt_pk_bf16_f32 v147, v158, v159
    ds_write_b64 v6, v[144:145] offset:0
    ds_write_b64 v6, v[146:147] offset:3200
    v_pk_fma_f32 v[128:129], v[236:237], v[216:217], v[56:57] op_sel_hi:[1,0,1]
    v_pk_fma_f32 v[130:131], v[238:239], v[216:217], v[58:59] op_sel_hi:[1,0,1]
    v_pk_fma_f32 v[132:133], v[236:237], v[220:221], v[60:61] op_sel_hi:[1,0,1]
    v_pk_fma_f32 v[134:135], v[238:239], v[220:221], v[62:63] op_sel_hi:[1,0,1]
    v_pk_fma_f32 v[136:137], v[128:129], v[184:185], v[184:185] op_sel:[0,0,1] op_sel_hi:[1,0,1]
    buffer_load_dwordx4 a[136:139], v254, s[36:39], s12 offen offset:0 sc1
    s_add_u32 s12, s12, 36864
    v_pk_fma_f32 v[138:139], v[130:131], v[184:185], v[184:185] op_sel:[0,0,1] op_sel_hi:[1,0,1]
    v_pk_fma_f32 v[140:141], v[132:133], v[186:187], v[186:187] op_sel:[0,0,1] op_sel_hi:[1,0,1]
    v_pk_fma_f32 v[142:143], v[134:135], v[186:187], v[186:187] op_sel:[0,0,1] op_sel_hi:[1,0,1]
    v_exp_f32_e64 v136, v136 clamp
    v_max_f32 v128, v11, v128
    v_exp_f32_e64 v137, v137 clamp
    v_max_f32 v129, v11, v129
    v_exp_f32_e64 v138, v138 clamp
    v_max_f32 v130, v11, v130
    v_exp_f32_e64 v139, v139 clamp
    v_max_f32 v131, v11, v131
    v_exp_f32_e64 v140, v140 clamp
    v_max_f32 v132, v12, v132
    v_exp_f32_e64 v141, v141 clamp
    v_max_f32 v133, v12, v133
    v_exp_f32_e64 v142, v142 clamp
    v_max_f32 v134, v12, v134
    v_exp_f32_e64 v143, v143 clamp
    v_max_f32 v135, v12, v135
    v_pk_fma_f32 v[128:129], v[128:129], v[216:217], v[136:137] op_sel:[0,1,0]
    buffer_load_dwordx4 a[140:143], v254, s[36:39], s12 offen offset:0 sc1
    v_pk_fma_f32 v[130:131], v[130:131], v[216:217], v[138:139] op_sel:[0,1,0]
    v_pk_fma_f32 v[132:133], v[132:133], v[220:221], v[140:141] op_sel:[0,1,0]
    v_pk_fma_f32 v[134:135], v[134:135], v[220:221], v[142:143] op_sel:[0,1,0]
    v_cvt_pk_bf16_f32 v148, v128, v129
    v_cvt_pk_bf16_f32 v149, v130, v131
    v_cvt_pk_bf16_f32 v150, v132, v133
    v_cvt_pk_bf16_f32 v151, v134, v135
    ds_write_b64 v6, v[148:149] offset:6400
    ds_write_b64 v6, v[150:151] offset:9600
    v_pk_fma_f32 v[152:153], v[188:189], v[208:209], v[96:97] op_sel_hi:[1,0,1]
    v_pk_fma_f32 v[154:155], v[190:191], v[208:209], v[98:99] op_sel_hi:[1,0,1]
    v_pk_fma_f32 v[156:157], v[192:193], v[208:209], v[112:113] op_sel_hi:[1,0,1]
    v_pk_fma_f32 v[158:159], v[194:195], v[208:209], v[114:115] op_sel_hi:[1,0,1]
    v_pk_mul_f32 v[160:161], v[152:153], v[210:211] op_sel_hi:[1,0] neg_lo:[0,1] neg_hi:[0,1]
    v_pk_mul_f32 v[162:163], v[154:155], v[210:211] op_sel_hi:[1,0] neg_lo:[0,1] neg_hi:[0,1]
    v_pk_mul_f32 v[164:165], v[156:157], v[210:211] op_sel_hi:[1,0] neg_lo:[0,1] neg_hi:[0,1]
    v_pk_mul_f32 v[166:167], v[158:159], v[210:211] op_sel_hi:[1,0] neg_lo:[0,1] neg_hi:[0,1]
    s_waitcnt lgkmcnt(0)
    s_barrier
    ds_read_b64_tr_b16 v[16:17], v196 offset:25600
    ds_read_b64_tr_b16 v[18:19], v196 offset:25800
    ds_read_b64_tr_b16 v[20:21], v196 offset:0
    ds_read_b64_tr_b16 v[22:23], v196 offset:200
    ds_read_b64_tr_b16 v[24:25], v196 offset:26400
    ds_read_b64_tr_b16 v[26:27], v196 offset:26600
    ds_read_b64_tr_b16 v[28:29], v196 offset:800
    ds_read_b64_tr_b16 v[30:31], v196 offset:1000
    ds_read_b64_tr_b16 v[32:33], v196 offset:32000
    ds_read_b64_tr_b16 v[34:35], v196 offset:32200
    ds_read_b64_tr_b16 v[36:37], v196 offset:6400
    ds_read_b64_tr_b16 v[38:39], v196 offset:6600
    s_waitcnt lgkmcnt(8)
    v_mfma_f32_32x32x16_bf16 v[80:95], v[20:23], v[16:19], 0
    ds_read_b64_tr_b16 v[40:41], v196 offset:32800
    ds_read_b64_tr_b16 v[42:43], v196 offset:33000
    ds_read_b64_tr_b16 v[44:45], v196 offset:7200
    ds_read_b64_tr_b16 v[46:47], v196 offset:7400
    s_waitcnt lgkmcnt(8)
    v_mfma_f32_32x32x16_bf16 v[80:95], v[28:31], v[24:27], v[80:95]
    ds_read_b64_tr_b16 v[48:49], v196 offset:38400
    ds_read_b64_tr_b16 v[50:51], v196 offset:38600
    ds_read_b64_tr_b16 v[52:53], v196 offset:12800
    ds_read_b64_tr_b16 v[54:55], v196 offset:13000
    s_waitcnt lgkmcnt(8)
    v_mfma_f32_32x32x16_bf16 v[80:95], v[36:39], v[32:35], v[80:95]
    ds_read_b64_tr_b16 v[56:57], v196 offset:39200
    ds_read_b64_tr_b16 v[58:59], v196 offset:39400
    ds_read_b64_tr_b16 v[60:61], v196 offset:13600
    ds_read_b64_tr_b16 v[62:63], v196 offset:13800
    s_waitcnt lgkmcnt(8)
    v_mfma_f32_32x32x16_bf16 v[80:95], v[44:47], v[40:43], v[80:95]
    ds_read_b64_tr_b16 v[64:65], v196 offset:44800
    ds_read_b64_tr_b16 v[66:67], v196 offset:45000
    ds_read_b64_tr_b16 v[68:69], v196 offset:19200
    ds_read_b64_tr_b16 v[70:71], v196 offset:19400
    s_waitcnt lgkmcnt(8)
    v_mfma_f32_32x32x16_bf16 v[80:95], v[52:55], v[48:51], v[80:95]
    ds_read_b64_tr_b16 v[72:73], v196 offset:45600
    ds_read_b64_tr_b16 v[74:75], v196 offset:45800
    ds_read_b64_tr_b16 v[76:77], v196 offset:20000
    ds_read_b64_tr_b16 v[78:79], v196 offset:20200
    s_waitcnt lgkmcnt(8)
    v_mfma_f32_32x32x16_bf16 v[80:95], v[60:63], v[56:59], v[80:95]
    s_waitcnt lgkmcnt(4)
    v_mfma_f32_32x32x16_bf16 v[80:95], v[68:71], v[64:67], v[80:95]
    s_waitcnt lgkmcnt(0)
    v_mfma_f32_32x32x16_bf16 v[80:95], v[76:79], v[72:75], v[80:95]
    v_exp_f32 v160, v160
    v_exp_f32 v161, v161
    v_exp_f32 v162, v162
    v_exp_f32 v163, v163
    v_exp_f32 v164, v164
    v_exp_f32 v165, v165
    v_exp_f32 v166, v166
    v_exp_f32 v167, v167
    s_nop 3
    ds_write_b128 v197, v[80:83] offset:0
    ds_write_b128 v197, v[84:87] offset:32
    ds_write_b128 v198, v[88:91] offset:64
    v_pk_fma_f32 v[160:161], v[160:161], v[210:211], v[210:211] op_sel:[0,1,1]
    v_pk_fma_f32 v[162:163], v[162:163], v[210:211], v[210:211] op_sel:[0,1,1]
    v_pk_fma_f32 v[164:165], v[164:165], v[210:211], v[210:211] op_sel:[0,1,1]
    v_pk_fma_f32 v[166:167], v[166:167], v[210:211], v[210:211] op_sel:[0,1,1]
    v_rcp_f32 v160, v160
    v_rcp_f32 v161, v161
    s_waitcnt lgkmcnt(0)
    ds_read_b32 v16, v199 offset:0
    ds_read_b32 v17, v199 offset:256
    ds_read_b32 v18, v199 offset:512
    ds_read_b32 v19, v199 offset:768
    ds_read_b32 v20, v199 offset:1024
    ds_read_b32 v21, v199 offset:1280
    ds_read_b32 v22, v199 offset:1536
    v_rcp_f32 v162, v162
    v_rcp_f32 v163, v163
    v_rcp_f32 v164, v164
    v_rcp_f32 v165, v165
    v_rcp_f32 v166, v166
    v_rcp_f32 v167, v167
    v_pk_mul_f32 v[152:153], v[152:153], v[160:161]
    v_pk_mul_f32 v[154:155], v[154:155], v[162:163]
    s_waitcnt lgkmcnt(0)
    buffer_atomic_add_f32 v16, v201, s[36:39], s22 offen offset:0
    buffer_atomic_add_f32 v17, v201, s[36:39], s22 offen offset:256
    buffer_atomic_add_f32 v18, v201, s[36:39], s22 offen offset:512
    buffer_atomic_add_f32 v19, v201, s[36:39], s22 offen offset:768
    buffer_atomic_add_f32 v20, v201, s[36:39], s22 offen offset:1024
    buffer_atomic_add_f32 v21, v201, s[36:39], s22 offen offset:1280
    buffer_atomic_add_f32 v22, v200, s[36:39], s22 offen offset:1536
    v_pk_mul_f32 v[156:157], v[156:157], v[164:165]
    v_pk_mul_f32 v[158:159], v[158:159], v[166:167]
    v_cvt_pk_bf16_f32 v144, v152, v153
    v_cvt_pk_bf16_f32 v145, v154, v155
    v_cvt_pk_bf16_f32 v146, v156, v157
    v_cvt_pk_bf16_f32 v147, v158, v159
    buffer_store_dwordx4 v[144:147], v254, s[36:39], s16 offen offset:0 sc1
    s_add_u32 s16, s16, 49152
    v_pk_fma_f32 v[128:129], v[188:189], v[212:213], v[100:101] op_sel_hi:[1,0,1]
    v_pk_fma_f32 v[130:131], v[190:191], v[212:213], v[102:103] op_sel_hi:[1,0,1]
    v_pk_fma_f32 v[132:133], v[192:193], v[212:213], v[116:117] op_sel_hi:[1,0,1]
    v_pk_fma_f32 v[134:135], v[194:195], v[212:213], v[118:119] op_sel_hi:[1,0,1]
    v_pk_mul_f32 v[136:137], v[128:129], v[214:215] op_sel_hi:[1,0] neg_lo:[0,1] neg_hi:[0,1]
    v_pk_mul_f32 v[138:139], v[130:131], v[214:215] op_sel_hi:[1,0] neg_lo:[0,1] neg_hi:[0,1]
    v_pk_mul_f32 v[140:141], v[132:133], v[214:215] op_sel_hi:[1,0] neg_lo:[0,1] neg_hi:[0,1]
    v_pk_mul_f32 v[142:143], v[134:135], v[214:215] op_sel_hi:[1,0] neg_lo:[0,1] neg_hi:[0,1]
    v_exp_f32 v136, v136
    v_exp_f32 v137, v137
    v_exp_f32 v138, v138
    v_exp_f32 v139, v139
    v_exp_f32 v140, v140
    v_exp_f32 v141, v141
    v_exp_f32 v142, v142
    v_exp_f32 v143, v143
    v_pk_fma_f32 v[136:137], v[136:137], v[214:215], v[214:215] op_sel:[0,1,1]
    v_pk_fma_f32 v[138:139], v[138:139], v[214:215], v[214:215] op_sel:[0,1,1]
    v_pk_fma_f32 v[140:141], v[140:141], v[214:215], v[214:215] op_sel:[0,1,1]
    v_pk_fma_f32 v[142:143], v[142:143], v[214:215], v[214:215] op_sel:[0,1,1]
    v_rcp_f32 v136, v136
    v_rcp_f32 v137, v137
    v_rcp_f32 v138, v138
    v_rcp_f32 v139, v139
    v_rcp_f32 v140, v140
    v_rcp_f32 v141, v141
    v_rcp_f32 v142, v142
    v_rcp_f32 v143, v143
    v_pk_mul_f32 v[128:129], v[128:129], v[136:137]
    v_pk_mul_f32 v[130:131], v[130:131], v[138:139]
    v_pk_mul_f32 v[132:133], v[132:133], v[140:141]
    v_pk_mul_f32 v[134:135], v[134:135], v[142:143]
    v_cvt_pk_bf16_f32 v148, v128, v129
    v_cvt_pk_bf16_f32 v149, v130, v131
    v_cvt_pk_bf16_f32 v150, v132, v133
    v_cvt_pk_bf16_f32 v151, v134, v135
    buffer_store_dwordx4 v[148:151], v254, s[36:39], s16 offen offset:0 sc1
    s_add_u32 s16, s16, 49152
    v_pk_fma_f32 v[152:153], v[188:189], v[216:217], v[104:105] op_sel_hi:[1,0,1]
    v_pk_fma_f32 v[154:155], v[190:191], v[216:217], v[106:107] op_sel_hi:[1,0,1]
    v_pk_fma_f32 v[156:157], v[192:193], v[216:217], v[120:121] op_sel_hi:[1,0,1]
    v_pk_fma_f32 v[158:159], v[194:195], v[216:217], v[122:123] op_sel_hi:[1,0,1]
    v_pk_mul_f32 v[160:161], v[152:153], v[218:219] op_sel_hi:[1,0] neg_lo:[0,1] neg_hi:[0,1]
    v_pk_mul_f32 v[162:163], v[154:155], v[218:219] op_sel_hi:[1,0] neg_lo:[0,1] neg_hi:[0,1]
    v_pk_mul_f32 v[164:165], v[156:157], v[218:219] op_sel_hi:[1,0] neg_lo:[0,1] neg_hi:[0,1]
    v_pk_mul_f32 v[166:167], v[158:159], v[218:219] op_sel_hi:[1,0] neg_lo:[0,1] neg_hi:[0,1]
    v_exp_f32 v160, v160
    v_exp_f32 v161, v161
    v_exp_f32 v162, v162
    v_exp_f32 v163, v163
    v_exp_f32 v164, v164
    v_exp_f32 v165, v165
    v_exp_f32 v166, v166
    v_exp_f32 v167, v167
    v_pk_fma_f32 v[160:161], v[160:161], v[218:219], v[218:219] op_sel:[0,1,1]
    v_pk_fma_f32 v[162:163], v[162:163], v[218:219], v[218:219] op_sel:[0,1,1]
    v_pk_fma_f32 v[164:165], v[164:165], v[218:219], v[218:219] op_sel:[0,1,1]
    v_pk_fma_f32 v[166:167], v[166:167], v[218:219], v[218:219] op_sel:[0,1,1]
    v_rcp_f32 v160, v160
    v_rcp_f32 v161, v161
    v_rcp_f32 v162, v162
    v_rcp_f32 v163, v163
    v_rcp_f32 v164, v164
    v_rcp_f32 v165, v165
    v_rcp_f32 v166, v166
    v_rcp_f32 v167, v167
    v_pk_mul_f32 v[152:153], v[152:153], v[160:161]
    v_pk_mul_f32 v[154:155], v[154:155], v[162:163]
    v_pk_mul_f32 v[156:157], v[156:157], v[164:165]
    v_pk_mul_f32 v[158:159], v[158:159], v[166:167]
    v_cvt_pk_bf16_f32 v144, v152, v153
    v_cvt_pk_bf16_f32 v145, v154, v155
    v_cvt_pk_bf16_f32 v146, v156, v157
    v_cvt_pk_bf16_f32 v147, v158, v159
    buffer_store_dwordx4 v[144:147], v254, s[36:39], s16 offen offset:0 sc1
    s_add_u32 s16, s16, 49152
    v_pk_fma_f32 v[128:129], v[188:189], v[220:221], v[108:109] op_sel_hi:[1,0,1]
    v_pk_fma_f32 v[130:131], v[190:191], v[220:221], v[110:111] op_sel_hi:[1,0,1]
    v_pk_fma_f32 v[132:133], v[192:193], v[220:221], v[124:125] op_sel_hi:[1,0,1]
    v_pk_fma_f32 v[134:135], v[194:195], v[220:221], v[126:127] op_sel_hi:[1,0,1]
    v_pk_mul_f32 v[136:137], v[128:129], v[222:223] op_sel_hi:[1,0] neg_lo:[0,1] neg_hi:[0,1]
    v_pk_mul_f32 v[138:139], v[130:131], v[222:223] op_sel_hi:[1,0] neg_lo:[0,1] neg_hi:[0,1]
    v_pk_mul_f32 v[140:141], v[132:133], v[222:223] op_sel_hi:[1,0] neg_lo:[0,1] neg_hi:[0,1]
    v_pk_mul_f32 v[142:143], v[134:135], v[222:223] op_sel_hi:[1,0] neg_lo:[0,1] neg_hi:[0,1]
    v_exp_f32 v136, v136
    v_exp_f32 v137, v137
    v_exp_f32 v138, v138
    v_exp_f32 v139, v139
    v_exp_f32 v140, v140
    v_exp_f32 v141, v141
    v_exp_f32 v142, v142
    v_exp_f32 v143, v143
    v_pk_fma_f32 v[136:137], v[136:137], v[222:223], v[222:223] op_sel:[0,1,1]
    v_pk_fma_f32 v[138:139], v[138:139], v[222:223], v[222:223] op_sel:[0,1,1]
    v_pk_fma_f32 v[140:141], v[140:141], v[222:223], v[222:223] op_sel:[0,1,1]
    v_pk_fma_f32 v[142:143], v[142:143], v[222:223], v[222:223] op_sel:[0,1,1]
    v_rcp_f32 v136, v136
    v_rcp_f32 v137, v137
    v_rcp_f32 v138, v138
    v_rcp_f32 v139, v139
    v_rcp_f32 v140, v140
    v_rcp_f32 v141, v141
    v_rcp_f32 v142, v142
    v_rcp_f32 v143, v143
    v_pk_mul_f32 v[128:129], v[128:129], v[136:137]
    v_pk_mul_f32 v[130:131], v[130:131], v[138:139]
    v_pk_mul_f32 v[132:133], v[132:133], v[140:141]
    v_pk_mul_f32 v[134:135], v[134:135], v[142:143]
    v_cvt_pk_bf16_f32 v148, v128, v129
    v_cvt_pk_bf16_f32 v149, v130, v131
    v_cvt_pk_bf16_f32 v150, v132, v133
    v_cvt_pk_bf16_f32 v151, v134, v135
    buffer_store_dwordx4 v[148:151], v254, s[36:39], s16 offen offset:0 sc1
    s_add_u32 s16, s16, 49152
    s_lshl_b32 s66, s51, 3
    s_add_u32 s66, s66, s52
    s_mul_i32 s66, s66, 256
    s_add_u32 s66, s66, 12947456
    s_lshl_b32 s67, s52, 4
    s_add_u32 s67, s67, s51
    s_mul_i32 s67, s67, 128
    s_add_u32 s67, s67, 13144064
    v_mul_u32_u24 v12, 128, v1
    v_mov_b32 v13, 1073741824
    v_cmp_gt_u32 vcc, 16, v1
    s_lshl_b32 s68, s17, 2
    s_nop 0
    v_cndmask_b32 v253, v13, v12, vcc
    v_cmp_gt_u32 vcc, 4, v1
    s_xor_b32 s69, s48, 0
    s_add_u32 s69, s69, s68
    s_mul_i32 s4, s69, 49152
    s_mul_i32 s8, s69, 20480
    s_xor_b32 s69, s48, 1
    s_add_u32 s69, s69, s68
    s_mul_i32 s5, s69, 49152
    s_mul_i32 s9, s69, 20480
    s_xor_b32 s69, s48, 2
    s_add_u32 s69, s69, s68
    s_mul_i32 s6, s69, 49152
    s_mul_i32 s10, s69, 20480
    s_xor_b32 s69, s48, 3
    s_add_u32 s69, s69, s68
    s_mul_i32 s7, s69, 49152
    s_mul_i32 s11, s69, 20480
    v_cndmask_b32 v255, v13, v12, vcc
    s_mul_i32 s69, s48, 12288
    s_mul_i32 s68, s48, 5120
    s_add_u32 s68, s68, 6815744
    s_add_u32 s4, s4, s69
    s_add_u32 s8, s8, s68
    s_add_u32 s5, s5, s69
    s_add_u32 s9, s9, s68
    s_add_u32 s6, s6, s69
    s_add_u32 s10, s10, s68
    s_add_u32 s7, s7, s69
    s_add_u32 s11, s11, s68
    s_lshr_b32 s68, s17, 1
    s_lshl_b32 s68, s68, 2
    s_add_u32 s68, s68, s48
    s_mul_i32 s68, s68, 512
    s_add_u32 s14, s68, 12947456
    s_lshr_b32 s68, s68, 1
    s_add_u32 s15, s68, 13209600
    v_cmp_gt_u32 vcc, 2, v1
    s_nop 1
    v_cndmask_b32 v250, v13, v12, vcc
    v_add_u32 v248, 4096, v254
    s_waitcnt vmcnt(4)
    s_barrier
    buffer_store_dword v251, v252, s[36:39], s67 offen sc1
    s_waitcnt vmcnt(1)
    s_barrier
    buffer_store_dword v251, v252, s[36:39], s66 offen sc1
    buffer_load_dwordx4 a[144:147], v254, s[36:39], s12 offen offset:1024 sc1
    buffer_load_dwordx4 a[148:151], v254, s[36:39], s12 offen offset:2048 sc1
    buffer_load_dwordx4 a[152:155], v254, s[36:39], s12 offen offset:3072 sc1
    s_add_u32 s12, s12, 4096
    buffer_load_dwordx4 a[156:159], v254, s[36:39], s12 offen offset:0 sc1
    s_add_u32 s12, s12, 36864
    buffer_load_dwordx4 a[160:163], v254, s[36:39], s12 offen offset:0 sc1
    buffer_load_dwordx4 a[164:167], v254, s[36:39], s12 offen offset:1024 sc1
    buffer_load_dwordx4 a[168:171], v254, s[36:39], s12 offen offset:2048 sc1
    buffer_load_dwordx4 a[172:175], v254, s[36:39], s12 offen offset:3072 sc1
    s_add_u32 s12, s12, 4096
    buffer_load_dwordx4 a[176:179], v254, s[36:39], s12 offen offset:0 sc1
    s_add_u32 s12, s12, 36864
    buffer_load_dwordx4 a[180:183], v254, s[36:39], s12 offen offset:0 sc1
    buffer_load_dwordx4 a[184:187], v254, s[36:39], s12 offen offset:1024 sc1
    buffer_load_dwordx4 a[188:191], v254, s[36:39], s12 offen offset:2048 sc1
    buffer_load_dwordx4 a[192:195], v254, s[36:39], s12 offen offset:3072 sc1
    s_add_u32 s12, s12, 4096
    buffer_load_dwordx4 a[196:199], v254, s[36:39], s12 offen offset:0 sc1
    s_add_u32 s12, s12, 36864
    buffer_load_dwordx4 a[200:203], v254, s[36:39], s12 offen offset:0 sc1
    buffer_load_dwordx4 a[204:207], v254, s[36:39], s12 offen offset:1024 sc1
    buffer_load_dwordx4 a[208:211], v254, s[36:39], s12 offen offset:2048 sc1
    buffer_load_dwordx4 a[212:215], v254, s[36:39], s12 offen offset:3072 sc1
    s_add_u32 s12, s12, 4096
    buffer_load_dword v3, v255, s[36:39], s14 offen sc1
    buffer_load_dwordx4 a[216:219], v254, s[36:39], s12 offen offset:0 sc1
    s_add_u32 s12, s12, 36864
    buffer_load_dwordx4 a[220:223], v254, s[36:39], s12 offen offset:0 sc1
    buffer_load_dwordx4 a[224:227], v254, s[36:39], s12 offen offset:1024 sc1
    s_waitcnt vmcnt(3)
    v_cmp_eq_u32 vcc, s54, v3
    s_nop 0
    s_and_b32 s68, vcc_lo, 10
    s_cmp_eq_u32 s68, 10
    s_cbranch_scc1 L_t0_ph_ok
    s_mov_b32 s69, 0
L_t0_ph:
    s_sleep 4
L_t0_ph_go:
    buffer_load_dword v3, v255, s[36:39], s14 offen offset:0 sc1
    s_add_u32 s69, s69, 1
    s_waitcnt vmcnt(0)
    v_cmp_eq_u32 vcc, s54, v3
    s_nop 0
    s_and_b32 s68, vcc_lo, 10
    s_cmp_eq_u32 s68, 10
    s_cbranch_scc1 L_t0_ph_ok
    s_cmp_lt_u32 s69, 262144
    s_cbranch_scc1 L_t0_ph
L_t0_ph_ok:
    s_and_b32 s68, vcc_lo, 5
    s_cmp_eq_u32 s68, 5
    s_cselect_b32 s56, s65, s14
    buffer_load_dwordx4 v[16:19], v254, s[36:39], s4 offen offset:0 sc1
    buffer_load_dwordx4 v[20:23], v254, s[36:39], s5 offen offset:0 sc1
    buffer_load_dwordx4 v[24:27], v254, s[36:39], s6 offen offset:0 sc1
    buffer_load_dwordx4 v[28:31], v254, s[36:39], s7 offen offset:0 sc1
    buffer_load_dwordx4 v[32:35], v254, s[36:39], s4 offen offset:1024 sc1
    buffer_load_dwordx4 v[36:39], v254, s[36:39], s5 offen offset:1024 sc1
    buffer_load_dwordx4 v[40:43], v254, s[36:39], s6 offen offset:1024 sc1
    buffer_load_dwordx4 v[44:47], v254, s[36:39], s7 offen offset:1024 sc1
    buffer_load_dwordx4 v[48:51], v254, s[36:39], s4 offen offset:2048 sc1
    buffer_load_dwordx4 v[52:55], v254, s[36:39], s5 offen offset:2048 sc1
    buffer_load_dwordx4 v[56:59], v254, s[36:39], s6 offen offset:2048 sc1
    buffer_load_dwordx4 v[60:63], v254, s[36:39], s7 offen offset:2048 sc1
    v_permlane16_swap_b32 v170, v172
    v_permlane16_swap_b32 v171, v173
    v_permlane16_swap_b32 v174, v176
    v_permlane16_swap_b32 v175, v177
    v_lshlrev_b32 v128, 16, v170
    v_and_b32 v129, 0xffff0000, v170
    v_lshlrev_b32 v130, 16, v171
    v_and_b32 v131, 0xffff0000, v171
    v_lshlrev_b32 v132, 16, v172
    v_and_b32 v133, 0xffff0000, v172
    v_lshlrev_b32 v134, 16, v173
    v_and_b32 v135, 0xffff0000, v173
    v_lshlrev_b32 v136, 16, v174
    v_and_b32 v137, 0xffff0000, v174
    v_lshlrev_b32 v138, 16, v175
    v_and_b32 v139, 0xffff0000, v175
    v_lshlrev_b32 v140, 16, v176
    v_and_b32 v141, 0xffff0000, v176
    v_lshlrev_b32 v142, 16, v177
    v_and_b32 v143, 0xffff0000, v177
    v_lshlrev_b32 v144, 16, v178
    v_and_b32 v145, 0xffff0000, v178
    v_lshlrev_b32 v146, 16, v179
    v_and_b32 v147, 0xffff0000, v179
    s_waitcnt vmcnt(8)
    v_mfma_f32_16x16x32_bf16 v[128:131], a[0:3], v[16:19], v[128:131]
    buffer_load_dwordx4 v[64:67], v254, s[36:39], s4 offen offset:3072 sc1
    v_mfma_f32_16x16x32_bf16 v[132:135], a[4:7], v[16:19], v[132:135]
    v_mfma_f32_16x16x32_bf16 v[136:139], a[8:11], v[16:19], v[136:139]
    buffer_load_dwordx4 v[68:71], v254, s[36:39], s5 offen offset:3072 sc1
    v_mfma_f32_16x16x32_bf16 v[140:143], a[12:15], v[16:19], v[140:143]
    v_mfma_f32_16x16x32_bf16 v[144:147], a[16:19], v[16:19], v[144:147]
    buffer_load_dwordx4 v[72:75], v254, s[36:39], s6 offen offset:3072 sc1
    v_mfma_f32_16x16x32_bf16 v[148:151], a[0:3], v[20:23], 0
    v_mfma_f32_16x16x32_bf16 v[152:155], a[4:7], v[20:23], 0
    buffer_load_dwordx4 v[76:79], v254, s[36:39], s7 offen offset:3072 sc1
    v_mfma_f32_16x16x32_bf16 v[156:159], a[8:11], v[20:23], 0
    s_add_u32 s4, s4, 4096
    v_mfma_f32_16x16x32_bf16 v[160:163], a[12:15], v[20:23], 0
    s_add_u32 s5, s5, 4096
    s_add_u32 s6, s6, 4096
    s_add_u32 s7, s7, 4096
    buffer_load_dwordx4 a[228:231], v254, s[36:39], s12 offen offset:2048 sc1
    v_mfma_f32_16x16x32_bf16 v[164:167], a[16:19], v[20:23], 0
    v_mfma_f32_16x16x32_bf16 v[168:171], a[0:3], v[24:27], 0
    buffer_load_dwordx4 a[232:235], v254, s[36:39], s12 offen offset:3072 sc1
    v_mfma_f32_16x16x32_bf16 v[172:175], a[4:7], v[24:27], 0
    s_add_u32 s12, s12, 4096
    v_mfma_f32_16x16x32_bf16 v[176:179], a[8:11], v[24:27], 0
    buffer_load_dwordx4 a[236:239], v254, s[36:39], s12 offen offset:0 sc1
    v_mfma_f32_16x16x32_bf16 v[180:183], a[12:15], v[24:27], 0
    s_add_u32 s12, s12, 36864
    v_mfma_f32_16x16x32_bf16 v[184:187], a[16:19], v[24:27], 0
    s_add_u32 m0, s60, 0
    s_nop 0
    buffer_load_dwordx4 v254, s[36:39], s13 offen offset:0 sc1 lds
    v_mfma_f32_16x16x32_bf16 v[188:191], a[0:3], v[28:31], 0
    v_mfma_f32_16x16x32_bf16 v[192:195], a[4:7], v[28:31], 0
    v_mfma_f32_16x16x32_bf16 v[196:199], a[8:11], v[28:31], 0
    v_mfma_f32_16x16x32_bf16 v[200:203], a[12:15], v[28:31], 0
    v_mfma_f32_16x16x32_bf16 v[204:207], a[16:19], v[28:31], 0
    s_waitcnt vmcnt(12)
    v_mfma_f32_16x16x32_bf16 v[128:131], a[20:23], v[32:35], v[128:131]
    buffer_load_dwordx4 v[16:19], v254, s[36:39], s4 offen offset:0 sc1
    v_mfma_f32_16x16x32_bf16 v[132:135], a[24:27], v[32:35], v[132:135]
    v_mfma_f32_16x16x32_bf16 v[136:139], a[28:31], v[32:35], v[136:139]
    buffer_load_dwordx4 v[20:23], v254, s[36:39], s5 offen offset:0 sc1
    v_mfma_f32_16x16x32_bf16 v[140:143], a[32:35], v[32:35], v[140:143]
    v_mfma_f32_16x16x32_bf16 v[144:147], a[36:39], v[32:35], v[144:147]
    buffer_load_dwordx4 v[24:27], v254, s[36:39], s6 offen offset:0 sc1
    v_mfma_f32_16x16x32_bf16 v[148:151], a[20:23], v[36:39], v[148:151]
    v_mfma_f32_16x16x32_bf16 v[152:155], a[24:27], v[36:39], v[152:155]
    buffer_load_dwordx4 v[28:31], v254, s[36:39], s7 offen offset:0 sc1
    v_mfma_f32_16x16x32_bf16 v[156:159], a[28:31], v[36:39], v[156:159]
    v_mfma_f32_16x16x32_bf16 v[160:163], a[32:35], v[36:39], v[160:163]
    buffer_load_dwordx4 v254, s[36:39], s13 offen offset:1024 sc1 lds
    v_mfma_f32_16x16x32_bf16 v[164:167], a[36:39], v[36:39], v[164:167]
    v_mfma_f32_16x16x32_bf16 v[168:171], a[20:23], v[40:43], v[168:171]
    buffer_load_dwordx4 v254, s[36:39], s13 offen offset:2048 sc1 lds
    v_mfma_f32_16x16x32_bf16 v[172:175], a[24:27], v[40:43], v[172:175]
    v_mfma_f32_16x16x32_bf16 v[176:179], a[28:31], v[40:43], v[176:179]
    buffer_load_dwordx4 v254, s[36:39], s13 offen offset:3072 sc1 lds
    v_mfma_f32_16x16x32_bf16 v[180:183], a[32:35], v[40:43], v[180:183]
    s_add_u32 s13, s13, 4096
    v_mfma_f32_16x16x32_bf16 v[184:187], a[36:39], v[40:43], v[184:187]
    v_mfma_f32_16x16x32_bf16 v[188:191], a[20:23], v[44:47], v[188:191]
    v_mfma_f32_16x16x32_bf16 v[192:195], a[24:27], v[44:47], v[192:195]
    v_mfma_f32_16x16x32_bf16 v[196:199], a[28:31], v[44:47], v[196:199]
    v_mfma_f32_16x16x32_bf16 v[200:203], a[32:35], v[44:47], v[200:203]
    v_mfma_f32_16x16x32_bf16 v[204:207], a[36:39], v[44:47], v[204:207]
    s_waitcnt vmcnt(15)
    v_mfma_f32_16x16x32_bf16 v[128:131], a[40:43], v[48:51], v[128:131]
    buffer_load_dwordx4 v[32:35], v254, s[36:39], s4 offen offset:1024 sc1
    v_mfma_f32_16x16x32_bf16 v[132:135], a[44:47], v[48:51], v[132:135]
    v_mfma_f32_16x16x32_bf16 v[136:139], a[48:51], v[48:51], v[136:139]
    buffer_load_dwordx4 v[36:39], v254, s[36:39], s5 offen offset:1024 sc1
    v_mfma_f32_16x16x32_bf16 v[140:143], a[52:55], v[48:51], v[140:143]
    v_mfma_f32_16x16x32_bf16 v[144:147], a[56:59], v[48:51], v[144:147]
    buffer_load_dwordx4 v[40:43], v254, s[36:39], s6 offen offset:1024 sc1
    v_mfma_f32_16x16x32_bf16 v[148:151], a[40:43], v[52:55], v[148:151]
    v_mfma_f32_16x16x32_bf16 v[152:155], a[44:47], v[52:55], v[152:155]
    buffer_load_dwordx4 v[44:47], v254, s[36:39], s7 offen offset:1024 sc1
    v_mfma_f32_16x16x32_bf16 v[156:159], a[48:51], v[52:55], v[156:159]
    s_add_u32 m0, s60, 4096
    v_mfma_f32_16x16x32_bf16 v[160:163], a[52:55], v[52:55], v[160:163]
    buffer_load_dwordx4 v254, s[36:39], s13 offen offset:0 sc1 lds
    v_mfma_f32_16x16x32_bf16 v[164:167], a[56:59], v[52:55], v[164:167]
    s_add_u32 s13, s13, 36864
    v_mfma_f32_16x16x32_bf16 v[168:171], a[40:43], v[56:59], v[168:171]
    s_add_u32 m0, s60, 5120
    s_nop 0
    buffer_load_dwordx4 v254, s[36:39], s13 offen offset:0 sc1 lds
    v_mfma_f32_16x16x32_bf16 v[172:175], a[44:47], v[56:59], v[172:175]
    v_mfma_f32_16x16x32_bf16 v[176:179], a[48:51], v[56:59], v[176:179]
    buffer_load_dwordx4 v254, s[36:39], s13 offen offset:1024 sc1 lds
    v_mfma_f32_16x16x32_bf16 v[180:183], a[52:55], v[56:59], v[180:183]
    v_mfma_f32_16x16x32_bf16 v[184:187], a[56:59], v[56:59], v[184:187]
    v_mfma_f32_16x16x32_bf16 v[188:191], a[40:43], v[60:63], v[188:191]
    v_mfma_f32_16x16x32_bf16 v[192:195], a[44:47], v[60:63], v[192:195]
    v_mfma_f32_16x16x32_bf16 v[196:199], a[48:51], v[60:63], v[196:199]
    v_mfma_f32_16x16x32_bf16 v[200:203], a[52:55], v[60:63], v[200:203]
    v_mfma_f32_16x16x32_bf16 v[204:207], a[56:59], v[60:63], v[204:207]
    s_waitcnt vmcnt(18)
    v_mfma_f32_16x16x32_bf16 v[128:131], a[60:63], v[64:67], v[128:131]
    buffer_load_dword v3, v255, s[36:39], s56 offen sc1
    v_mfma_f32_16x16x32_bf16 v[132:135], a[64:67], v[64:67], v[132:135]
    v_mfma_f32_16x16x32_bf16 v[136:139], a[68:71], v[64:67], v[136:139]
    buffer_load_dwordx4 v[48:51], v254, s[36:39], s4 offen offset:2048 sc1
    v_mfma_f32_16x16x32_bf16 v[140:143], a[72:75], v[64:67], v[140:143]
    v_mfma_f32_16x16x32_bf16 v[144:147], a[76:79], v[64:67], v[144:147]
    buffer_load_dwordx4 v[52:55], v254, s[36:39], s5 offen offset:2048 sc1
    v_mfma_f32_16x16x32_bf16 v[148:151], a[60:63], v[68:71], v[148:151]
    v_mfma_f32_16x16x32_bf16 v[152:155], a[64:67], v[68:71], v[152:155]
    buffer_load_dwordx4 v[56:59], v254, s[36:39], s6 offen offset:2048 sc1
    v_mfma_f32_16x16x32_bf16 v[156:159], a[68:71], v[68:71], v[156:159]
    v_mfma_f32_16x16x32_bf16 v[160:163], a[72:75], v[68:71], v[160:163]
    buffer_load_dwordx4 v[60:63], v254, s[36:39], s7 offen offset:2048 sc1
    v_mfma_f32_16x16x32_bf16 v[164:167], a[76:79], v[68:71], v[164:167]
    v_mfma_f32_16x16x32_bf16 v[168:171], a[60:63], v[72:75], v[168:171]
    buffer_load_dwordx4 v254, s[36:39], s13 offen offset:2048 sc1 lds
    v_mfma_f32_16x16x32_bf16 v[172:175], a[64:67], v[72:75], v[172:175]
    v_mfma_f32_16x16x32_bf16 v[176:179], a[68:71], v[72:75], v[176:179]
    buffer_load_dwordx4 v254, s[36:39], s13 offen offset:3072 sc1 lds
    v_mfma_f32_16x16x32_bf16 v[180:183], a[72:75], v[72:75], v[180:183]
    s_add_u32 s13, s13, 4096
    v_mfma_f32_16x16x32_bf16 v[184:187], a[76:79], v[72:75], v[184:187]
    s_add_u32 m0, s60, 9216
    s_nop 0
    buffer_load_dwordx4 v254, s[36:39], s13 offen offset:0 sc1 lds
    v_mfma_f32_16x16x32_bf16 v[188:191], a[60:63], v[76:79], v[188:191]
    s_add_u32 s13, s13, 36864
    v_mfma_f32_16x16x32_bf16 v[192:195], a[64:67], v[76:79], v[192:195]
    v_mfma_f32_16x16x32_bf16 v[196:199], a[68:71], v[76:79], v[196:199]
    v_mfma_f32_16x16x32_bf16 v[200:203], a[72:75], v[76:79], v[200:203]
    v_mfma_f32_16x16x32_bf16 v[204:207], a[76:79], v[76:79], v[204:207]
    s_waitcnt vmcnt(18)
    v_mfma_f32_16x16x32_bf16 v[128:131], a[80:83], v[16:19], v[128:131]
    buffer_load_dwordx4 v[64:67], v254, s[36:39], s4 offen offset:3072 sc1
    v_mfma_f32_16x16x32_bf16 v[132:135], a[84:87], v[16:19], v[132:135]
    v_mfma_f32_16x16x32_bf16 v[136:139], a[88:91], v[16:19], v[136:139]
    buffer_load_dwordx4 v[68:71], v254, s[36:39], s5 offen offset:3072 sc1
    v_mfma_f32_16x16x32_bf16 v[140:143], a[92:95], v[16:19], v[140:143]
    v_mfma_f32_16x16x32_bf16 v[144:147], a[96:99], v[16:19], v[144:147]
    buffer_load_dwordx4 v[72:75], v254, s[36:39], s6 offen offset:3072 sc1
    v_mfma_f32_16x16x32_bf16 v[148:151], a[80:83], v[20:23], v[148:151]
    v_mfma_f32_16x16x32_bf16 v[152:155], a[84:87], v[20:23], v[152:155]
    buffer_load_dwordx4 v[76:79], v254, s[36:39], s7 offen offset:3072 sc1
    v_mfma_f32_16x16x32_bf16 v[156:159], a[88:91], v[20:23], v[156:159]
    s_add_u32 s4, s4, 4096
    v_mfma_f32_16x16x32_bf16 v[160:163], a[92:95], v[20:23], v[160:163]
    s_add_u32 s5, s5, 4096
    s_add_u32 s6, s6, 4096
    s_add_u32 s7, s7, 4096
    s_add_u32 m0, s60, 10240
    s_nop 0
    buffer_load_dwordx4 v254, s[36:39], s13 offen offset:0 sc1 lds
    v_mfma_f32_16x16x32_bf16 v[164:167], a[96:99], v[20:23], v[164:167]
    v_mfma_f32_16x16x32_bf16 v[168:171], a[80:83], v[24:27], v[168:171]
    buffer_load_dwordx4 v254, s[36:39], s13 offen offset:1024 sc1 lds
    v_mfma_f32_16x16x32_bf16 v[172:175], a[84:87], v[24:27], v[172:175]
    v_mfma_f32_16x16x32_bf16 v[176:179], a[88:91], v[24:27], v[176:179]
    buffer_load_dwordx4 v254, s[36:39], s13 offen offset:2048 sc1 lds
    v_mfma_f32_16x16x32_bf16 v[180:183], a[92:95], v[24:27], v[180:183]
    v_mfma_f32_16x16x32_bf16 v[184:187], a[96:99], v[24:27], v[184:187]
    v_mfma_f32_16x16x32_bf16 v[188:191], a[80:83], v[28:31], v[188:191]
    v_mfma_f32_16x16x32_bf16 v[192:195], a[84:87], v[28:31], v[192:195]
    v_mfma_f32_16x16x32_bf16 v[196:199], a[88:91], v[28:31], v[196:199]
    v_mfma_f32_16x16x32_bf16 v[200:203], a[92:95], v[28:31], v[200:203]
    v_mfma_f32_16x16x32_bf16 v[204:207], a[96:99], v[28:31], v[204:207]
    s_cmp_eq_u32 s56, s65
    s_cbranch_scc1 L_t0_p0_ok
    s_waitcnt vmcnt(14)
    v_cmp_eq_u32 vcc, s54, v3
    s_nop 0
    s_and_b32 s68, vcc_lo, 5
    s_cmp_eq_u32 s68, 5
    s_cbranch_scc1 L_t0_p0_ok
    s_mov_b32 s69, 0
L_t0_p0:
    s_sleep 4
L_t0_p0_go:
    buffer_load_dword v3, v255, s[36:39], s14 offen offset:0 sc1
    s_add_u32 s69, s69, 1
    s_waitcnt vmcnt(0)
    v_cmp_eq_u32 vcc, s54, v3
    s_nop 0
    s_and_b32 s68, vcc_lo, 5
    s_cmp_eq_u32 s68, 5
    s_cbranch_scc1 L_t0_p0_ok
    s_cmp_lt_u32 s69, 262144
    s_cbranch_scc1 L_t0_p0
L_t0_p0_ok:
    s_waitcnt vmcnt(18)
    v_mfma_f32_16x16x32_bf16 v[128:131], a[100:103], v[32:35], v[128:131]
    buffer_load_dwordx4 v[16:19], v254, s[36:39], s4 offen offset:0 sc1
    v_mfma_f32_16x16x32_bf16 v[132:135], a[104:107], v[32:35], v[132:135]
    v_mfma_f32_16x16x32_bf16 v[136:139], a[108:111], v[32:35], v[136:139]
    buffer_load_dwordx4 v[20:23], v254, s[36:39], s5 offen offset:0 sc1
    v_mfma_f32_16x16x32_bf16 v[140:143], a[112:115], v[32:35], v[140:143]
    v_mfma_f32_16x16x32_bf16 v[144:147], a[116:119], v[32:35], v[144:147]
    buffer_load_dwordx4 v[24:27], v254, s[36:39], s6 offen offset:0 sc1
    v_mfma_f32_16x16x32_bf16 v[148:151], a[100:103], v[36:39], v[148:151]
    v_mfma_f32_16x16x32_bf16 v[152:155], a[104:107], v[36:39], v[152:155]
    buffer_load_dwordx4 v[28:31], v254, s[36:39], s7 offen offset:0 sc1
    v_mfma_f32_16x16x32_bf16 v[156:159], a[108:111], v[36:39], v[156:159]
    v_mfma_f32_16x16x32_bf16 v[160:163], a[112:115], v[36:39], v[160:163]
    buffer_load_dwordx4 v254, s[36:39], s13 offen offset:3072 sc1 lds
    v_mfma_f32_16x16x32_bf16 v[164:167], a[116:119], v[36:39], v[164:167]
    s_add_u32 s13, s13, 4096
    v_mfma_f32_16x16x32_bf16 v[168:171], a[100:103], v[40:43], v[168:171]
    s_add_u32 m0, s60, 14336
    s_nop 0
    buffer_load_dwordx4 v254, s[36:39], s13 offen offset:0 sc1 lds
    v_mfma_f32_16x16x32_bf16 v[172:175], a[104:107], v[40:43], v[172:175]
    s_add_u32 s13, s13, 36864
    v_mfma_f32_16x16x32_bf16 v[176:179], a[108:111], v[40:43], v[176:179]
    s_add_u32 m0, s60, 15360
    s_nop 0
    buffer_load_dwordx4 v254, s[36:39], s13 offen offset:0 sc1 lds
    v_mfma_f32_16x16x32_bf16 v[180:183], a[112:115], v[40:43], v[180:183]
    v_mfma_f32_16x16x32_bf16 v[184:187], a[116:119], v[40:43], v[184:187]
    v_mfma_f32_16x16x32_bf16 v[188:191], a[100:103], v[44:47], v[188:191]
    v_mfma_f32_16x16x32_bf16 v[192:195], a[104:107], v[44:47], v[192:195]
    v_mfma_f32_16x16x32_bf16 v[196:199], a[108:111], v[44:47], v[196:199]
    v_mfma_f32_16x16x32_bf16 v[200:203], a[112:115], v[44:47], v[200:203]
    v_mfma_f32_16x16x32_bf16 v[204:207], a[116:119], v[44:47], v[204:207]
    s_waitcnt vmcnt(17)
    v_mfma_f32_16x16x32_bf16 v[128:131], a[120:123], v[48:51], v[128:131]
    buffer_load_dwordx4 v[32:35], v254, s[36:39], s4 offen offset:1024 sc1
    v_mfma_f32_16x16x32_bf16 v[132:135], a[124:127], v[48:51], v[132:135]
    v_mfma_f32_16x16x32_bf16 v[136:139], a[128:131], v[48:51], v[136:139]
    buffer_load_dwordx4 v[36:39], v254, s[36:39], s5 offen offset:1024 sc1
    v_mfma_f32_16x16x32_bf16 v[140:143], a[132:135], v[48:51], v[140:143]
    v_mfma_f32_16x16x32_bf16 v[144:147], a[136:139], v[48:51], v[144:147]
    buffer_load_dwordx4 v[40:43], v254, s[36:39], s6 offen offset:1024 sc1
    v_mfma_f32_16x16x32_bf16 v[148:151], a[120:123], v[52:55], v[148:151]
    v_mfma_f32_16x16x32_bf16 v[152:155], a[124:127], v[52:55], v[152:155]
    buffer_load_dwordx4 v[44:47], v254, s[36:39], s7 offen offset:1024 sc1
    v_mfma_f32_16x16x32_bf16 v[156:159], a[128:131], v[52:55], v[156:159]
    v_mfma_f32_16x16x32_bf16 v[160:163], a[132:135], v[52:55], v[160:163]
    buffer_load_dwordx4 v254, s[36:39], s13 offen offset:1024 sc1 lds
    v_mfma_f32_16x16x32_bf16 v[164:167], a[136:139], v[52:55], v[164:167]
    v_mfma_f32_16x16x32_bf16 v[168:171], a[120:123], v[56:59], v[168:171]
    buffer_load_dwordx4 v254, s[36:39], s13 offen offset:2048 sc1 lds
    v_mfma_f32_16x16x32_bf16 v[172:175], a[124:127], v[56:59], v[172:175]
    v_mfma_f32_16x16x32_bf16 v[176:179], a[128:131], v[56:59], v[176:179]
    buffer_load_dwordx4 v254, s[36:39], s13 offen offset:3072 sc1 lds
    v_mfma_f32_16x16x32_bf16 v[180:183], a[132:135], v[56:59], v[180:183]
    s_add_u32 s13, s13, 4096
    v_mfma_f32_16x16x32_bf16 v[184:187], a[136:139], v[56:59], v[184:187]
    v_mfma_f32_16x16x32_bf16 v[188:191], a[120:123], v[60:63], v[188:191]
    v_mfma_f32_16x16x32_bf16 v[192:195], a[124:127], v[60:63], v[192:195]
    v_mfma_f32_16x16x32_bf16 v[196:199], a[128:131], v[60:63], v[196:199]
    v_mfma_f32_16x16x32_bf16 v[200:203], a[132:135], v[60:63], v[200:203]
    v_mfma_f32_16x16x32_bf16 v[204:207], a[136:139], v[60:63], v[204:207]
    s_waitcnt vmcnt(17)
    v_mfma_f32_16x16x32_bf16 v[128:131], a[140:143], v[64:67], v[128:131]
    buffer_load_dwordx4 v[48:51], v254, s[36:39], s4 offen offset:2048 sc1
    v_mfma_f32_16x16x32_bf16 v[132:135], a[144:147], v[64:67], v[132:135]
    v_mfma_f32_16x16x32_bf16 v[136:139], a[148:151], v[64:67], v[136:139]
    buffer_load_dwordx4 v[52:55], v254, s[36:39], s5 offen offset:2048 sc1
    v_mfma_f32_16x16x32_bf16 v[140:143], a[152:155], v[64:67], v[140:143]
    v_mfma_f32_16x16x32_bf16 v[144:147], a[156:159], v[64:67], v[144:147]
    buffer_load_dwordx4 v[56:59], v254, s[36:39], s6 offen offset:2048 sc1
    v_mfma_f32_16x16x32_bf16 v[148:151], a[140:143], v[68:71], v[148:151]
    v_mfma_f32_16x16x32_bf16 v[152:155], a[144:147], v[68:71], v[152:155]
    buffer_load_dwordx4 v[60:63], v254, s[36:39], s7 offen offset:2048 sc1
    v_mfma_f32_16x16x32_bf16 v[156:159], a[148:151], v[68:71], v[156:159]
    s_add_u32 m0, s60, 19456
    v_mfma_f32_16x16x32_bf16 v[160:163], a[152:155], v[68:71], v[160:163]
    buffer_load_dwordx4 v254, s[36:39], s13 offen offset:0 sc1 lds
    v_mfma_f32_16x16x32_bf16 v[164:167], a[156:159], v[68:71], v[164:167]
    s_add_u32 s13, s13, 36864
    v_mfma_f32_16x16x32_bf16 v[168:171], a[140:143], v[72:75], v[168:171]
    s_add_u32 m0, s60, 20480
    s_nop 0
    buffer_load_dwordx4 v254, s[36:39], s13 offen offset:0 sc1 lds
    v_mfma_f32_16x16x32_bf16 v[172:175], a[144:147], v[72:75], v[172:175]
    v_mfma_f32_16x16x32_bf16 v[176:179], a[148:151], v[72:75], v[176:179]
    buffer_load_dwordx4 v254, s[36:39], s13 offen offset:1024 sc1 lds
    v_mfma_f32_16x16x32_bf16 v[180:183], a[152:155], v[72:75], v[180:183]
    v_mfma_f32_16x16x32_bf16 v[184:187], a[156:159], v[72:75], v[184:187]
    v_mfma_f32_16x16x32_bf16 v[188:191], a[140:143], v[76:79], v[188:191]
    v_mfma_f32_16x16x32_bf16 v[192:195], a[144:147], v[76:79], v[192:195]
    v_mfma_f32_16x16x32_bf16 v[196:199], a[148:151], v[76:79], v[196:199]
    v_mfma_f32_16x16x32_bf16 v[200:203], a[152:155], v[76:79], v[200:203]
    v_mfma_f32_16x16x32_bf16 v[204:207], a[156:159], v[76:79], v[204:207]
    s_waitcnt vmcnt(17)
    v_mfma_f32_16x16x32_bf16 v[128:131], a[160:163], v[16:19], v[128:131]
    buffer_load_dword v3, v250, s[36:39], s15 offen sc1
    v_mfma_f32_16x16x32_bf16 v[132:135], a[164:167], v[16:19], v[132:135]
    v_mfma_f32_16x16x32_bf16 v[136:139], a[168:171], v[16:19], v[136:139]
    buffer_load_dwordx4 v[64:67], v254, s[36:39], s4 offen offset:3072 sc1
    v_mfma_f32_16x16x32_bf16 v[140:143], a[172:175], v[16:19], v[140:143]
    v_mfma_f32_16x16x32_bf16 v[144:147], a[176:179], v[16:19], v[144:147]
    buffer_load_dwordx4 v[68:71], v254, s[36:39], s5 offen offset:3072 sc1
    v_mfma_f32_16x16x32_bf16 v[148:151], a[160:163], v[20:23], v[148:151]
    v_mfma_f32_16x16x32_bf16 v[152:155], a[164:167], v[20:23], v[152:155]
    buffer_load_dwordx4 v[72:75], v254, s[36:39], s6 offen offset:3072 sc1
    v_mfma_f32_16x16x32_bf16 v[156:159], a[168:171], v[20:23], v[156:159]
    v_mfma_f32_16x16x32_bf16 v[160:163], a[172:175], v[20:23], v[160:163]
    buffer_load_dwordx4 v[76:79], v254, s[36:39], s7 offen offset:3072 sc1
    v_mfma_f32_16x16x32_bf16 v[164:167], a[176:179], v[20:23], v[164:167]
    s_add_u32 s4, s4, 4096
    v_mfma_f32_16x16x32_bf16 v[168:171], a[160:163], v[24:27], v[168:171]
    s_add_u32 s5, s5, 4096
    s_add_u32 s6, s6, 4096
    s_add_u32 s7, s7, 4096
    buffer_load_dwordx4 v254, s[36:39], s13 offen offset:2048 sc1 lds
    v_mfma_f32_16x16x32_bf16 v[172:175], a[164:167], v[24:27], v[172:175]
    v_mfma_f32_16x16x32_bf16 v[176:179], a[168:171], v[24:27], v[176:179]
    buffer_load_dwordx4 v254, s[36:39], s13 offen offset:3072 sc1 lds
    v_mfma_f32_16x16x32_bf16 v[180:183], a[172:175], v[24:27], v[180:183]
    s_add_u32 s13, s13, 4096
    v_mfma_f32_16x16x32_bf16 v[184:187], a[176:179], v[24:27], v[184:187]
    s_add_u32 m0, s60, 24576
    s_nop 0
    buffer_load_dwordx4 v254, s[36:39], s13 offen offset:0 sc1 lds
    v_mfma_f32_16x16x32_bf16 v[188:191], a[160:163], v[28:31], v[188:191]
    s_add_u32 s13, s13, 36864
    v_mfma_f32_16x16x32_bf16 v[192:195], a[164:167], v[28:31], v[192:195]
    v_add_u32 v5, s60, v254
    v_bfe_u32 v9, v1, 4, 1
    v_mul_u32_u24 v9, 24, v9
    v_add_u32 v9, v9, v249
    s_xor_b32 s66, s48, 1
    s_mul_i32 s66, s66, 25600
    s_add_u32 s66, s66, 51200
    v_add_u32 v6, s66, v254
    s_xor_b32 s66, s48, 2
    s_mul_i32 s66, s66, 25600
    s_add_u32 s66, s66, 56320
    v_add_u32 v7, s66, v254
    s_xor_b32 s66, s48, 3
    s_mul_i32 s66, s66, 25600
    s_add_u32 s66, s66, 61440
    v_add_u32 v8, s66, v254
    v_mfma_f32_16x16x32_bf16 v[196:199], a[168:171], v[28:31], v[196:199]
    v_mfma_f32_16x16x32_bf16 v[200:203], a[172:175], v[28:31], v[200:203]
    v_mfma_f32_16x16x32_bf16 v[204:207], a[176:179], v[28:31], v[204:207]
    s_waitcnt vmcnt(18)
    v_mfma_f32_16x16x32_bf16 v[128:131], a[180:183], v[32:35], v[128:131]
    v_mfma_f32_16x16x32_bf16 v[132:135], a[184:187], v[32:35], v[132:135]
    v_mfma_f32_16x16x32_bf16 v[136:139], a[188:191], v[32:35], v[136:139]
    v_mfma_f32_16x16x32_bf16 v[140:143], a[192:195], v[32:35], v[140:143]
    v_mfma_f32_16x16x32_bf16 v[144:147], a[196:199], v[32:35], v[144:147]
    v_mfma_f32_16x16x32_bf16 v[148:151], a[180:183], v[36:39], v[148:151]
    v_mfma_f32_16x16x32_bf16 v[152:155], a[184:187], v[36:39], v[152:155]
    v_mfma_f32_16x16x32_bf16 v[156:159], a[188:191], v[36:39], v[156:159]
    v_mfma_f32_16x16x32_bf16 v[160:163], a[192:195], v[36:39], v[160:163]
    v_mfma_f32_16x16x32_bf16 v[164:167], a[196:199], v[36:39], v[164:167]
    v_mfma_f32_16x16x32_bf16 v[168:171], a[180:183], v[40:43], v[168:171]
    v_mfma_f32_16x16x32_bf16 v[172:175], a[184:187], v[40:43], v[172:175]
    v_mfma_f32_16x16x32_bf16 v[176:179], a[188:191], v[40:43], v[176:179]
    v_mfma_f32_16x16x32_bf16 v[180:183], a[192:195], v[40:43], v[180:183]
    v_mfma_f32_16x16x32_bf16 v[184:187], a[196:199], v[40:43], v[184:187]
    v_mfma_f32_16x16x32_bf16 v[188:191], a[180:183], v[44:47], v[188:191]
    v_mfma_f32_16x16x32_bf16 v[192:195], a[184:187], v[44:47], v[192:195]
    v_mfma_f32_16x16x32_bf16 v[196:199], a[188:191], v[44:47], v[196:199]
    v_mfma_f32_16x16x32_bf16 v[200:203], a[192:195], v[44:47], v[200:203]
    v_mfma_f32_16x16x32_bf16 v[204:207], a[196:199], v[44:47], v[204:207]
    s_waitcnt vmcnt(7)
    v_cmp_eq_u32 vcc, s54, v3
    s_nop 0
    s_and_b32 s68, vcc_lo, 3
    s_cmp_eq_u32 s68, 3
    s_cbranch_scc0 L_t0_olate
    v_mfma_f32_16x16x32_bf16 v[128:131], a[200:203], v[48:51], v[128:131]
    buffer_load_dwordx4 v[16:19], v254, s[36:39], s8 offen offset:0 sc1
    v_mfma_f32_16x16x32_bf16 v[132:135], a[204:207], v[48:51], v[132:135]
    v_mfma_f32_16x16x32_bf16 v[136:139], a[208:211], v[48:51], v[136:139]
    buffer_load_dwordx4 v[20:23], v254, s[36:39], s9 offen offset:0 sc1
    v_mfma_f32_16x16x32_bf16 v[140:143], a[212:215], v[48:51], v[140:143]
    v_mfma_f32_16x16x32_bf16 v[144:147], a[216:219], v[48:51], v[144:147]
    buffer_load_dwordx4 v[24:27], v254, s[36:39], s10 offen offset:0 sc1
    v_mfma_f32_16x16x32_bf16 v[148:151], a[200:203], v[52:55], v[148:151]
    v_mfma_f32_16x16x32_bf16 v[152:155], a[204:207], v[52:55], v[152:155]
    buffer_load_dwordx4 v[28:31], v254, s[36:39], s11 offen offset:0 sc1
    v_mfma_f32_16x16x32_bf16 v[156:159], a[208:211], v[52:55], v[156:159]
    v_mfma_f32_16x16x32_bf16 v[160:163], a[212:215], v[52:55], v[160:163]
    buffer_load_dwordx4 v[32:35], v254, s[36:39], s8 offen offset:1024 sc1
    v_mfma_f32_16x16x32_bf16 v[164:167], a[216:219], v[52:55], v[164:167]
    v_mfma_f32_16x16x32_bf16 v[168:171], a[200:203], v[56:59], v[168:171]
    buffer_load_dwordx4 v[36:39], v254, s[36:39], s9 offen offset:1024 sc1
    v_mfma_f32_16x16x32_bf16 v[172:175], a[204:207], v[56:59], v[172:175]
    v_mfma_f32_16x16x32_bf16 v[176:179], a[208:211], v[56:59], v[176:179]
    buffer_load_dwordx4 v[40:43], v254, s[36:39], s10 offen offset:1024 sc1
    v_mfma_f32_16x16x32_bf16 v[180:183], a[212:215], v[56:59], v[180:183]
    v_mfma_f32_16x16x32_bf16 v[184:187], a[216:219], v[56:59], v[184:187]
    buffer_load_dwordx4 v[44:47], v254, s[36:39], s11 offen offset:1024 sc1
    v_mfma_f32_16x16x32_bf16 v[188:191], a[200:203], v[60:63], v[188:191]
    v_mfma_f32_16x16x32_bf16 v[192:195], a[204:207], v[60:63], v[192:195]
    v_mfma_f32_16x16x32_bf16 v[196:199], a[208:211], v[60:63], v[196:199]
    v_mfma_f32_16x16x32_bf16 v[200:203], a[212:215], v[60:63], v[200:203]
    v_mfma_f32_16x16x32_bf16 v[204:207], a[216:219], v[60:63], v[204:207]
    s_waitcnt vmcnt(8)
    v_mfma_f32_16x16x32_bf16 v[128:131], a[220:223], v[64:67], v[128:131]
    ds_read_b128 v[80:83], v5 offset:0
    ds_read_b128 v[84:87], v5 offset:1024
    ds_read_b128 v[88:91], v5 offset:2048
    ds_read_b128 v[92:95], v5 offset:3072
    ds_read_b128 v[96:99], v5 offset:4096
    buffer_load_dwordx4 v[48:51], v254, s[36:39], s8 offen offset:2048 sc1
    v_mfma_f32_16x16x32_bf16 v[132:135], a[224:227], v[64:67], v[132:135]
    v_mfma_f32_16x16x32_bf16 v[136:139], a[228:231], v[64:67], v[136:139]
    v_mfma_f32_16x16x32_bf16 v[140:143], a[232:235], v[64:67], v[140:143]
    v_mfma_f32_16x16x32_bf16 v[144:147], a[236:239], v[64:67], v[144:147]
    buffer_load_dwordx4 v[52:55], v254, s[36:39], s9 offen offset:2048 sc1
    v_mfma_f32_16x16x32_bf16 v[148:151], a[220:223], v[68:71], v[148:151]
    v_mfma_f32_16x16x32_bf16 v[152:155], a[224:227], v[68:71], v[152:155]
    v_mfma_f32_16x16x32_bf16 v[156:159], a[228:231], v[68:71], v[156:159]
    v_mfma_f32_16x16x32_bf16 v[160:163], a[232:235], v[68:71], v[160:163]
    buffer_load_dwordx4 v[56:59], v254, s[36:39], s10 offen offset:2048 sc1
    v_mfma_f32_16x16x32_bf16 v[164:167], a[236:239], v[68:71], v[164:167]
    v_mfma_f32_16x16x32_bf16 v[168:171], a[220:223], v[72:75], v[168:171]
    v_mfma_f32_16x16x32_bf16 v[172:175], a[224:227], v[72:75], v[172:175]
    v_mfma_f32_16x16x32_bf16 v[176:179], a[228:231], v[72:75], v[176:179]
    buffer_load_dwordx4 v[60:63], v254, s[36:39], s11 offen offset:2048 sc1
    v_mfma_f32_16x16x32_bf16 v[180:183], a[232:235], v[72:75], v[180:183]
    v_mfma_f32_16x16x32_bf16 v[184:187], a[236:239], v[72:75], v[184:187]
    v_mfma_f32_16x16x32_bf16 v[188:191], a[220:223], v[76:79], v[188:191]
    v_mfma_f32_16x16x32_bf16 v[192:195], a[224:227], v[76:79], v[192:195]
    v_mfma_f32_16x16x32_bf16 v[196:199], a[228:231], v[76:79], v[196:199]
    v_mfma_f32_16x16x32_bf16 v[200:203], a[232:235], v[76:79], v[200:203]
    v_mfma_f32_16x16x32_bf16 v[204:207], a[236:239], v[76:79], v[204:207]
    s_waitcnt vmcnt(8)
    s_waitcnt lgkmcnt(0)
    v_mfma_f32_16x16x32_bf16 v[128:131], v[80:83], v[16:19], v[128:131]
    ds_read_b128 v[100:103], v5 offset:5120
    ds_read_b128 v[104:107], v5 offset:6144
    ds_read_b128 v[108:111], v5 offset:7168
    ds_read_b128 v[112:115], v5 offset:8192
    ds_read_b128 v[116:119], v5 offset:9216
    buffer_load_dwordx4 v[64:67], v254, s[36:39], s8 offen offset:3072 sc1
    v_mfma_f32_16x16x32_bf16 v[132:135], v[84:87], v[16:19], v[132:135]
    v_mfma_f32_16x16x32_bf16 v[136:139], v[88:91], v[16:19], v[136:139]
    v_mfma_f32_16x16x32_bf16 v[140:143], v[92:95], v[16:19], v[140:143]
    v_mfma_f32_16x16x32_bf16 v[144:147], v[96:99], v[16:19], v[144:147]
    buffer_load_dwordx4 v[68:71], v254, s[36:39], s9 offen offset:3072 sc1
    v_mfma_f32_16x16x32_bf16 v[148:151], v[80:83], v[20:23], v[148:151]
    v_mfma_f32_16x16x32_bf16 v[152:155], v[84:87], v[20:23], v[152:155]
    v_mfma_f32_16x16x32_bf16 v[156:159], v[88:91], v[20:23], v[156:159]
    v_mfma_f32_16x16x32_bf16 v[160:163], v[92:95], v[20:23], v[160:163]
    buffer_load_dwordx4 v[72:75], v254, s[36:39], s10 offen offset:3072 sc1
    v_mfma_f32_16x16x32_bf16 v[164:167], v[96:99], v[20:23], v[164:167]
    v_mfma_f32_16x16x32_bf16 v[168:171], v[80:83], v[24:27], v[168:171]
    v_mfma_f32_16x16x32_bf16 v[172:175], v[84:87], v[24:27], v[172:175]
    v_mfma_f32_16x16x32_bf16 v[176:179], v[88:91], v[24:27], v[176:179]
    buffer_load_dwordx4 v[76:79], v254, s[36:39], s11 offen offset:3072 sc1
    v_mfma_f32_16x16x32_bf16 v[180:183], v[92:95], v[24:27], v[180:183]
    v_mfma_f32_16x16x32_bf16 v[184:187], v[96:99], v[24:27], v[184:187]
    v_mfma_f32_16x16x32_bf16 v[188:191], v[80:83], v[28:31], v[188:191]
    v_mfma_f32_16x16x32_bf16 v[192:195], v[84:87], v[28:31], v[192:195]
    v_mfma_f32_16x16x32_bf16 v[196:199], v[88:91], v[28:31], v[196:199]
    v_mfma_f32_16x16x32_bf16 v[200:203], v[92:95], v[28:31], v[200:203]
    v_mfma_f32_16x16x32_bf16 v[204:207], v[96:99], v[28:31], v[204:207]
    s_waitcnt vmcnt(8)
    s_waitcnt lgkmcnt(0)
    v_mfma_f32_16x16x32_bf16 v[128:131], v[100:103], v[32:35], v[128:131]
    ds_read_b128 v[80:83], v5 offset:10240
    ds_read_b128 v[84:87], v5 offset:11264
    ds_read_b128 v[88:91], v5 offset:12288
    ds_read_b128 v[92:95], v5 offset:13312
    ds_read_b128 v[96:99], v5 offset:14336
    buffer_load_dwordx4 v[208:211], v248, s[36:39], s8 offen offset:0 sc1
    v_mfma_f32_16x16x32_bf16 v[132:135], v[104:107], v[32:35], v[132:135]
    v_mfma_f32_16x16x32_bf16 v[136:139], v[108:111], v[32:35], v[136:139]
    v_mfma_f32_16x16x32_bf16 v[140:143], v[112:115], v[32:35], v[140:143]
    v_mfma_f32_16x16x32_bf16 v[144:147], v[116:119], v[32:35], v[144:147]
    buffer_load_dwordx4 v[212:215], v248, s[36:39], s9 offen offset:0 sc1
    v_mfma_f32_16x16x32_bf16 v[148:151], v[100:103], v[36:39], v[148:151]
    v_mfma_f32_16x16x32_bf16 v[152:155], v[104:107], v[36:39], v[152:155]
    v_mfma_f32_16x16x32_bf16 v[156:159], v[108:111], v[36:39], v[156:159]
    v_mfma_f32_16x16x32_bf16 v[160:163], v[112:115], v[36:39], v[160:163]
    buffer_load_dwordx4 v[216:219], v248, s[36:39], s10 offen offset:0 sc1
    v_mfma_f32_16x16x32_bf16 v[164:167], v[116:119], v[36:39], v[164:167]
    v_mfma_f32_16x16x32_bf16 v[168:171], v[100:103], v[40:43], v[168:171]
    v_mfma_f32_16x16x32_bf16 v[172:175], v[104:107], v[40:43], v[172:175]
    v_mfma_f32_16x16x32_bf16 v[176:179], v[108:111], v[40:43], v[176:179]
    buffer_load_dwordx4 v[220:223], v248, s[36:39], s11 offen offset:0 sc1
    v_mfma_f32_16x16x32_bf16 v[180:183], v[112:115], v[40:43], v[180:183]
    v_mfma_f32_16x16x32_bf16 v[184:187], v[116:119], v[40:43], v[184:187]
    v_mfma_f32_16x16x32_bf16 v[188:191], v[100:103], v[44:47], v[188:191]
    v_mfma_f32_16x16x32_bf16 v[192:195], v[104:107], v[44:47], v[192:195]
    v_mfma_f32_16x16x32_bf16 v[196:199], v[108:111], v[44:47], v[196:199]
    v_mfma_f32_16x16x32_bf16 v[200:203], v[112:115], v[44:47], v[200:203]
    v_mfma_f32_16x16x32_bf16 v[204:207], v[116:119], v[44:47], v[204:207]
L_t0_ojoin:
    s_waitcnt vmcnt(8)
    s_waitcnt lgkmcnt(0)
    v_mfma_f32_16x16x32_bf16 v[128:131], v[80:83], v[48:51], v[128:131]
    ds_read_b128 v[100:103], v5 offset:15360
    ds_read_b128 v[104:107], v5 offset:16384
    ds_read_b128 v[108:111], v5 offset:17408
    ds_read_b128 v[112:115], v5 offset:18432
    ds_read_b128 v[116:119], v5 offset:19456
    v_mfma_f32_16x16x32_bf16 v[132:135], v[84:87], v[48:51], v[132:135]
    v_mfma_f32_16x16x32_bf16 v[136:139], v[88:91], v[48:51], v[136:139]
    v_mfma_f32_16x16x32_bf16 v[140:143], v[92:95], v[48:51], v[140:143]
    v_mfma_f32_16x16x32_bf16 v[144:147], v[96:99], v[48:51], v[144:147]
    v_mfma_f32_16x16x32_bf16 v[148:151], v[80:83], v[52:55], v[148:151]
    v_mfma_f32_16x16x32_bf16 v[152:155], v[84:87], v[52:55], v[152:155]
    v_mfma_f32_16x16x32_bf16 v[156:159], v[88:91], v[52:55], v[156:159]
    v_mfma_f32_16x16x32_bf16 v[160:163], v[92:95], v[52:55], v[160:163]
    v_mfma_f32_16x16x32_bf16 v[164:167], v[96:99], v[52:55], v[164:167]
    v_mfma_f32_16x16x32_bf16 v[168:171], v[80:83], v[56:59], v[168:171]
    v_mfma_f32_16x16x32_bf16 v[172:175], v[84:87], v[56:59], v[172:175]
    v_mfma_f32_16x16x32_bf16 v[176:179], v[88:91], v[56:59], v[176:179]
    v_mfma_f32_16x16x32_bf16 v[180:183], v[92:95], v[56:59], v[180:183]
    v_mfma_f32_16x16x32_bf16 v[184:187], v[96:99], v[56:59], v[184:187]
    v_mfma_f32_16x16x32_bf16 v[188:191], v[80:83], v[60:63], v[188:191]
    v_mfma_f32_16x16x32_bf16 v[192:195], v[84:87], v[60:63], v[192:195]
    v_mfma_f32_16x16x32_bf16 v[196:199], v[88:91], v[60:63], v[196:199]
    v_mfma_f32_16x16x32_bf16 v[200:203], v[92:95], v[60:63], v[200:203]
    v_mfma_f32_16x16x32_bf16 v[204:207], v[96:99], v[60:63], v[204:207]
    s_waitcnt vmcnt(4)
    s_waitcnt lgkmcnt(0)
    v_mfma_f32_16x16x32_bf16 v[128:131], v[100:103], v[64:67], v[128:131]
    ds_read_b128 v[80:83], v5 offset:20480
    ds_read_b128 v[84:87], v5 offset:21504
    ds_read_b128 v[88:91], v5 offset:22528
    ds_read_b128 v[92:95], v5 offset:23552
    ds_read_b128 v[96:99], v5 offset:24576
    v_mfma_f32_16x16x32_bf16 v[132:135], v[104:107], v[64:67], v[132:135]
    v_mfma_f32_16x16x32_bf16 v[136:139], v[108:111], v[64:67], v[136:139]
    v_mfma_f32_16x16x32_bf16 v[140:143], v[112:115], v[64:67], v[140:143]
    v_mfma_f32_16x16x32_bf16 v[144:147], v[116:119], v[64:67], v[144:147]
    v_mfma_f32_16x16x32_bf16 v[148:151], v[100:103], v[68:71], v[148:151]
    v_mfma_f32_16x16x32_bf16 v[152:155], v[104:107], v[68:71], v[152:155]
    v_mfma_f32_16x16x32_bf16 v[156:159], v[108:111], v[68:71], v[156:159]
    v_mfma_f32_16x16x32_bf16 v[160:163], v[112:115], v[68:71], v[160:163]
    v_mfma_f32_16x16x32_bf16 v[164:167], v[116:119], v[68:71], v[164:167]
    v_mfma_f32_16x16x32_bf16 v[168:171], v[100:103], v[72:75], v[168:171]
    v_mfma_f32_16x16x32_bf16 v[172:175], v[104:107], v[72:75], v[172:175]
    v_mfma_f32_16x16x32_bf16 v[176:179], v[108:111], v[72:75], v[176:179]
    v_mfma_f32_16x16x32_bf16 v[180:183], v[112:115], v[72:75], v[180:183]
    v_mfma_f32_16x16x32_bf16 v[184:187], v[116:119], v[72:75], v[184:187]
    v_mfma_f32_16x16x32_bf16 v[188:191], v[100:103], v[76:79], v[188:191]
    v_mfma_f32_16x16x32_bf16 v[192:195], v[104:107], v[76:79], v[192:195]
    v_mfma_f32_16x16x32_bf16 v[196:199], v[108:111], v[76:79], v[196:199]
    v_mfma_f32_16x16x32_bf16 v[200:203], v[112:115], v[76:79], v[200:203]
    v_mfma_f32_16x16x32_bf16 v[204:207], v[116:119], v[76:79], v[204:207]
    s_waitcnt vmcnt(0)
    s_waitcnt lgkmcnt(0)
    v_mfma_f32_16x16x32_bf16 v[148:151], v[80:83], v[212:215], v[148:151]
    v_mfma_f32_16x16x32_bf16 v[152:155], v[84:87], v[212:215], v[152:155]
    v_mfma_f32_16x16x32_bf16 v[156:159], v[88:91], v[212:215], v[156:159]
    v_mfma_f32_16x16x32_bf16 v[160:163], v[92:95], v[212:215], v[160:163]
    v_mfma_f32_16x16x32_bf16 v[164:167], v[96:99], v[212:215], v[164:167]
    v_mfma_f32_16x16x32_bf16 v[168:171], v[80:83], v[216:219], v[168:171]
    v_mfma_f32_16x16x32_bf16 v[172:175], v[84:87], v[216:219], v[172:175]
    v_mfma_f32_16x16x32_bf16 v[176:179], v[88:91], v[216:219], v[176:179]
    s_nop 0
    ds_write_b128 v5, v[148:151] offset:0
    v_mfma_f32_16x16x32_bf16 v[180:183], v[92:95], v[216:219], v[180:183]
    ds_write_b128 v5, v[152:155] offset:1024
    v_mfma_f32_16x16x32_bf16 v[184:187], v[96:99], v[216:219], v[184:187]
    ds_write_b128 v5, v[156:159] offset:2048
    v_mfma_f32_16x16x32_bf16 v[188:191], v[80:83], v[220:223], v[188:191]
    ds_write_b128 v5, v[160:163] offset:3072
    v_mfma_f32_16x16x32_bf16 v[192:195], v[84:87], v[220:223], v[192:195]
    ds_write_b128 v5, v[164:167] offset:4096
    v_mfma_f32_16x16x32_bf16 v[196:199], v[88:91], v[220:223], v[196:199]
    ds_write_b128 v5, v[168:171] offset:5120
    v_mfma_f32_16x16x32_bf16 v[200:203], v[92:95], v[220:223], v[200:203]
    ds_write_b128 v5, v[172:175] offset:6144
    v_mfma_f32_16x16x32_bf16 v[204:207], v[96:99], v[220:223], v[204:207]
    ds_write_b128 v5, v[176:179] offset:7168
    v_mfma_f32_16x16x32_bf16 v[128:131], v[80:83], v[208:211], v[128:131]
    ds_write_b128 v5, v[180:183] offset:8192
    v_mfma_f32_16x16x32_bf16 v[132:135], v[84:87], v[208:211], v[132:135]
    ds_write_b128 v5, v[184:187] offset:9216
    v_mfma_f32_16x16x32_bf16 v[136:139], v[88:91], v[208:211], v[136:139]
    ds_write_b128 v5, v[188:191] offset:10240
    v_mfma_f32_16x16x32_bf16 v[140:143], v[92:95], v[208:211], v[140:143]
    ds_write_b128 v5, v[192:195] offset:11264
    v_mfma_f32_16x16x32_bf16 v[144:147], v[96:99], v[208:211], v[144:147]
    ds_write_b128 v5, v[196:199] offset:12288
    ds_write_b128 v5, v[200:203] offset:13312
    ds_write_b128 v5, v[204:207] offset:14336
    s_waitcnt lgkmcnt(0)
    s_barrier
    ds_read_b128 v[16:19], v6 offset:0
    ds_read_b128 v[20:23], v7 offset:0
    ds_read_b128 v[24:27], v8 offset:0
    ds_read_b128 v[28:31], v6 offset:1024
    ds_read_b128 v[32:35], v7 offset:1024
    ds_read_b128 v[36:39], v8 offset:1024
    ds_read_b128 v[40:43], v6 offset:2048
    ds_read_b128 v[44:47], v7 offset:2048
    ds_read_b128 v[48:51], v8 offset:2048
    ds_read_b128 v[52:55], v6 offset:3072
    ds_read_b128 v[56:59], v7 offset:3072
    ds_read_b128 v[60:63], v8 offset:3072
    ds_read_b128 v[64:67], v6 offset:4096
    ds_read_b128 v[68:71], v7 offset:4096
    ds_read_b128 v[72:75], v8 offset:4096
    s_waitcnt lgkmcnt(12)
    v_pk_add_f32 v[16:17], v[16:17], v[20:21]
    v_pk_add_f32 v[18:19], v[18:19], v[22:23]
    v_pk_add_f32 v[128:129], v[128:129], v[24:25]
    v_pk_add_f32 v[130:131], v[130:131], v[26:27]
    v_pk_add_f32 v[128:129], v[128:129], v[16:17]
    v_pk_add_f32 v[130:131], v[130:131], v[18:19]
    v_cvt_pk_bf16_f32 v16, v128, v129
    v_cvt_pk_bf16_f32 v17, v130, v131
    buffer_store_dwordx2 v[16:17], v249, s[44:47], 0 offen offset:0
    s_waitcnt lgkmcnt(9)
    v_pk_add_f32 v[28:29], v[28:29], v[32:33]
    v_pk_add_f32 v[30:31], v[30:31], v[34:35]
    v_pk_add_f32 v[132:133], v[132:133], v[36:37]
    v_pk_add_f32 v[134:135], v[134:135], v[38:39]
    v_pk_add_f32 v[132:133], v[132:133], v[28:29]
    v_pk_add_f32 v[134:135], v[134:135], v[30:31]
    v_cvt_pk_bf16_f32 v28, v132, v133
    v_cvt_pk_bf16_f32 v29, v134, v135
    buffer_store_dwordx2 v[28:29], v249, s[44:47], 0 offen offset:32
    s_waitcnt lgkmcnt(6)
    v_pk_add_f32 v[40:41], v[40:41], v[44:45]
    v_pk_add_f32 v[42:43], v[42:43], v[46:47]
    v_pk_add_f32 v[136:137], v[136:137], v[48:49]
    v_pk_add_f32 v[138:139], v[138:139], v[50:51]
    v_pk_add_f32 v[136:137], v[136:137], v[40:41]
    v_pk_add_f32 v[138:139], v[138:139], v[42:43]
    v_cvt_pk_bf16_f32 v40, v136, v137
    v_cvt_pk_bf16_f32 v41, v138, v139
    buffer_store_dwordx2 v[40:41], v249, s[44:47], 0 offen offset:64
    s_waitcnt lgkmcnt(3)
    v_pk_add_f32 v[52:53], v[52:53], v[56:57]
    v_pk_add_f32 v[54:55], v[54:55], v[58:59]
    v_pk_add_f32 v[140:141], v[140:141], v[60:61]
    v_pk_add_f32 v[142:143], v[142:143], v[62:63]
    v_pk_add_f32 v[140:141], v[140:141], v[52:53]
    v_pk_add_f32 v[142:143], v[142:143], v[54:55]
    v_cvt_pk_bf16_f32 v52, v140, v141
    v_cvt_pk_bf16_f32 v53, v142, v143
    buffer_store_dwordx2 v[52:53], v249, s[44:47], 0 offen offset:96
    s_waitcnt lgkmcnt(0)
    v_pk_add_f32 v[64:65], v[64:65], v[68:69]
    v_pk_add_f32 v[66:67], v[66:67], v[70:71]
    v_pk_add_f32 v[144:145], v[144:145], v[72:73]
    v_pk_add_f32 v[146:147], v[146:147], v[74:75]
    v_pk_add_f32 v[144:145], v[144:145], v[64:65]
    v_pk_add_f32 v[146:147], v[146:147], v[66:67]
    v_cvt_pk_bf16_f32 v64, v144, v145
    v_cvt_pk_bf16_f32 v65, v146, v147
    buffer_store_dwordx2 v[64:65], v249, s[44:47], 0 offen offset:128
    s_endpgm
L_t0_olate:
    v_mfma_f32_16x16x32_bf16 v[128:131], a[200:203], v[48:51], v[128:131]
    v_mfma_f32_16x16x32_bf16 v[132:135], a[204:207], v[48:51], v[132:135]
    v_mfma_f32_16x16x32_bf16 v[136:139], a[208:211], v[48:51], v[136:139]
    v_mfma_f32_16x16x32_bf16 v[140:143], a[212:215], v[48:51], v[140:143]
    v_mfma_f32_16x16x32_bf16 v[144:147], a[216:219], v[48:51], v[144:147]
    v_mfma_f32_16x16x32_bf16 v[148:151], a[200:203], v[52:55], v[148:151]
    v_mfma_f32_16x16x32_bf16 v[152:155], a[204:207], v[52:55], v[152:155]
    v_mfma_f32_16x16x32_bf16 v[156:159], a[208:211], v[52:55], v[156:159]
    v_mfma_f32_16x16x32_bf16 v[160:163], a[212:215], v[52:55], v[160:163]
    v_mfma_f32_16x16x32_bf16 v[164:167], a[216:219], v[52:55], v[164:167]
    v_mfma_f32_16x16x32_bf16 v[168:171], a[200:203], v[56:59], v[168:171]
    v_mfma_f32_16x16x32_bf16 v[172:175], a[204:207], v[56:59], v[172:175]
    v_mfma_f32_16x16x32_bf16 v[176:179], a[208:211], v[56:59], v[176:179]
    v_mfma_f32_16x16x32_bf16 v[180:183], a[212:215], v[56:59], v[180:183]
    v_mfma_f32_16x16x32_bf16 v[184:187], a[216:219], v[56:59], v[184:187]
    v_mfma_f32_16x16x32_bf16 v[188:191], a[200:203], v[60:63], v[188:191]
    v_mfma_f32_16x16x32_bf16 v[192:195], a[204:207], v[60:63], v[192:195]
    v_mfma_f32_16x16x32_bf16 v[196:199], a[208:211], v[60:63], v[196:199]
    v_mfma_f32_16x16x32_bf16 v[200:203], a[212:215], v[60:63], v[200:203]
    v_mfma_f32_16x16x32_bf16 v[204:207], a[216:219], v[60:63], v[204:207]
    s_waitcnt vmcnt(0)
    v_mfma_f32_16x16x32_bf16 v[128:131], a[220:223], v[64:67], v[128:131]
    ds_read_b128 v[80:83], v5 offset:0
    ds_read_b128 v[84:87], v5 offset:1024
    ds_read_b128 v[88:91], v5 offset:2048
    ds_read_b128 v[92:95], v5 offset:3072
    ds_read_b128 v[96:99], v5 offset:4096
    v_mfma_f32_16x16x32_bf16 v[132:135], a[224:227], v[64:67], v[132:135]
    v_mfma_f32_16x16x32_bf16 v[136:139], a[228:231], v[64:67], v[136:139]
    v_mfma_f32_16x16x32_bf16 v[140:143], a[232:235], v[64:67], v[140:143]
    v_mfma_f32_16x16x32_bf16 v[144:147], a[236:239], v[64:67], v[144:147]
    v_mfma_f32_16x16x32_bf16 v[148:151], a[220:223], v[68:71], v[148:151]
    v_mfma_f32_16x16x32_bf16 v[152:155], a[224:227], v[68:71], v[152:155]
    v_mfma_f32_16x16x32_bf16 v[156:159], a[228:231], v[68:71], v[156:159]
    v_mfma_f32_16x16x32_bf16 v[160:163], a[232:235], v[68:71], v[160:163]
    v_mfma_f32_16x16x32_bf16 v[164:167], a[236:239], v[68:71], v[164:167]
    v_mfma_f32_16x16x32_bf16 v[168:171], a[220:223], v[72:75], v[168:171]
    v_mfma_f32_16x16x32_bf16 v[172:175], a[224:227], v[72:75], v[172:175]
    v_mfma_f32_16x16x32_bf16 v[176:179], a[228:231], v[72:75], v[176:179]
    v_mfma_f32_16x16x32_bf16 v[180:183], a[232:235], v[72:75], v[180:183]
    v_mfma_f32_16x16x32_bf16 v[184:187], a[236:239], v[72:75], v[184:187]
    v_mfma_f32_16x16x32_bf16 v[188:191], a[220:223], v[76:79], v[188:191]
    v_mfma_f32_16x16x32_bf16 v[192:195], a[224:227], v[76:79], v[192:195]
    v_mfma_f32_16x16x32_bf16 v[196:199], a[228:231], v[76:79], v[196:199]
    v_mfma_f32_16x16x32_bf16 v[200:203], a[232:235], v[76:79], v[200:203]
    v_mfma_f32_16x16x32_bf16 v[204:207], a[236:239], v[76:79], v[204:207]
    s_mov_b32 s69, 0
    s_branch L_t0_po_go
L_t0_po:
    s_sleep 4
L_t0_po_go:
    buffer_load_dword v3, v250, s[36:39], s15 offen offset:0 sc1
    s_add_u32 s69, s69, 1
    s_waitcnt vmcnt(0)
    v_cmp_eq_u32 vcc, s54, v3
    s_nop 0
    s_and_b32 s68, vcc_lo, 3
    s_cmp_eq_u32 s68, 3
    s_cbranch_scc1 L_t0_po_ok
    s_cmp_lt_u32 s69, 262144
    s_cbranch_scc1 L_t0_po
L_t0_po_ok:
    buffer_load_dwordx4 v[16:19], v254, s[36:39], s8 offen offset:0 sc1
    buffer_load_dwordx4 v[20:23], v254, s[36:39], s9 offen offset:0 sc1
    buffer_load_dwordx4 v[24:27], v254, s[36:39], s10 offen offset:0 sc1
    buffer_load_dwordx4 v[28:31], v254, s[36:39], s11 offen offset:0 sc1
    buffer_load_dwordx4 v[32:35], v254, s[36:39], s8 offen offset:1024 sc1
    buffer_load_dwordx4 v[36:39], v254, s[36:39], s9 offen offset:1024 sc1
    buffer_load_dwordx4 v[40:43], v254, s[36:39], s10 offen offset:1024 sc1
    buffer_load_dwordx4 v[44:47], v254, s[36:39], s11 offen offset:1024 sc1
    buffer_load_dwordx4 v[48:51], v254, s[36:39], s8 offen offset:2048 sc1
    buffer_load_dwordx4 v[52:55], v254, s[36:39], s9 offen offset:2048 sc1
    buffer_load_dwordx4 v[56:59], v254, s[36:39], s10 offen offset:2048 sc1
    buffer_load_dwordx4 v[60:63], v254, s[36:39], s11 offen offset:2048 sc1
    buffer_load_dwordx4 v[64:67], v254, s[36:39], s8 offen offset:3072 sc1
    buffer_load_dwordx4 v[68:71], v254, s[36:39], s9 offen offset:3072 sc1
    buffer_load_dwordx4 v[72:75], v254, s[36:39], s10 offen offset:3072 sc1
    buffer_load_dwordx4 v[76:79], v254, s[36:39], s11 offen offset:3072 sc1
    buffer_load_dwordx4 v[208:211], v248, s[36:39], s8 offen offset:0 sc1
    buffer_load_dwordx4 v[212:215], v248, s[36:39], s9 offen offset:0 sc1
    buffer_load_dwordx4 v[216:219], v248, s[36:39], s10 offen offset:0 sc1
    buffer_load_dwordx4 v[220:223], v248, s[36:39], s11 offen offset:0 sc1
    s_waitcnt vmcnt(16)
    s_waitcnt lgkmcnt(0)
    v_mfma_f32_16x16x32_bf16 v[128:131], v[80:83], v[16:19], v[128:131]
    ds_read_b128 v[100:103], v5 offset:5120
    ds_read_b128 v[104:107], v5 offset:6144
    ds_read_b128 v[108:111], v5 offset:7168
    ds_read_b128 v[112:115], v5 offset:8192
    ds_read_b128 v[116:119], v5 offset:9216
    v_mfma_f32_16x16x32_bf16 v[132:135], v[84:87], v[16:19], v[132:135]
    v_mfma_f32_16x16x32_bf16 v[136:139], v[88:91], v[16:19], v[136:139]
    v_mfma_f32_16x16x32_bf16 v[140:143], v[92:95], v[16:19], v[140:143]
    v_mfma_f32_16x16x32_bf16 v[144:147], v[96:99], v[16:19], v[144:147]
    v_mfma_f32_16x16x32_bf16 v[148:151], v[80:83], v[20:23], v[148:151]
    v_mfma_f32_16x16x32_bf16 v[152:155], v[84:87], v[20:23], v[152:155]
    v_mfma_f32_16x16x32_bf16 v[156:159], v[88:91], v[20:23], v[156:159]
    v_mfma_f32_16x16x32_bf16 v[160:163], v[92:95], v[20:23], v[160:163]
    v_mfma_f32_16x16x32_bf16 v[164:167], v[96:99], v[20:23], v[164:167]
    v_mfma_f32_16x16x32_bf16 v[168:171], v[80:83], v[24:27], v[168:171]
    v_mfma_f32_16x16x32_bf16 v[172:175], v[84:87], v[24:27], v[172:175]
    v_mfma_f32_16x16x32_bf16 v[176:179], v[88:91], v[24:27], v[176:179]
    v_mfma_f32_16x16x32_bf16 v[180:183], v[92:95], v[24:27], v[180:183]
    v_mfma_f32_16x16x32_bf16 v[184:187], v[96:99], v[24:27], v[184:187]
    v_mfma_f32_16x16x32_bf16 v[188:191], v[80:83], v[28:31], v[188:191]
    v_mfma_f32_16x16x32_bf16 v[192:195], v[84:87], v[28:31], v[192:195]
    v_mfma_f32_16x16x32_bf16 v[196:199], v[88:91], v[28:31], v[196:199]
    v_mfma_f32_16x16x32_bf16 v[200:203], v[92:95], v[28:31], v[200:203]
    v_mfma_f32_16x16x32_bf16 v[204:207], v[96:99], v[28:31], v[204:207]
    s_waitcnt vmcnt(12)
    s_waitcnt lgkmcnt(0)
    v_mfma_f32_16x16x32_bf16 v[128:131], v[100:103], v[32:35], v[128:131]
    ds_read_b128 v[80:83], v5 offset:10240
    ds_read_b128 v[84:87], v5 offset:11264
    ds_read_b128 v[88:91], v5 offset:12288
    ds_read_b128 v[92:95], v5 offset:13312
    ds_read_b128 v[96:99], v5 offset:14336
    v_mfma_f32_16x16x32_bf16 v[132:135], v[104:107], v[32:35], v[132:135]
    v_mfma_f32_16x16x32_bf16 v[136:139], v[108:111], v[32:35], v[136:139]
    v_mfma_f32_16x16x32_bf16 v[140:143], v[112:115], v[32:35], v[140:143]
    v_mfma_f32_16x16x32_bf16 v[144:147], v[116:119], v[32:35], v[144:147]
    v_mfma_f32_16x16x32_bf16 v[148:151], v[100:103], v[36:39], v[148:151]
    v_mfma_f32_16x16x32_bf16 v[152:155], v[104:107], v[36:39], v[152:155]
    v_mfma_f32_16x16x32_bf16 v[156:159], v[108:111], v[36:39], v[156:159]
    v_mfma_f32_16x16x32_bf16 v[160:163], v[112:115], v[36:39], v[160:163]
    v_mfma_f32_16x16x32_bf16 v[164:167], v[116:119], v[36:39], v[164:167]
    v_mfma_f32_16x16x32_bf16 v[168:171], v[100:103], v[40:43], v[168:171]
    v_mfma_f32_16x16x32_bf16 v[172:175], v[104:107], v[40:43], v[172:175]
    v_mfma_f32_16x16x32_bf16 v[176:179], v[108:111], v[40:43], v[176:179]
    v_mfma_f32_16x16x32_bf16 v[180:183], v[112:115], v[40:43], v[180:183]
    v_mfma_f32_16x16x32_bf16 v[184:187], v[116:119], v[40:43], v[184:187]
    v_mfma_f32_16x16x32_bf16 v[188:191], v[100:103], v[44:47], v[188:191]
    v_mfma_f32_16x16x32_bf16 v[192:195], v[104:107], v[44:47], v[192:195]
    v_mfma_f32_16x16x32_bf16 v[196:199], v[108:111], v[44:47], v[196:199]
    v_mfma_f32_16x16x32_bf16 v[200:203], v[112:115], v[44:47], v[200:203]
    v_mfma_f32_16x16x32_bf16 v[204:207], v[116:119], v[44:47], v[204:207]
    s_branch L_t0_ojoin
L_t0_slow:
    s_mov_b32 s69, 0
L_t0_slow2:
    buffer_load_dwordx4 v[2:5], v254, s[36:39], s19 offen sc1
    s_add_u32 s69, s69, 1
    s_waitcnt vmcnt(0)
    v_cmp_eq_u32 s[74:75], s54, v2
    v_cmp_eq_u32 vcc, s54, v3
    s_nop 0
    s_and_b64 s[74:75], s[74:75], vcc
    v_cmp_eq_u32 vcc, s54, v4
    s_nop 0
    s_and_b64 s[74:75], s[74:75], vcc
    v_cmp_eq_u32 vcc, s54, v5
    s_nop 0
    s_and_b64 s[74:75], s[74:75], vcc
    s_cmp_eq_u64 s[74:75], -1
    s_cbranch_scc1 L_t0_fast
    s_cmp_lt_u32 s69, 262144
    s_cbranch_scc1 L_t0_slow2
    s_branch L_t0_fast
L_t0_rlx:
    s_cmp_eq_u32 s100, 3
    s_cbranch_scc1 L_t0_rlx3
    s_cmp_eq_u32 s100, 2
    s_mov_b32 s100, 0
    s_cbranch_scc1 L_t0_rlx2
    s_waitcnt vmcnt(11) lgkmcnt(0)
    s_branch L_t0_back
L_t0_rlx3:
    s_mov_b32 s100, 0
    s_waitcnt vmcnt(14) lgkmcnt(0)
    s_branch L_t0_back
L_t0_rlx2:
    s_waitcnt vmcnt(12) lgkmcnt(0)
    s_branch L_t0_back
L_t0_exit:
    s_cmp_eq_u32 s65, 2
    s_cbranch_scc1 L_t0_h1
    s_cmp_eq_u32 s65, 4
    s_cbranch_scc1 L_t0_h2
    s_mov_b32 s65, 2
    s_mov_b32 s100, 0
    ds_read_b64_tr_b16 a[0:1], v13 offset:0
    ds_read_b64_tr_b16 a[2:3], v13 offset:2048
    ds_read_b64_tr_b16 a[4:5], v13 offset:4096
    ds_read_b64_tr_b16 a[6:7], v13 offset:6144
    ds_read_b64_tr_b16 a[8:9], v13 offset:8192
    ds_read_b64_tr_b16 a[10:11], v13 offset:10240
    ds_read_b64_tr_b16 a[12:13], v13 offset:12288
    ds_read_b64_tr_b16 a[14:15], v13 offset:14336
    ds_read_b64_tr_b16 a[16:17], v13 offset:16384
    ds_read_b64_tr_b16 a[18:19], v13 offset:18432
    v_readfirstlane_b32 s54, v207
    s_mul_i32 s54, s54, 0x9E3779B1
    s_add_u32 s54, s54, 0x7F4A7C15
    v_mov_b32 v251, s54
    s_waitcnt lgkmcnt(0)
    v_mfma_f32_16x16x32_bf16 a[20:23], v[240:243], a[0:3], 0
    v_mfma_f32_16x16x32_bf16 a[20:23], v[240:243], a[4:7], a[20:23]
    v_mfma_f32_16x16x32_bf16 a[20:23], v[240:243], a[8:11], a[20:23]
    v_mfma_f32_16x16x32_bf16 a[20:23], v[240:243], a[12:15], a[20:23]
    v_mfma_f32_16x16x32_bf16 a[20:23], v[240:243], a[16:19], a[20:23]
    s_nop 7
    ds_write_b32 v12, a20
    s_branch L_t0_loop
L_t0_h1:
    s_mov_b32 s65, 4
    s_mov_b32 s100, 2
    v_add_u32 v2, 159744, v254
    ds_read_b128 v[4:7], v2
    s_waitcnt lgkmcnt(0)
    buffer_store_dwordx4 v[4:7], v247, s[36:39], 0 offen sc1
    s_branch L_t0_loop
L_t0_h2:
    s_lshl_b32 s66, s2, 2
    s_add_u32 s66, s66, 12943360
    s_mov_b32 s65, 7
    buffer_store_dword v251, v252, s[36:39], s66 offen sc1
    s_branch L_t0_loop
L_ty1:
    s_lshl_b32 s66, s48, 4
    s_mul_i32 s67, s52, 160
    v_add_u32 v2, 0, v1
    v_mul_u32_u24 v3, 5462, v2
    v_lshrrev_b32 v3, 16, v3
    v_mul_u32_u24 v4, 12, v3
    v_sub_u32 v4, v2, v4
    v_bfe_u32 v5, v3, 2, 1
    v_and_b32 v6, 3, v3
    v_lshl_add_u32 v6, v5, 3, v6
    v_bfe_u32 v7, v3, 3, 1
    v_lshl_add_u32 v6, v7, 2, v6
    v_add_u32 v6, s66, v6
    v_lshlrev_b32 v5, 1, v5
    v_xor_b32 v4, v4, v5
    v_mul_u32_u24 v6, 3840, v6
    v_cmp_lt_u32 vcc, 5, v4
    v_lshl_add_u32 v6, v4, 4, v6
    v_add_u32 v6, s67, v6
    v_cndmask_b32 v7, 0, 16, vcc
    v_sub_u32 v6, v6, v7
    v_cmp_eq_u32 vcc, 5, v4
    v_cmp_eq_u32 s[74:75], 11, v4
    v_subrev_u32 v6, 0, v6
    s_or_b64 vcc, vcc, s[74:75]
    v_mov_b32 v7, 1073741824
    v_cndmask_b32 v192, v6, v7, vcc
    s_add_u32 m0, s60, s63
    s_nop 0
    buffer_load_dwordx4 v192, s[28:31], s58 offen offset:0 lds
    v_add_u32 v2, 64, v1
    v_mul_u32_u24 v3, 5462, v2
    v_lshrrev_b32 v3, 16, v3
    v_mul_u32_u24 v4, 12, v3
    v_sub_u32 v4, v2, v4
    v_bfe_u32 v5, v3, 2, 1
    v_and_b32 v6, 3, v3
    v_lshl_add_u32 v6, v5, 3, v6
    v_bfe_u32 v7, v3, 3, 1
    v_lshl_add_u32 v6, v7, 2, v6
    v_add_u32 v6, s66, v6
    v_lshlrev_b32 v5, 1, v5
    v_xor_b32 v4, v4, v5
    v_mul_u32_u24 v6, 3840, v6
    v_cmp_lt_u32 vcc, 5, v4
    v_lshl_add_u32 v6, v4, 4, v6
    v_add_u32 v6, s67, v6
    v_cndmask_b32 v7, 0, 16, vcc
    v_sub_u32 v6, v6, v7
    v_cmp_eq_u32 vcc, 5, v4
    v_cmp_eq_u32 s[74:75], 11, v4
    v_subrev_u32 v6, 1024, v6
    s_or_b64 vcc, vcc, s[74:75]
    v_mov_b32 v7, 1073741824
    v_cndmask_b32 v193, v6, v7, vcc
    buffer_load_dwordx4 v193, s[28:31], s58 offen offset:1024 lds
    v_add_u32 v2, 128, v1
    v_mul_u32_u24 v3, 5462, v2
    v_lshrrev_b32 v3, 16, v3
    v_mul_u32_u24 v4, 12, v3
    v_sub_u32 v4, v2, v4
    v_bfe_u32 v5, v3, 2, 1
    v_and_b32 v6, 3, v3
    v_lshl_add_u32 v6, v5, 3, v6
    v_bfe_u32 v7, v3, 3, 1
    v_lshl_add_u32 v6, v7, 2, v6
    v_add_u32 v6, s66, v6
    v_lshlrev_b32 v5, 1, v5
    v_xor_b32 v4, v4, v5
    v_mul_u32_u24 v6, 3840, v6
    v_cmp_lt_u32 vcc, 5, v4
    v_lshl_add_u32 v6, v4, 4, v6
    v_add_u32 v6, s67, v6
    v_cndmask_b32 v7, 0, 16, vcc
    v_sub_u32 v6, v6, v7
    v_cmp_eq_u32 vcc, 5, v4
    v_cmp_eq_u32 s[74:75], 11, v4
    v_subrev_u32 v6, 2048, v6
    s_or_b64 vcc, vcc, s[74:75]
    v_mov_b32 v7, 1073741824
    v_cndmask_b32 v194, v6, v7, vcc
    buffer_load_dwordx4 v194, s[28:31], s58 offen offset:2048 lds
    v_add_u32 v2, 0, v1
    v_lshrrev_b32 v3, 4, v2
    v_and_b32 v4, 15, v2
    v_bfe_u32 v5, v3, 2, 1
    v_and_b32 v6, 3, v3
    v_lshl_add_u32 v6, v5, 3, v6
    v_bfe_u32 v7, v3, 3, 1
    v_lshl_add_u32 v6, v7, 2, v6
    v_add_u32 v6, s66, v6
    v_and_b32 v5, 7, v3
    v_lshlrev_b32 v5, 1, v5
    v_xor_b32 v4, v4, v5
    v_mul_u32_u24 v6, 3072, v6
    v_lshl_add_u32 v6, v4, 4, v6
    v_add_u32 v6, s64, v6
    v_subrev_u32 v195, 0, v6
    s_mul_i32 s58, s3, 245760
    s_add_u32 m0, m0, 3072
    s_nop 0
    buffer_load_dwordx4 v195, s[32:35], s59 offen offset:0 lds
    v_add_u32 v2, 64, v1
    v_lshrrev_b32 v3, 4, v2
    v_and_b32 v4, 15, v2
    v_bfe_u32 v5, v3, 2, 1
    v_and_b32 v6, 3, v3
    v_lshl_add_u32 v6, v5, 3, v6
    v_bfe_u32 v7, v3, 3, 1
    v_lshl_add_u32 v6, v7, 2, v6
    v_add_u32 v6, s66, v6
    v_and_b32 v5, 7, v3
    v_lshlrev_b32 v5, 1, v5
    v_xor_b32 v4, v4, v5
    v_mul_u32_u24 v6, 3072, v6
    v_lshl_add_u32 v6, v4, 4, v6
    v_add_u32 v6, s64, v6
    v_subrev_u32 v196, 1024, v6
    buffer_load_dwordx4 v196, s[32:35], s59 offen offset:1024 lds
    v_add_u32 v2, 128, v1
    v_lshrrev_b32 v3, 4, v2
    v_and_b32 v4, 15, v2
    v_bfe_u32 v5, v3, 2, 1
    v_and_b32 v6, 3, v3
    v_lshl_add_u32 v6, v5, 3, v6
    v_bfe_u32 v7, v3, 3, 1
    v_lshl_add_u32 v6, v7, 2, v6
    v_add_u32 v6, s66, v6
    v_and_b32 v5, 7, v3
    v_lshlrev_b32 v5, 1, v5
    v_xor_b32 v4, v4, v5
    v_mul_u32_u24 v6, 3072, v6
    v_lshl_add_u32 v6, v4, 4, v6
    v_add_u32 v6, s64, v6
    v_subrev_u32 v197, 2048, v6
    buffer_load_dwordx4 v197, s[32:35], s59 offen offset:2048 lds
    v_add_u32 v2, 192, v1
    v_lshrrev_b32 v3, 4, v2
    v_and_b32 v4, 15, v2
    v_bfe_u32 v5, v3, 2, 1
    v_and_b32 v6, 3, v3
    v_lshl_add_u32 v6, v5, 3, v6
    v_bfe_u32 v7, v3, 3, 1
    v_lshl_add_u32 v6, v7, 2, v6
    v_add_u32 v6, s66, v6
    v_and_b32 v5, 7, v3
    v_lshlrev_b32 v5, 1, v5
    v_xor_b32 v4, v4, v5
    v_mul_u32_u24 v6, 3072, v6
    v_lshl_add_u32 v6, v4, 4, v6
    v_add_u32 v6, s64, v6
    v_subrev_u32 v198, 3072, v6
    buffer_load_dwordx4 v198, s[32:35], s59 offen offset:3072 lds
    s_mul_i32 s59, s3, 196608
    s_and_b32 s66, s2, 1
    s_lshr_b32 s67, s2, 3
    s_bfe_u32 s68, s2, 0x20001
    s_mul_i32 s71, s67, 52
    s_lshr_b32 s71, s71, 8
    s_add_u32 s71, s71, s66
    s_mul_i32 s71, s71, 5
    s_mul_i32 s70, s66, 12
    s_add_u32 s70, s70, 15
    s_cmp_lt_u32 s67, 15
    s_cselect_b32 s71, s71, s70
    s_add_u32 s71, s71, s67
    s_mov_b32 s42, 1966080
    s_movk_i32 s23, 3072
    s_cmp_lt_u32 s71, 30
    s_cselect_b32 s23, 3840, s23
    s_cselect_b32 s69, 0, 30
    s_cselect_b32 s40, s6, s12
    s_cselect_b32 s41, s7, s13
    s_cselect_b32 s42, 2457600, s42
    s_mov_b32 s43, 0x20000
    s_cmp_lt_u32 s2, 216
    s_cselect_b32 s42, s42, 0
    s_sub_u32 s69, s71, s69
    s_lshl_b32 s69, s69, 7
    s_mul_i32 s70, s68, 160
    s_mul_i32 s22, s48, 40
    s_add_u32 s70, s70, s22
    s_mul_i32 s70, s70, s23
    s_add_u32 s22, s70, s69
    v_lshrrev_b32 v2, 3, v1
    v_lshrrev_b32 v3, 4, v1
    v_and_b32 v4, 7, v1
    v_lshlrev_b32 v3, 1, v3
    v_xor_b32 v4, v4, v3
    v_mul_u32_u24 v2, s23, v2
    v_lshl_add_u32 v10, v4, 4, v2
    s_lshl_b32 s23, s23, 3
    s_mov_b32 s60, 45056
    s_mul_i32 s70, s48, 5120
    s_add_u32 m0, s70, 135168
    v_mov_b32 v6, 0
    buffer_load_dwordx4 v10, s[40:43], s22 offen lds
    s_add_u32 m0, m0, 1024
    s_add_u32 s22, s22, s23
    buffer_load_dwordx4 v10, s[40:43], s22 offen lds
    s_add_u32 m0, m0, 1024
    s_add_u32 s22, s22, s23
    buffer_load_dwordx4 v10, s[40:43], s22 offen lds
    s_add_u32 m0, m0, 1024
    s_add_u32 s22, s22, s23
    buffer_load_dwordx4 v10, s[40:43], s22 offen lds
    s_add_u32 m0, m0, 1024
    s_add_u32 s22, s22, s23
    buffer_load_dwordx4 v10, s[40:43], s22 offen lds
    s_mov_b32 s36, s20
    s_mov_b32 s37, s21
    s_mov_b32 s38, 13412352
    s_mov_b32 s39, 0x20000
    s_mov_b32 s70, 13277184
    buffer_load_dword v207, v6, s[36:39], s70 offen sc1
    s_mov_b32 s44, s16
    s_mov_b32 s45, s17
    s_mov_b32 s46, 2621440
    s_mov_b32 s47, 0x20000
    s_lshl_b32 s69, s71, 8
    s_mul_i32 s70, s68, 13824
    s_add_u32 s69, s69, s70
    s_add_u32 s69, s69, 12812288
    s_cmp_lt_u32 s2, 216
    s_cselect_b32 s69, s69, 1073741824
    v_add_u32 v247, s69, v254
    s_lshl_b32 s69, s48, 6
    s_add_u32 s69, s69, 159744
    v_lshlrev_b32 v2, 2, v1
    v_add_u32 v2, s69, v2
    v_cmp_gt_u32 vcc, 16, v1
    v_mov_b32 v12, 160512
    s_and_b32 s49, s48, 1
    v_cndmask_b32 v12, v12, v2, vcc
    v_lshrrev_b32 v2, 2, v1
    v_bfe_u32 v3, v1, 3, 2
    v_xor_b32 v3, s48, v3
    v_lshlrev_b32 v3, 5, v3
    v_lshl_add_u32 v3, v2, 7, v3
    v_and_b32 v2, 3, v1
    v_lshl_add_u32 v3, v2, 3, v3
    v_add_u32 v13, 135168, v3
    v_cmp_eq_u32 vcc, 0, v0
    s_lshr_b32 s50, s48, 1
    s_mov_b32 s72, 0
    s_mov_b32 s73, -1
    v_cndmask_b32 v252, v9, 0, vcc
    s_and_b32 s69, s2, 7
    s_lshl_b32 s69, s69, 4
    s_bfe_u32 s70, s2, 0x20003
    s_add_u32 s69, s69, s70
    s_lshr_b32 s70, s2, 6
    s_lshl_b32 s70, s70, 2
    s_add_u32 s69, s69, s70
    s_lshl_b32 s69, s69, 4
    s_lshl_b32 s70, s48, 2
    v_lshrrev_b32 v2, 4, v1
    v_add_u32 v2, s70, v2
    v_add_u32 v4, s69, v2
    v_and_b32 v3, 15, v1
    v_mul_u32_u24 v4, 1280, v4
    v_lshl_add_u32 v7, v3, 4, v4
    v_add_u32 v2, s69, v2
    v_lshlrev_b32 v2, 5, v2
    v_lshl_add_u32 v2, v3, 4, v2
    v_cmp_gt_u32 vcc, 2, v3
    v_add_u32 v2, 12877824, v2
    v_mov_b32 v8, v7
    v_cndmask_b32 v11, v9, v2, vcc
    buffer_load_dwordx4 v[208:211], v8, s[24:27], 0 offen offset:0
    buffer_load_dwordx4 v[212:215], v8, s[24:27], 0 offen offset:256
    buffer_load_dwordx4 v[216:219], v8, s[24:27], 0 offen offset:512
    buffer_load_dwordx4 v[220:223], v8, s[24:27], 0 offen offset:768
    buffer_load_dwordx4 v[224:227], v8, s[24:27], 0 offen offset:1024
    v_cmp_gt_u32 vcc, 16, v0
    s_nop 1
    v_cndmask_b32 v247, v9, v247, vcc
    v_bfe_u32 v2, v1, 4, 1
    v_bfe_u32 v3, v1, 2, 2
    v_lshl_add_u32 v3, v2, 2, v3
    v_lshrrev_b32 v4, 5, v1
    v_mul_u32_u24 v4, 7168, v4
    v_and_b32 v5, 3, v1
    v_lshl_add_u32 v4, v5, 3, v4
    v_add_u32 v4, 16384, v4
    v_mul_u32_u24 v5, 192, v3
    v_add_u32 v5, v5, v4
    s_mul_i32 s68, s50, 3
    s_add_u32 s69, s68, 1
    v_xor_b32 v6, s68, v2
    v_lshl_add_u32 v201, v6, 5, v5
    v_xor_b32 v6, s69, v2
    v_lshl_add_u32 v202, v6, 5, v5
    v_mul_u32_u24 v5, 256, v3
    v_add_u32 v5, v5, v4
    v_add_u32 v5, 3072, v5
    s_mul_i32 s68, s50, 4
    v_mov_b32 v6, v3
    s_add_u32 m0, s60, s62
    s_nop 0
    buffer_load_dwordx4 v188, s[24:27], s57 offen offset:0 lds
    v_xor_b32 v6, s68, v6
    v_xor_b32 v7, 0, v6
    v_lshl_add_u32 v203, v7, 5, v5
    v_xor_b32 v7, 1, v6
    v_lshl_add_u32 v204, v7, 5, v5
    v_xor_b32 v7, 2, v6
    v_lshl_add_u32 v205, v7, 5, v5
    v_xor_b32 v7, 3, v6
    v_lshl_add_u32 v206, v7, 5, v5
    v_and_b32 v2, 15, v1
    v_bfe_u32 v3, v1, 1, 3
    v_lshrrev_b32 v4, 4, v1
    v_xor_b32 v3, v3, v4
    s_lshl_b32 s68, s49, 13
    buffer_load_dwordx4 v189, s[24:27], s57 offen offset:1024 lds
    v_lshlrev_b32 v5, 7, v2
    v_add_u32 v5, s68, v5
    v_lshl_add_u32 v199, v3, 4, v5
    v_xor_b32 v3, 4, v3
    v_lshl_add_u32 v200, v3, 4, v5
    s_lshl_b32 s66, s51, 3
    s_add_u32 s66, s66, s52
    s_mul_i32 s66, s66, 3
    s_add_u32 s66, s66, s48
    s_cmp_eq_u32 s48, 3
    s_cselect_b32 s66, 340, s66
    s_min_u32 s66, s66, 340
    s_mul_i32 s22, s66, 52429
    s_lshr_b32 s22, s22, 18
    s_mul_i32 s67, s22, 5
    s_sub_u32 s23, s66, s67
    buffer_load_dwordx4 v190, s[24:27], s57 offen offset:2048 lds
    s_sub_u32 s67, s22, 48
    s_mul_i32 s68, s67, 52
    s_lshr_b32 s68, s68, 8
    s_mul_i32 s69, s68, 5
    s_sub_u32 s69, s67, s69
    s_mul_i32 s68, s68, 160
    s_mul_i32 s70, s69, 40
    s_mov_b32 s10, 20
    s_cmp_eq_u32 s69, 4
    s_cselect_b32 s70, 16, s70
    s_cselect_b32 s11, 40, 4
    s_add_u32 s68, s68, s70
    s_mul_i32 s67, s22, 43
    s_lshr_b32 s67, s67, 9
    s_mul_i32 s69, s67, 12
    s_sub_u32 s69, s22, s69
    buffer_load_dwordx4 v191, s[24:27], s57 offen offset:3072 lds
    s_and_b32 s70, s67, 1
    s_lshr_b32 s67, s67, 1
    s_mul_i32 s67, s67, 768
    s_lshl_b32 s71, s70, 7
    s_sub_u32 s71, s71, 256
    s_lshl_b32 s70, s70, 8
    s_add_u32 s70, s70, 256
    s_cmp_lt_u32 s69, 8
    s_cselect_b32 s70, s70, s71
    s_lshl_b32 s69, s69, 5
    s_add_u32 s70, s70, s69
    s_add_u32 s70, s70, s67
    s_mov_b32 s67, 1966080
    s_cmp_ge_u32 s22, 48
    s_cselect_b32 s68, s68, s70
    s_cselect_b32 s10, s10, 16
    s_cselect_b32 s11, s11, 4
    s_cselect_b32 s40, s8, s14
    s_cselect_b32 s41, s9, s15
    s_cselect_b32 s42, 819200, s67
    s_lshl_b32 s69, s48, 13
    s_add_u32 s3, s3, 1
    s_cmp_eq_u32 s3, 10
    s_cselect_b32 s3, 0, s3
    s_lshl_b32 s57, s3, 7
    s_add_u32 m0, s60, s63
    s_nop 0
    buffer_load_dwordx4 v192, s[28:31], s58 offen offset:0 lds
    s_add_u32 s69, s69, 135168
    s_cmp_eq_u32 s66, 340
    s_cselect_b32 s42, 0, s42
    s_cselect_b32 s71, 1073741824, 0
    s_cselect_b32 s101, 160768, s69
    s_mul_i32 s68, s68, 1280
    s_lshl_b32 s70, s23, 8
    s_add_u32 s68, s68, s70
    s_mul_i32 s10, s10, 1280
    s_mul_i32 s11, s11, 1280
    v_add_u32 v15, s71, v254
    v_lshrrev_b32 v2, 4, v1
    v_and_b32 v3, 15, v1
    v_lshlrev_b32 v4, 1, v2
    v_xor_b32 v3, v3, v4
    v_mul_u32_u24 v2, 1280, v2
    v_lshl_add_u32 v5, v3, 4, v2
    buffer_load_dwordx4 v193, s[28:31], s58 offen offset:1024 lds
    v_xor_b32 v3, 8, v3
    v_lshl_add_u32 v6, v3, 4, v2
    s_mul_i32 s66, s11, 0
    s_add_u32 s66, s66, s68
    v_add_u32 v232, s66, v5
    s_mul_i32 s66, s11, 1
    s_add_u32 s66, s66, s68
    v_add_u32 v233, s66, v6
    s_mul_i32 s66, s11, 2
    s_add_u32 s66, s66, s68
    v_add_u32 v234, s66, v5
    s_mul_i32 s66, s11, 3
    s_add_u32 s66, s66, s68
    v_add_u32 v235, s66, v6
    buffer_load_dwordx4 v194, s[28:31], s58 offen offset:2048 lds
    s_add_u32 s68, s68, s10
    s_mul_i32 s66, s11, 0
    s_add_u32 s66, s66, s68
    v_add_u32 v236, s66, v5
    s_mul_i32 s66, s11, 1
    s_add_u32 s66, s66, s68
    v_add_u32 v237, s66, v6
    s_mul_i32 s66, s11, 2
    s_add_u32 s66, s66, s68
    v_add_u32 v238, s66, v5
    s_mul_i32 s66, s11, 3
    s_add_u32 s66, s66, s68
    v_add_u32 v239, s66, v6
    v_bfe_u32 v2, v1, 4, 1
    v_bfe_u32 v3, v1, 2, 2
    v_lshl_add_u32 v2, v2, 2, v3
    v_lshrrev_b32 v3, 4, v1
    v_bfe_u32 v4, v1, 2, 2
    v_lshl_add_u32 v3, v3, 2, v4
    v_lshlrev_b32 v2, 5, v2
    v_lshl_add_u32 v2, v3, 8, v2
    v_and_b32 v3, 3, v1
    v_lshl_add_u32 v2, v3, 3, v2
    s_min_u32 s69, s69, 151552
    v_add_u32 v14, s69, v2
    s_mul_i32 s22, s22, 40960
    s_lshl_b32 s23, s23, 13
    s_add_u32 s22, s22, s23
    s_add_u32 s22, s22, 9961472
    s_add_u32 s23, s22, 4096
    v_mov_b32 v240, 0x3f803f80
    v_mov_b32 v241, 0x3f803f80
    v_mov_b32 v242, 0x3f803f80
    v_mov_b32 v243, 0x3f803f80
    v_mov_b64 v[16:17], 0
    v_mov_b64 v[18:19], 0
    v_mov_b64 v[20:21], 0
    v_mov_b64 v[22:23], 0
    v_mov_b64 v[24:25], 0
    v_mov_b64 v[26:27], 0
    v_mov_b64 v[28:29], 0
    v_mov_b64 v[30:31], 0
    v_mov_b64 v[32:33], 0
    v_mov_b64 v[34:35], 0
    v_mov_b64 v[36:37], 0
    v_mov_b64 v[38:39], 0
    v_mov_b64 v[40:41], 0
    v_mov_b64 v[42:43], 0
    v_mov_b64 v[44:45], 0
    v_mov_b64 v[46:47], 0
    v_mov_b64 v[48:49], 0
    v_mov_b64 v[50:51], 0
    v_mov_b64 v[52:53], 0
    v_mov_b64 v[54:55], 0
    v_mov_b64 v[56:57], 0
    v_mov_b64 v[58:59], 0
    v_mov_b64 v[60:61], 0
    v_mov_b64 v[62:63], 0
    v_mov_b64 v[64:65], 0
    v_mov_b64 v[66:67], 0
    v_mov_b64 v[68:69], 0
    v_mov_b64 v[70:71], 0
    v_mov_b64 v[72:73], 0
    v_mov_b64 v[74:75], 0
    v_mov_b64 v[76:77], 0
    v_mov_b64 v[78:79], 0
    v_mov_b64 v[80:81], 0
    v_mov_b64 v[82:83], 0
    v_mov_b64 v[84:85], 0
    v_mov_b64 v[86:87], 0
    v_mov_b64 v[88:89], 0
    v_mov_b64 v[90:91], 0
    v_mov_b64 v[92:93], 0
    v_mov_b64 v[94:95], 0
    v_mov_b64 v[96:97], 0
    v_mov_b64 v[98:99], 0
    v_mov_b64 v[100:101], 0
    v_mov_b64 v[102:103], 0
    v_mov_b64 v[104:105], 0
    v_mov_b64 v[106:107], 0
    v_mov_b64 v[108:109], 0
    v_mov_b64 v[110:111], 0
    v_mov_b64 v[112:113], 0
    v_mov_b64 v[114:115], 0
    v_mov_b64 v[116:117], 0
    v_mov_b64 v[118:119], 0
    v_mov_b64 v[120:121], 0
    v_mov_b64 v[122:123], 0
    v_mov_b64 v[124:125], 0
    v_mov_b64 v[126:127], 0
    s_waitcnt vmcnt(18)
    s_barrier
    ds_read_b128 v[128:131], v199 offset:0
    ds_read_b128 v[132:135], v199 offset:2048
    ds_read_b128 v[136:139], v199 offset:4096
    s_mul_i32 s58, s3, 245760
    s_add_u32 m0, m0, 3072
    s_nop 0
    buffer_load_dwordx4 v195, s[32:35], s59 offen offset:0 lds
    ds_read_b128 v[140:143], v199 offset:6144
    ds_read_b64_tr_b16 v[160:161], v201 offset:0
    ds_read_b64_tr_b16 v[162:163], v201 offset:1536
    buffer_load_dwordx4 v196, s[32:35], s59 offen offset:1024 lds
    ds_read_b64_tr_b16 v[164:165], v202 offset:0
    ds_read_b64_tr_b16 v[166:167], v202 offset:1536
    ds_read_b64_tr_b16 v[168:169], v201 offset:64
    buffer_load_dwordx4 v197, s[32:35], s59 offen offset:2048 lds
    ds_read_b64_tr_b16 v[170:171], v201 offset:1600
    ds_read_b64_tr_b16 v[172:173], v203 offset:0
    ds_read_b64_tr_b16 v[174:175], v203 offset:2048
    buffer_load_dwordx4 v198, s[32:35], s59 offen offset:3072 lds
    ds_read_b64_tr_b16 v[176:177], v204 offset:0
    ds_read_b64_tr_b16 v[178:179], v204 offset:2048
    ds_read_b64_tr_b16 v[180:181], v205 offset:0
    s_mul_i32 s59, s3, 196608
    s_mov_b32 s60, 90112
    s_add_u32 m0, s60, s62
    s_nop 0
    buffer_load_dwordx4 v188, s[24:27], s57 offen offset:0 lds
    ds_read_b64_tr_b16 v[182:183], v205 offset:2048
    ds_read_b64_tr_b16 v[184:185], v206 offset:0
    ds_read_b64_tr_b16 v[186:187], v206 offset:2048
    buffer_load_dwordx4 v189, s[24:27], s57 offen offset:1024 lds
    buffer_load_dwordx4 v190, s[24:27], s57 offen offset:2048 lds
    buffer_load_dwordx4 v191, s[24:27], s57 offen offset:3072 lds
    s_add_u32 s3, s3, 1
    s_cmp_eq_u32 s3, 10
    s_cselect_b32 s3, 0, s3
    s_lshl_b32 s57, s3, 7
    s_add_u32 m0, s60, s63
    s_nop 0
    buffer_load_dwordx4 v192, s[28:31], s58 offen offset:0 lds
    buffer_load_dwordx4 v193, s[28:31], s58 offen offset:1024 lds
    s_mov_b32 s56, 0
    s_mov_b32 s55, 0
    s_mov_b32 s65, 1
    s_mov_b32 s100, 0
    s_mov_b32 s19, 12943360
L_t1_loop:
    s_waitcnt lgkmcnt(0)
    v_mfma_f32_16x16x32_bf16 v[16:19], v[160:163], v[128:131], v[16:19]
    ds_read_b64_tr_b16 a[240:241], v205 offset:14336
    v_mfma_f32_16x16x32_bf16 v[20:23], v[160:163], v[132:135], v[20:23]
    ds_read_b128 v[144:147], v200 offset:0
    v_mfma_f32_16x16x32_bf16 v[24:27], v[160:163], v[136:139], v[24:27]
    buffer_load_dwordx4 v194, s[28:31], s58 offen offset:2048 lds
    v_mfma_f32_16x16x32_bf16 v[28:31], v[160:163], v[140:143], v[28:31]
    ds_read_b64_tr_b16 v[160:161], v201 offset:14336
    s_mul_i32 s58, s3, 245760
    v_mfma_f32_16x16x32_bf16 v[32:35], v[164:167], v[128:131], v[32:35]
    ds_read_b64_tr_b16 v[162:163], v201 offset:15872
    s_mov_b32 s61, 45056
    v_mfma_f32_16x16x32_bf16 v[36:39], v[164:167], v[132:135], v[36:39]
    ds_read_b128 v[148:151], v200 offset:2048
    v_mfma_f32_16x16x32_bf16 v[40:43], v[164:167], v[136:139], v[40:43]
    ds_read_b64_tr_b16 a[242:243], v205 offset:16384
    v_mfma_f32_16x16x32_bf16 v[44:47], v[164:167], v[140:143], v[44:47]
    ds_read_b64_tr_b16 v[164:165], v202 offset:14336
    v_mfma_f32_16x16x32_bf16 v[48:51], v[168:171], v[128:131], v[48:51]
    ds_read_b64_tr_b16 v[166:167], v202 offset:15872
    v_mfma_f32_16x16x32_bf16 v[52:55], v[168:171], v[132:135], v[52:55]
    ds_read_b128 v[152:155], v200 offset:4096
    s_add_u32 m0, m0, 3072
    v_mfma_f32_16x16x32_bf16 v[56:59], v[168:171], v[136:139], v[56:59]
    buffer_load_dwordx4 v195, s[32:35], s59 offen offset:0 lds
    v_mfma_f32_16x16x32_bf16 v[60:63], v[168:171], v[140:143], v[60:63]
    ds_read_b64_tr_b16 v[168:169], v201 offset:14400
    v_mfma_f32_16x16x32_bf16 v[64:67], v[172:175], v[128:131], v[64:67]
    ds_read_b64_tr_b16 v[170:171], v201 offset:15936
    s_cmp_eq_u32 s56, 90112
    s_cmov_b32 s61, 4294877184
    v_mfma_f32_16x16x32_bf16 v[68:71], v[172:175], v[132:135], v[68:71]
    ds_read_b128 v[156:159], v200 offset:6144
    v_mfma_f32_16x16x32_bf16 v[72:75], v[172:175], v[136:139], v[72:75]
    buffer_load_dwordx4 v196, s[32:35], s59 offen offset:1024 lds
    v_mfma_f32_16x16x32_bf16 v[76:79], v[172:175], v[140:143], v[76:79]
    ds_read_b64_tr_b16 v[172:173], v203 offset:14336
    v_mfma_f32_16x16x32_bf16 v[80:83], v[176:179], v[128:131], v[80:83]
    ds_read_b64_tr_b16 v[174:175], v203 offset:16384
    s_mov_b32 s60, s56
    v_mfma_f32_16x16x32_bf16 v[84:87], v[176:179], v[132:135], v[84:87]
    ds_read_b64_tr_b16 a[244:245], v206 offset:14336
    v_add_u32 v199, s61, v199
    v_mfma_f32_16x16x32_bf16 v[88:91], v[176:179], v[136:139], v[88:91]
    ds_read_b64_tr_b16 a[246:247], v206 offset:16384
    v_mfma_f32_16x16x32_bf16 v[92:95], v[176:179], v[140:143], v[92:95]
    ds_read_b64_tr_b16 v[176:177], v204 offset:14336
    v_mfma_f32_16x16x32_bf16 v[96:99], v[180:183], v[128:131], v[96:99]
    ds_read_b64_tr_b16 v[178:179], v204 offset:16384
    v_mfma_f32_16x16x32_bf16 v[100:103], v[180:183], v[132:135], v[100:103]
    v_mfma_f32_16x16x32_bf16 v[104:107], v[180:183], v[136:139], v[104:107]
    buffer_load_dwordx4 v197, s[32:35], s59 offen offset:2048 lds
    v_add_u32 v206, s61, v206
    v_mfma_f32_16x16x32_bf16 v[108:111], v[180:183], v[140:143], v[108:111]
    v_add_u32 v205, s61, v205
    v_mfma_f32_16x16x32_bf16 v[112:115], v[184:187], v[128:131], v[112:115]
    v_add_u32 v202, s61, v202
    v_add_u32 v201, s61, v201
    v_mfma_f32_16x16x32_bf16 v[116:119], v[184:187], v[132:135], v[116:119]
    v_add_u32 v203, s61, v203
    v_mfma_f32_16x16x32_bf16 v[120:123], v[184:187], v[136:139], v[120:123]
    buffer_load_dwordx4 v198, s[32:35], s59 offen offset:3072 lds
    v_add_u32 v204, s61, v204
    v_mfma_f32_16x16x32_bf16 v[124:127], v[184:187], v[140:143], v[124:127]
    s_mul_i32 s59, s3, 196608
    v_add_u32 v200, s61, v200
    s_cmp_eq_u32 s100, 0
    s_cbranch_scc0 L_t1_rlx
    s_waitcnt vmcnt(11) lgkmcnt(0)
L_t1_back:
    s_barrier
    v_mfma_f32_16x16x32_bf16 v[16:19], v[160:163], v[144:147], v[16:19]
    ds_read_b64_tr_b16 v[180:181], v205 offset:0
    v_mfma_f32_16x16x32_bf16 v[20:23], v[160:163], v[148:151], v[20:23]
    ds_read_b128 v[128:131], v199 offset:0
    s_add_u32 m0, s60, s62
    v_mfma_f32_16x16x32_bf16 v[24:27], v[160:163], v[152:155], v[24:27]
    buffer_load_dwordx4 v188, s[24:27], s57 offen offset:0 lds
    v_mfma_f32_16x16x32_bf16 v[28:31], v[160:163], v[156:159], v[28:31]
    ds_read_b64_tr_b16 v[160:161], v201 offset:0
    v_mfma_f32_16x16x32_bf16 v[32:35], v[164:167], v[144:147], v[32:35]
    ds_read_b64_tr_b16 v[162:163], v201 offset:1536
    s_add_u32 s55, s55, 1
    v_mfma_f32_16x16x32_bf16 v[36:39], v[164:167], v[148:151], v[36:39]
    s_add_u32 s56, s56, s61
    ds_read_b128 v[132:135], v199 offset:2048
    v_mfma_f32_16x16x32_bf16 v[40:43], v[164:167], v[152:155], v[40:43]
    ds_read_b64_tr_b16 v[182:183], v205 offset:2048
    v_mfma_f32_16x16x32_bf16 v[44:47], v[164:167], v[156:159], v[44:47]
    ds_read_b64_tr_b16 v[164:165], v202 offset:0
    v_mfma_f32_16x16x32_bf16 v[48:51], v[168:171], v[144:147], v[48:51]
    ds_read_b64_tr_b16 v[166:167], v202 offset:1536
    v_mfma_f32_16x16x32_bf16 v[52:55], v[168:171], v[148:151], v[52:55]
    ds_read_b128 v[136:139], v199 offset:4096
    v_mfma_f32_16x16x32_bf16 v[56:59], v[168:171], v[152:155], v[56:59]
    buffer_load_dwordx4 v189, s[24:27], s57 offen offset:1024 lds
    v_mfma_f32_16x16x32_bf16 v[60:63], v[168:171], v[156:159], v[60:63]
    ds_read_b64_tr_b16 v[168:169], v201 offset:64
    v_mfma_f32_16x16x32_bf16 v[64:67], v[172:175], v[144:147], v[64:67]
    ds_read_b64_tr_b16 v[170:171], v201 offset:1600
    v_mfma_f32_16x16x32_bf16 v[68:71], v[172:175], v[148:151], v[68:71]
    ds_read_b128 v[140:143], v199 offset:6144
    v_mfma_f32_16x16x32_bf16 v[72:75], v[172:175], v[152:155], v[72:75]
    buffer_load_dwordx4 v190, s[24:27], s57 offen offset:2048 lds
    v_mfma_f32_16x16x32_bf16 v[76:79], v[172:175], v[156:159], v[76:79]
    ds_read_b64_tr_b16 v[172:173], v203 offset:0
    v_mfma_f32_16x16x32_bf16 v[80:83], v[176:179], v[144:147], v[80:83]
    ds_read_b64_tr_b16 v[174:175], v203 offset:2048
    v_mfma_f32_16x16x32_bf16 v[84:87], v[176:179], v[148:151], v[84:87]
    ds_read_b64_tr_b16 v[184:185], v206 offset:0
    v_mfma_f32_16x16x32_bf16 v[88:91], v[176:179], v[152:155], v[88:91]
    ds_read_b64_tr_b16 v[186:187], v206 offset:2048
    v_mfma_f32_16x16x32_bf16 v[92:95], v[176:179], v[156:159], v[92:95]
    ds_read_b64_tr_b16 v[176:177], v204 offset:0
    v_mfma_f32_16x16x32_bf16 v[96:99], a[240:243], v[144:147], v[96:99]
    ds_read_b64_tr_b16 v[178:179], v204 offset:2048
    v_mfma_f32_16x16x32_bf16 v[100:103], a[240:243], v[148:151], v[100:103]
    buffer_load_dwordx4 v191, s[24:27], s57 offen offset:3072 lds
    v_mfma_f32_16x16x32_bf16 v[104:107], a[240:243], v[152:155], v[104:107]
    s_add_u32 s3, s3, 1
    s_cmp_eq_u32 s3, 10
    s_cselect_b32 s3, 0, s3
    s_lshl_b32 s57, s3, 7
    v_mfma_f32_16x16x32_bf16 v[108:111], a[240:243], v[156:159], v[108:111]
    s_add_u32 m0, s60, s63
    v_mfma_f32_16x16x32_bf16 v[112:115], a[244:247], v[144:147], v[112:115]
    buffer_load_dwordx4 v192, s[28:31], s58 offen offset:0 lds
    v_mfma_f32_16x16x32_bf16 v[116:119], a[244:247], v[148:151], v[116:119]
    v_mfma_f32_16x16x32_bf16 v[120:123], a[244:247], v[152:155], v[120:123]
    buffer_load_dwordx4 v193, s[28:31], s58 offen offset:1024 lds
    v_mfma_f32_16x16x32_bf16 v[124:127], a[244:247], v[156:159], v[124:127]
    s_cmp_lt_u32 s55, s65
    s_cbranch_scc1 L_t1_loop
    s_cmp_lg_u32 s65, 7
    s_cbranch_scc1 L_t1_exit
    s_mov_b32 s65, 1073741824
    s_waitcnt lgkmcnt(0)
    v_mfma_f32_16x16x32_bf16 v[16:19], v[160:163], v[128:131], v[16:19]
    ds_read_b64_tr_b16 a[240:241], v205 offset:14336
    v_and_b32 v10, 15, v1
    v_mfma_f32_16x16x32_bf16 v[20:23], v[160:163], v[132:135], v[20:23]
    ds_read_b128 v[144:147], v200 offset:0
    s_lshl_b32 s68, s51, 7
    v_mfma_f32_16x16x32_bf16 v[24:27], v[160:163], v[136:139], v[24:27]
    buffer_load_dwordx4 v194, s[28:31], s58 offen offset:2048 lds
    s_lshl_b32 s69, s49, 6
    v_mfma_f32_16x16x32_bf16 v[28:31], v[160:163], v[140:143], v[28:31]
    ds_read_b64_tr_b16 v[160:161], v201 offset:14336
    s_mul_i32 s58, s3, 245760
    v_mfma_f32_16x16x32_bf16 v[32:35], v[164:167], v[128:131], v[32:35]
    ds_read_b64_tr_b16 v[162:163], v201 offset:15872
    s_mov_b32 s61, 45056
    v_mfma_f32_16x16x32_bf16 v[36:39], v[164:167], v[132:135], v[36:39]
    ds_read_b128 v[148:151], v200 offset:2048
    buffer_load_dwordx4 v[2:5], v254, s[36:39], s19 offen sc1
    v_mfma_f32_16x16x32_bf16 v[40:43], v[164:167], v[136:139], v[40:43]
    ds_read_b64_tr_b16 a[242:243], v205 offset:16384
    s_add_u32 s68, s68, s69
    v_mfma_f32_16x16x32_bf16 v[44:47], v[164:167], v[140:143], v[44:47]
    ds_read_b64_tr_b16 v[164:165], v202 offset:14336
    v_add_u32 v10, s68, v10
    v_mfma_f32_16x16x32_bf16 v[48:51], v[168:171], v[128:131], v[48:51]
    ds_read_b64_tr_b16 v[166:167], v202 offset:15872
    v_lshlrev_b32 v10, 5, v10
    v_mfma_f32_16x16x32_bf16 v[52:55], v[168:171], v[132:135], v[52:55]
    ds_read_b128 v[152:155], v200 offset:4096
    s_add_u32 m0, m0, 3072
    v_mfma_f32_16x16x32_bf16 v[56:59], v[168:171], v[136:139], v[56:59]
    buffer_load_dwordx4 v195, s[32:35], s59 offen offset:0 lds
    v_add_u32 v248, 12877824, v10
    v_mfma_f32_16x16x32_bf16 v[60:63], v[168:171], v[140:143], v[60:63]
    ds_read_b64_tr_b16 v[168:169], v201 offset:14400
    v_cmp_lt_u32 vcc, 111, v0
    v_mfma_f32_16x16x32_bf16 v[64:67], v[172:175], v[128:131], v[64:67]
    ds_read_b64_tr_b16 v[170:171], v201 offset:15936
    s_cmp_eq_u32 s56, 90112
    s_cmov_b32 s61, 4294877184
    v_mfma_f32_16x16x32_bf16 v[68:71], v[172:175], v[132:135], v[68:71]
    ds_read_b128 v[156:159], v200 offset:6144
    s_mul_i32 s68, s52, 80
    v_mfma_f32_16x16x32_bf16 v[72:75], v[172:175], v[136:139], v[72:75]
    buffer_load_dwordx4 v196, s[32:35], s59 offen offset:1024 lds
    s_lshr_b32 s69, s64, 1
    v_mfma_f32_16x16x32_bf16 v[76:79], v[172:175], v[140:143], v[76:79]
    ds_read_b64_tr_b16 v[172:173], v203 offset:14336
    v_cndmask_b32 v10, 0, 1, vcc
    v_mfma_f32_16x16x32_bf16 v[80:83], v[176:179], v[128:131], v[80:83]
    ds_read_b64_tr_b16 v[174:175], v203 offset:16384
    s_mov_b32 s60, s56
    v_mfma_f32_16x16x32_bf16 v[84:87], v[176:179], v[132:135], v[84:87]
    ds_read_b64_tr_b16 a[244:245], v206 offset:14336
    v_add_u32 v199, s61, v199
    v_mfma_f32_16x16x32_bf16 v[88:91], v[176:179], v[136:139], v[88:91]
    ds_read_b64_tr_b16 a[246:247], v206 offset:16384
    v_mul_u32_u24 v11, 112, v10
    v_mfma_f32_16x16x32_bf16 v[92:95], v[176:179], v[140:143], v[92:95]
    ds_read_b64_tr_b16 v[176:177], v204 offset:14336
    v_sub_u32 v11, v0, v11
    v_mfma_f32_16x16x32_bf16 v[96:99], v[180:183], v[128:131], v[96:99]
    ds_read_b64_tr_b16 v[178:179], v204 offset:16384
    v_mul_u32_u24 v12, 40, v10
    v_mfma_f32_16x16x32_bf16 v[100:103], v[180:183], v[132:135], v[100:103]
    v_add_u32 v12, s68, v12
    v_cmp_gt_u32 vcc, 48, v11
    v_mfma_f32_16x16x32_bf16 v[104:107], v[180:183], v[136:139], v[104:107]
    buffer_load_dwordx4 v197, s[32:35], s59 offen offset:2048 lds
    v_add_u32 v206, s61, v206
    v_mfma_f32_16x16x32_bf16 v[108:111], v[180:183], v[140:143], v[108:111]
    v_add_u32 v205, s61, v205
    v_lshlrev_b32 v13, 6, v10
    v_mfma_f32_16x16x32_bf16 v[112:115], v[184:187], v[128:131], v[112:115]
    v_add_u32 v202, s61, v202
    v_add_u32 v201, s61, v201
    v_mfma_f32_16x16x32_bf16 v[116:119], v[184:187], v[132:135], v[116:119]
    v_add_u32 v203, s61, v203
    v_add_u32 v13, s69, v13
    v_mfma_f32_16x16x32_bf16 v[120:123], v[184:187], v[136:139], v[120:123]
    buffer_load_dwordx4 v198, s[32:35], s59 offen offset:3072 lds
    v_add_u32 v204, s61, v204
    v_mfma_f32_16x16x32_bf16 v[124:127], v[184:187], v[140:143], v[124:127]
    s_mul_i32 s59, s3, 196608
    v_add_u32 v200, s61, v200
    s_waitcnt vmcnt(12) lgkmcnt(0)
    s_barrier
    v_mfma_f32_16x16x32_bf16 v[16:19], v[160:163], v[144:147], v[16:19]
    ds_read_b64_tr_b16 v[180:181], v205 offset:0
    v_add_u32 v13, 1872, v13
    v_mfma_f32_16x16x32_bf16 v[20:23], v[160:163], v[148:151], v[20:23]
    ds_read_b128 v[128:131], v199 offset:0
    v_cndmask_b32 v12, v13, v12, vcc
    v_mfma_f32_16x16x32_bf16 v[24:27], v[160:163], v[152:155], v[24:27]
    v_add_u32 v12, v12, v11
    v_lshlrev_b32 v12, 2, v12
    v_mfma_f32_16x16x32_bf16 v[28:31], v[160:163], v[156:159], v[28:31]
    ds_read_b64_tr_b16 v[160:161], v201 offset:0
    v_add_u32 v249, 12812288, v12
    v_mfma_f32_16x16x32_bf16 v[32:35], v[164:167], v[144:147], v[32:35]
    ds_read_b64_tr_b16 v[162:163], v201 offset:1536
    s_lshl_b32 s68, s51, 1
    v_mfma_f32_16x16x32_bf16 v[36:39], v[164:167], v[148:151], v[36:39]
    s_add_u32 s56, s56, s61
    ds_read_b128 v[132:135], v199 offset:2048
    v_mfma_f32_16x16x32_bf16 v[40:43], v[164:167], v[152:155], v[40:43]
    ds_read_b64_tr_b16 v[182:183], v205 offset:2048
    s_add_u32 s17, s68, s53
    v_mfma_f32_16x16x32_bf16 v[44:47], v[164:167], v[156:159], v[44:47]
    ds_read_b64_tr_b16 v[164:165], v202 offset:0
    s_mov_b32 s18, s52
    v_mfma_f32_16x16x32_bf16 v[48:51], v[168:171], v[144:147], v[48:51]
    ds_read_b64_tr_b16 v[166:167], v202 offset:1536
    s_mul_i32 s68, s18, 5120
    v_mfma_f32_16x16x32_bf16 v[52:55], v[168:171], v[148:151], v[52:55]
    ds_read_b128 v[136:139], v199 offset:4096
    s_add_u32 s68, s68, 9961472
    v_mfma_f32_16x16x32_bf16 v[56:59], v[168:171], v[152:155], v[56:59]
    s_mul_i32 s69, s48, 491520
    s_add_u32 s12, s68, s69
    v_mfma_f32_16x16x32_bf16 v[60:63], v[168:171], v[156:159], v[60:63]
    ds_read_b64_tr_b16 v[168:169], v201 offset:64
    s_mul_i32 s69, s48, 204800
    v_mfma_f32_16x16x32_bf16 v[64:67], v[172:175], v[144:147], v[64:67]
    ds_read_b64_tr_b16 v[170:171], v201 offset:1600
    s_add_u32 s13, s68, s69
    v_mfma_f32_16x16x32_bf16 v[68:71], v[172:175], v[148:151], v[68:71]
    ds_read_b128 v[140:143], v199 offset:6144
    s_add_u32 s13, s13, 1966080
    v_mfma_f32_16x16x32_bf16 v[72:75], v[172:175], v[152:155], v[72:75]
    v_mfma_f32_16x16x32_bf16 v[76:79], v[172:175], v[156:159], v[76:79]
    ds_read_b64_tr_b16 v[172:173], v203 offset:0
    v_mfma_f32_16x16x32_bf16 v[80:83], v[176:179], v[144:147], v[80:83]
    ds_read_b64_tr_b16 v[174:175], v203 offset:2048
    v_mfma_f32_16x16x32_bf16 v[84:87], v[176:179], v[148:151], v[84:87]
    ds_read_b64_tr_b16 v[184:185], v206 offset:0
    s_waitcnt vmcnt(4)
    v_mfma_f32_16x16x32_bf16 v[88:91], v[176:179], v[152:155], v[88:91]
    ds_read_b64_tr_b16 v[186:187], v206 offset:2048
    v_cmp_eq_u32 s[74:75], s54, v2
    v_mfma_f32_16x16x32_bf16 v[92:95], v[176:179], v[156:159], v[92:95]
    ds_read_b64_tr_b16 v[176:177], v204 offset:0
    v_cmp_eq_u32 vcc, s54, v3
    v_mfma_f32_16x16x32_bf16 v[96:99], a[240:243], v[144:147], v[96:99]
    ds_read_b64_tr_b16 v[178:179], v204 offset:2048
    s_and_b64 s[74:75], s[74:75], vcc
    v_mfma_f32_16x16x32_bf16 v[100:103], a[240:243], v[148:151], v[100:103]
    v_cmp_eq_u32 vcc, s54, v4
    v_mfma_f32_16x16x32_bf16 v[104:107], a[240:243], v[152:155], v[104:107]
    s_and_b64 s[74:75], s[74:75], vcc
    v_mfma_f32_16x16x32_bf16 v[108:111], a[240:243], v[156:159], v[108:111]
    v_cmp_eq_u32 vcc, s54, v5
    v_mfma_f32_16x16x32_bf16 v[112:115], a[244:247], v[144:147], v[112:115]
    s_and_b64 s[74:75], s[74:75], vcc
    v_mfma_f32_16x16x32_bf16 v[116:119], a[244:247], v[148:151], v[116:119]
    s_cmp_eq_u64 s[74:75], -1
    v_mfma_f32_16x16x32_bf16 v[120:123], a[244:247], v[152:155], v[120:123]
    s_cbranch_scc0 L_t1_slow
L_t1_fast:
    v_mfma_f32_16x16x32_bf16 v[124:127], a[244:247], v[156:159], v[124:127]
    s_mov_b32 s66, 13824
    s_mov_b32 s67, 27648
    s_waitcnt lgkmcnt(0)
    v_mfma_f32_16x16x32_bf16 v[16:19], v[160:163], v[128:131], v[16:19]
    ds_read_b64_tr_b16 a[240:241], v205 offset:14336
    s_mov_b32 s68, 41472
    v_mfma_f32_16x16x32_bf16 v[20:23], v[160:163], v[132:135], v[20:23]
    ds_read_b128 v[144:147], v200 offset:0
    buffer_load_dword v228, v249, s[36:39], 0 offen sc1
    v_mfma_f32_16x16x32_bf16 v[24:27], v[160:163], v[136:139], v[24:27]
    v_mfma_f32_16x16x32_bf16 v[28:31], v[160:163], v[140:143], v[28:31]
    ds_read_b64_tr_b16 v[160:161], v201 offset:14336
    buffer_load_dword v229, v249, s[36:39], s66 offen sc1
    v_mfma_f32_16x16x32_bf16 v[32:35], v[164:167], v[128:131], v[32:35]
    ds_read_b64_tr_b16 v[162:163], v201 offset:15872
    s_mov_b32 s61, 45056
    v_mfma_f32_16x16x32_bf16 v[36:39], v[164:167], v[132:135], v[36:39]
    ds_read_b128 v[148:151], v200 offset:2048
    buffer_load_dword v230, v249, s[36:39], s67 offen sc1
    v_mfma_f32_16x16x32_bf16 v[40:43], v[164:167], v[136:139], v[40:43]
    ds_read_b64_tr_b16 a[242:243], v205 offset:16384
    v_mfma_f32_16x16x32_bf16 v[44:47], v[164:167], v[140:143], v[44:47]
    ds_read_b64_tr_b16 v[164:165], v202 offset:14336
    buffer_load_dword v231, v249, s[36:39], s68 offen sc1
    v_mfma_f32_16x16x32_bf16 v[48:51], v[168:171], v[128:131], v[48:51]
    ds_read_b64_tr_b16 v[166:167], v202 offset:15872
    v_mfma_f32_16x16x32_bf16 v[52:55], v[168:171], v[132:135], v[52:55]
    ds_read_b128 v[152:155], v200 offset:4096
    buffer_load_dwordx4 v[208:211], v248, s[36:39], 0 offen offset:0 sc1
    v_mfma_f32_16x16x32_bf16 v[56:59], v[168:171], v[136:139], v[56:59]
    v_mfma_f32_16x16x32_bf16 v[60:63], v[168:171], v[140:143], v[60:63]
    ds_read_b64_tr_b16 v[168:169], v201 offset:14400
    v_mfma_f32_16x16x32_bf16 v[64:67], v[172:175], v[128:131], v[64:67]
    ds_read_b64_tr_b16 v[170:171], v201 offset:15936
    s_cmp_eq_u32 s56, 90112
    s_cmov_b32 s61, 4294877184
    v_mfma_f32_16x16x32_bf16 v[68:71], v[172:175], v[132:135], v[68:71]
    ds_read_b128 v[156:159], v200 offset:6144
    v_mfma_f32_16x16x32_bf16 v[72:75], v[172:175], v[136:139], v[72:75]
    buffer_load_dwordx4 v[212:215], v248, s[36:39], 0 offen offset:512 sc1
    v_mfma_f32_16x16x32_bf16 v[76:79], v[172:175], v[140:143], v[76:79]
    ds_read_b64_tr_b16 v[172:173], v203 offset:14336
    v_mfma_f32_16x16x32_bf16 v[80:83], v[176:179], v[128:131], v[80:83]
    ds_read_b64_tr_b16 v[174:175], v203 offset:16384
    s_mov_b32 s60, s56
    v_mfma_f32_16x16x32_bf16 v[84:87], v[176:179], v[132:135], v[84:87]
    ds_read_b64_tr_b16 a[244:245], v206 offset:14336
    v_add_u32 v199, s61, v199
    buffer_load_dwordx4 v[216:219], v248, s[36:39], 0 offen offset:1024 sc1
    v_mfma_f32_16x16x32_bf16 v[88:91], v[176:179], v[136:139], v[88:91]
    ds_read_b64_tr_b16 a[246:247], v206 offset:16384
    buffer_load_dwordx4 v[220:223], v248, s[36:39], 0 offen offset:1536 sc1
    v_mfma_f32_16x16x32_bf16 v[92:95], v[176:179], v[140:143], v[92:95]
    ds_read_b64_tr_b16 v[176:177], v204 offset:14336
    v_mfma_f32_16x16x32_bf16 v[96:99], v[180:183], v[128:131], v[96:99]
    ds_read_b64_tr_b16 v[178:179], v204 offset:16384
    s_lshl_b32 s69, s51, 1
    v_mfma_f32_16x16x32_bf16 v[100:103], v[180:183], v[132:135], v[100:103]
    buffer_load_dwordx4 a[0:3], v254, s[36:39], s12 offen offset:0 sc1
    s_add_u32 s69, s69, s49
    v_mfma_f32_16x16x32_bf16 v[104:107], v[180:183], v[136:139], v[104:107]
    v_add_u32 v206, s61, v206
    buffer_load_dwordx4 a[4:7], v254, s[36:39], s12 offen offset:1024 sc1
    v_mfma_f32_16x16x32_bf16 v[108:111], v[180:183], v[140:143], v[108:111]
    v_add_u32 v205, s61, v205
    s_mul_i32 s16, s69, 196608
    v_mfma_f32_16x16x32_bf16 v[112:115], v[184:187], v[128:131], v[112:115]
    v_add_u32 v202, s61, v202
    v_add_u32 v201, s61, v201
    buffer_load_dwordx4 a[8:11], v254, s[36:39], s12 offen offset:2048 sc1
    v_mfma_f32_16x16x32_bf16 v[116:119], v[184:187], v[132:135], v[116:119]
    v_add_u32 v203, s61, v203
    s_lshr_b32 s69, s52, 1
    v_mfma_f32_16x16x32_bf16 v[120:123], v[184:187], v[136:139], v[120:123]
    v_add_u32 v204, s61, v204
    buffer_load_dwordx4 a[12:15], v254, s[36:39], s12 offen offset:3072 sc1
    s_add_u32 s12, s12, 4096
    v_mfma_f32_16x16x32_bf16 v[124:127], v[184:187], v[140:143], v[124:127]
    v_add_u32 v200, s61, v200
    buffer_load_dwordx4 a[16:19], v254, s[36:39], s12 offen offset:0 sc1
    s_add_u32 s12, s12, 36864
    s_waitcnt vmcnt(13) lgkmcnt(0)
    s_barrier
    v_mfma_f32_16x16x32_bf16 v[16:19], v[160:163], v[144:147], v[16:19]
    ds_read_b64_tr_b16 v[180:181], v205 offset:0
    s_mul_i32 s69, s69, 12288
    v_mfma_f32_16x16x32_bf16 v[20:23], v[160:163], v[148:151], v[20:23]
    ds_read_b128 v[128:131], v199 offset:0
    s_add_u32 s16, s16, s69
    v_mfma_f32_16x16x32_bf16 v[24:27], v[160:163], v[152:155], v[24:27]
    s_and_b32 s69, s52, 1
    s_lshl_b32 s69, s69, 1
    v_mfma_f32_16x16x32_bf16 v[28:31], v[160:163], v[156:159], v[28:31]
    ds_read_b64_tr_b16 v[160:161], v201 offset:0
    s_add_u32 s69, s69, s50
    v_mfma_f32_16x16x32_bf16 v[32:35], v[164:167], v[144:147], v[32:35]
    ds_read_b64_tr_b16 v[162:163], v201 offset:1536
    s_lshl_b32 s69, s69, 11
    v_mfma_f32_16x16x32_bf16 v[36:39], v[164:167], v[148:151], v[36:39]
    s_add_u32 s56, s56, s61
    ds_read_b128 v[132:135], v199 offset:2048
    v_mfma_f32_16x16x32_bf16 v[40:43], v[164:167], v[152:155], v[40:43]
    ds_read_b64_tr_b16 v[182:183], v205 offset:2048
    s_add_u32 s16, s16, s69
    v_mfma_f32_16x16x32_bf16 v[44:47], v[164:167], v[156:159], v[44:47]
    ds_read_b64_tr_b16 v[164:165], v202 offset:0
    s_lshl_b32 s69, s17, 2
    v_mfma_f32_16x16x32_bf16 v[48:51], v[168:171], v[144:147], v[48:51]
    ds_read_b64_tr_b16 v[166:167], v202 offset:1536
    s_add_u32 s69, s69, s48
    v_mfma_f32_16x16x32_bf16 v[52:55], v[168:171], v[148:151], v[52:55]
    ds_read_b128 v[136:139], v199 offset:4096
    s_lshl_b32 s69, s69, 4
    v_mfma_f32_16x16x32_bf16 v[56:59], v[168:171], v[152:155], v[56:59]
    buffer_load_dwordx4 a[20:23], v254, s[36:39], s12 offen offset:0 sc1
    v_and_b32 v14, 15, v1
    v_mfma_f32_16x16x32_bf16 v[60:63], v[168:171], v[156:159], v[60:63]
    ds_read_b64_tr_b16 v[168:169], v201 offset:64
    v_add_u32 v14, s69, v14
    v_mfma_f32_16x16x32_bf16 v[64:67], v[172:175], v[144:147], v[64:67]
    ds_read_b64_tr_b16 v[170:171], v201 offset:1600
    v_mul_u32_u24 v14, 1280, v14
    v_mfma_f32_16x16x32_bf16 v[68:71], v[172:175], v[148:151], v[68:71]
    ds_read_b128 v[140:143], v199 offset:6144
    v_lshrrev_b32 v15, 4, v1
    v_mfma_f32_16x16x32_bf16 v[72:75], v[172:175], v[152:155], v[72:75]
    s_cmp_eq_u32 s2, 0
    s_cselect_b32 s67, 13277184, s65
    v_lshl_add_u32 v14, v15, 3, v14
    v_mfma_f32_16x16x32_bf16 v[76:79], v[172:175], v[156:159], v[76:79]
    ds_read_b64_tr_b16 v[172:173], v203 offset:0
    s_mul_i32 s69, s18, 160
    v_mfma_f32_16x16x32_bf16 v[80:83], v[176:179], v[144:147], v[80:83]
    ds_read_b64_tr_b16 v[174:175], v203 offset:2048
    v_add_u32 v249, s69, v14
    v_mfma_f32_16x16x32_bf16 v[84:87], v[176:179], v[148:151], v[84:87]
    ds_read_b64_tr_b16 v[184:185], v206 offset:0
    buffer_store_dword v251, v252, s[36:39], s67 offen sc1
    v_mfma_f32_16x16x32_bf16 v[88:91], v[176:179], v[152:155], v[88:91]
    ds_read_b64_tr_b16 v[186:187], v206 offset:2048
    v_mfma_f32_16x16x32_bf16 v[92:95], v[176:179], v[156:159], v[92:95]
    ds_read_b64_tr_b16 v[176:177], v204 offset:0
    v_mfma_f32_16x16x32_bf16 v[96:99], a[240:243], v[144:147], v[96:99]
    ds_read_b64_tr_b16 v[178:179], v204 offset:2048
    v_mfma_f32_16x16x32_bf16 v[100:103], a[240:243], v[148:151], v[100:103]
    buffer_load_dwordx4 a[24:27], v254, s[36:39], s12 offen offset:1024 sc1
    v_mfma_f32_16x16x32_bf16 v[104:107], a[240:243], v[152:155], v[104:107]
    buffer_load_dwordx4 a[28:31], v254, s[36:39], s12 offen offset:2048 sc1
    v_mfma_f32_16x16x32_bf16 v[108:111], a[240:243], v[156:159], v[108:111]
    v_mfma_f32_16x16x32_bf16 v[112:115], a[244:247], v[144:147], v[112:115]
    buffer_load_dwordx4 a[32:35], v254, s[36:39], s12 offen offset:3072 sc1
    s_add_u32 s12, s12, 4096
    v_mfma_f32_16x16x32_bf16 v[116:119], a[244:247], v[148:151], v[116:119]
    v_mfma_f32_16x16x32_bf16 v[120:123], a[244:247], v[152:155], v[120:123]
    buffer_load_dwordx4 a[36:39], v254, s[36:39], s12 offen offset:0 sc1
    s_add_u32 s12, s12, 36864
    v_mfma_f32_16x16x32_bf16 v[124:127], a[244:247], v[156:159], v[124:127]
    s_waitcnt vmcnt(11) lgkmcnt(0)
    v_mfma_f32_16x16x32_bf16 v[16:19], v[160:163], v[128:131], v[16:19]
    ds_read_b64_tr_b16 a[240:241], v205 offset:14336
    v_add_f32 v228, v228, v229
    v_mfma_f32_16x16x32_bf16 v[20:23], v[160:163], v[132:135], v[20:23]
    ds_read_b128 v[144:147], v200 offset:0
    v_add_f32 v230, v230, v231
    v_mfma_f32_16x16x32_bf16 v[24:27], v[160:163], v[136:139], v[24:27]
    v_lshlrev_b32 v15, 2, v0
    buffer_load_dwordx4 a[40:43], v254, s[36:39], s12 offen offset:0 sc1
    v_mfma_f32_16x16x32_bf16 v[28:31], v[160:163], v[140:143], v[28:31]
    ds_read_b64_tr_b16 v[160:161], v201 offset:14336
    v_add_f32 v14, v228, v230
    v_mfma_f32_16x16x32_bf16 v[32:35], v[164:167], v[128:131], v[32:35]
    ds_read_b64_tr_b16 v[162:163], v201 offset:15872
    v_add_u32 v15, 159744, v15
    v_mfma_f32_16x16x32_bf16 v[36:39], v[164:167], v[132:135], v[36:39]
    ds_read_b128 v[148:151], v200 offset:2048
    v_mul_f32 v224, 897988541, v211
    v_mfma_f32_16x16x32_bf16 v[40:43], v[164:167], v[136:139], v[40:43]
    ds_read_b64_tr_b16 a[242:243], v205 offset:16384
    v_mul_f32 v225, 897988541, v215
    v_mfma_f32_16x16x32_bf16 v[44:47], v[164:167], v[140:143], v[44:47]
    ds_read_b64_tr_b16 v[164:165], v202 offset:14336
    v_mul_f32 v226, 897988541, v219
    v_mfma_f32_16x16x32_bf16 v[48:51], v[168:171], v[128:131], v[48:51]
    ds_read_b64_tr_b16 v[166:167], v202 offset:15872
    v_mul_f32 v227, 897988541, v223
    v_mfma_f32_16x16x32_bf16 v[52:55], v[168:171], v[132:135], v[52:55]
    ds_read_b128 v[152:155], v200 offset:4096
    v_lshrrev_b32 v3, 4, v1
    v_mfma_f32_16x16x32_bf16 v[56:59], v[168:171], v[136:139], v[56:59]
    v_lshlrev_b32 v3, 4, v3
    s_mul_i32 s66, s50, 448
    v_mfma_f32_16x16x32_bf16 v[60:63], v[168:171], v[140:143], v[60:63]
    ds_read_b64_tr_b16 v[168:169], v201 offset:14400
    s_add_u32 s66, s66, 159744
    v_mfma_f32_16x16x32_bf16 v[64:67], v[172:175], v[128:131], v[64:67]
    ds_read_b64_tr_b16 v[170:171], v201 offset:15936
    v_add_u32 v250, s66, v3
    v_mfma_f32_16x16x32_bf16 v[68:71], v[172:175], v[132:135], v[68:71]
    ds_read_b128 v[156:159], v200 offset:6144
    v_mfma_f32_16x16x32_bf16 v[72:75], v[172:175], v[136:139], v[72:75]
    ds_write_b32 v15, v14
    v_mfma_f32_16x16x32_bf16 v[76:79], v[172:175], v[140:143], v[76:79]
    ds_read_b64_tr_b16 v[172:173], v203 offset:14336
    v_mfma_f32_16x16x32_bf16 v[80:83], v[176:179], v[128:131], v[80:83]
    ds_read_b64_tr_b16 v[174:175], v203 offset:16384
    v_mfma_f32_16x16x32_bf16 v[84:87], v[176:179], v[132:135], v[84:87]
    ds_read_b64_tr_b16 a[244:245], v206 offset:14336
    v_mfma_f32_16x16x32_bf16 v[88:91], v[176:179], v[136:139], v[88:91]
    ds_read_b64_tr_b16 a[246:247], v206 offset:16384
    v_mfma_f32_16x16x32_bf16 v[92:95], v[176:179], v[140:143], v[92:95]
    ds_read_b64_tr_b16 v[176:177], v204 offset:14336
    v_mfma_f32_16x16x32_bf16 v[96:99], v[180:183], v[128:131], v[96:99]
    ds_read_b64_tr_b16 v[178:179], v204 offset:16384
    v_mfma_f32_16x16x32_bf16 v[100:103], v[180:183], v[132:135], v[100:103]
    buffer_load_dwordx4 a[44:47], v254, s[36:39], s12 offen offset:1024 sc1
    v_mfma_f32_16x16x32_bf16 v[104:107], v[180:183], v[136:139], v[104:107]
    v_mfma_f32_16x16x32_bf16 v[108:111], v[180:183], v[140:143], v[108:111]
    buffer_load_dwordx4 a[48:51], v254, s[36:39], s12 offen offset:2048 sc1
    v_mfma_f32_16x16x32_bf16 v[112:115], v[184:187], v[128:131], v[112:115]
    v_mfma_f32_16x16x32_bf16 v[116:119], v[184:187], v[132:135], v[116:119]
    buffer_load_dwordx4 a[52:55], v254, s[36:39], s12 offen offset:3072 sc1
    s_add_u32 s12, s12, 4096
    v_mfma_f32_16x16x32_bf16 v[120:123], v[184:187], v[136:139], v[120:123]
    v_mfma_f32_16x16x32_bf16 v[124:127], v[184:187], v[140:143], v[124:127]
    buffer_load_dwordx4 a[56:59], v254, s[36:39], s12 offen offset:0 sc1
    s_add_u32 s12, s12, 36864
    s_waitcnt lgkmcnt(0)
    s_barrier
    v_mfma_f32_16x16x32_bf16 v[16:19], v[160:163], v[144:147], v[16:19]
    ds_read_b128 v[228:231], v250 offset:0
    s_mul_i32 s60, s48, 25600
    v_mfma_f32_16x16x32_bf16 v[20:23], v[160:163], v[148:151], v[20:23]
    ds_read_b128 v[232:235], v250 offset:64
    s_add_u32 s60, s60, 51200
    v_mfma_f32_16x16x32_bf16 v[24:27], v[160:163], v[152:155], v[24:27]
    ds_read_b128 v[236:239], v250 offset:128
    v_and_b32 v2, 15, v1
    v_mfma_f32_16x16x32_bf16 v[28:31], v[160:163], v[156:159], v[28:31]
    ds_read_b128 v[240:243], v250 offset:192
    v_mul_u32_u24 v12, 80, v2
    v_mfma_f32_16x16x32_bf16 v[32:35], v[164:167], v[144:147], v[32:35]
    ds_read_b128 v[244:247], v250 offset:256
    v_lshrrev_b32 v3, 4, v1
    v_mfma_f32_16x16x32_bf16 v[36:39], v[164:167], v[148:151], v[36:39]
    ds_read_b128 v[188:191], v250 offset:320
    v_lshlrev_b32 v3, 4, v3
    v_mfma_f32_16x16x32_bf16 v[40:43], v[164:167], v[152:155], v[40:43]
    ds_read_b128 v[192:195], v250 offset:384
    v_and_b32 v14, 3, v1
    v_mfma_f32_16x16x32_bf16 v[44:47], v[164:167], v[156:159], v[44:47]
    v_add_u32 v14, 16, v14
    s_lshl_b32 s71, s48, 12
    v_mfma_f32_16x16x32_bf16 v[48:51], v[168:171], v[144:147], v[48:51]
    buffer_load_dwordx4 a[60:63], v254, s[36:39], s12 offen offset:0 sc1
    v_add_u32 v3, s71, v3
    v_mfma_f32_16x16x32_bf16 v[52:55], v[168:171], v[148:151], v[52:55]
    s_add_u32 s67, s71, 4080
    v_mov_b32 v13, s67
    v_mfma_f32_16x16x32_bf16 v[56:59], v[168:171], v[152:155], v[56:59]
    buffer_load_dwordx4 a[64:67], v254, s[36:39], s12 offen offset:1024 sc1
    v_cmp_gt_u32 vcc, 4, v2
    v_mfma_f32_16x16x32_bf16 v[60:63], v[168:171], v[156:159], v[60:63]
    s_lshl_b32 s68, s50, 1
    s_nop 0
    v_mfma_f32_16x16x32_bf16 v[64:67], v[172:175], v[144:147], v[64:67]
    v_cndmask_b32 v15, 20, v14, vcc
    v_mul_u32_u24 v15, 80, v15
    v_mfma_f32_16x16x32_bf16 v[68:71], v[172:175], v[148:151], v[68:71]
    buffer_load_dwordx4 a[68:71], v254, s[36:39], s12 offen offset:2048 sc1
    v_add_u32 v4, 0, v3
    v_mfma_f32_16x16x32_bf16 v[72:75], v[172:175], v[152:155], v[72:75]
    v_add_u32 v6, v4, v15
    v_add_u32 v4, v4, v12
    v_mfma_f32_16x16x32_bf16 v[76:79], v[172:175], v[156:159], v[76:79]
    buffer_load_dwordx4 a[72:75], v254, s[36:39], s12 offen offset:3072 sc1
    s_add_u32 s12, s12, 4096
    v_mfma_f32_16x16x32_bf16 v[80:83], v[176:179], v[144:147], v[80:83]
    v_add_u32 v5, 64, v3
    v_cmp_gt_u32 vcc, 16, v1
    v_mfma_f32_16x16x32_bf16 v[84:87], v[176:179], v[148:151], v[84:87]
    buffer_load_dwordx4 a[76:79], v254, s[36:39], s12 offen offset:0 sc1
    s_add_u32 s12, s12, 36864
    v_mfma_f32_16x16x32_bf16 v[88:91], v[176:179], v[152:155], v[88:91]
    v_add_u32 v7, v5, v15
    v_add_u32 v5, v5, v12
    v_mfma_f32_16x16x32_bf16 v[92:95], v[176:179], v[156:159], v[92:95]
    buffer_load_dwordx4 a[80:83], v254, s[36:39], s12 offen offset:0 sc1
    v_cndmask_b32 v7, v13, v7, vcc
    v_mfma_f32_16x16x32_bf16 v[96:99], a[240:243], v[144:147], v[96:99]
    v_cndmask_b32 v5, v13, v5, vcc
    v_add_u32 v8, 1776, v3
    v_mfma_f32_16x16x32_bf16 v[100:103], a[240:243], v[148:151], v[100:103]
    buffer_load_dwordx4 a[84:87], v254, s[36:39], s12 offen offset:1024 sc1
    v_cmp_lt_u32 vcc, 15, v1
    v_mfma_f32_16x16x32_bf16 v[104:107], a[240:243], v[152:155], v[104:107]
    v_add_u32 v10, v8, v15
    v_add_u32 v8, v8, v12
    v_mfma_f32_16x16x32_bf16 v[108:111], a[240:243], v[156:159], v[108:111]
    buffer_load_dwordx4 a[88:91], v254, s[36:39], s12 offen offset:2048 sc1
    v_cndmask_b32 v10, v13, v10, vcc
    v_mfma_f32_16x16x32_bf16 v[112:115], a[244:247], v[144:147], v[112:115]
    v_cndmask_b32 v8, v13, v8, vcc
    v_add_u32 v9, 1840, v3
    v_mfma_f32_16x16x32_bf16 v[116:119], a[244:247], v[148:151], v[116:119]
    buffer_load_dwordx4 a[92:95], v254, s[36:39], s12 offen offset:3072 sc1
    s_add_u32 s12, s12, 4096
    v_mfma_f32_16x16x32_bf16 v[120:123], a[244:247], v[152:155], v[120:123]
    v_cmp_gt_u32 vcc, 32, v1
    v_add_u32 v11, v9, v15
    v_mfma_f32_16x16x32_bf16 v[124:127], a[244:247], v[156:159], v[124:127]
    v_add_u32 v9, v9, v12
    v_cndmask_b32 v11, v13, v11, vcc
    v_cndmask_b32 v9, v13, v9, vcc
    s_lshl_b32 s67, s52, 2
    s_add_u32 s67, s67, s68
    s_mul_i32 s70, s67, 1792
    s_add_u32 s70, s70, 12746752
    v_cmp_gt_u32 vcc, 32, v1
    v_mov_b32 v2, 1073741824
    s_nop 0
    v_cndmask_b32 v196, v2, v254, vcc
    s_mul_i32 s57, s52, 2048
    s_add_u32 s57, s57, 13144064
    v_bfe_u32 v168, v1, 4, 1
    v_mul_u32_u24 v168, 24, v168
    v_add_u32 v168, v168, v249
    buffer_load_dwordx4 v[170:173], v168, s[24:27], 0 offen offset:0
    buffer_load_dwordx4 v[174:177], v168, s[24:27], 0 offen offset:64
    buffer_load_dwordx2 v[178:179], v249, s[24:27], 0 offen offset:128
    s_waitcnt lgkmcnt(0)
    v_pk_fma_f32 v[152:153], v[240:241], v[208:209], v[64:65] op_sel_hi:[1,0,1]
    v_pk_fma_f32 v[154:155], v[242:243], v[208:209], v[66:67] op_sel_hi:[1,0,1]
    v_pk_fma_f32 v[156:157], v[244:245], v[208:209], v[80:81] op_sel_hi:[1,0,1]
    v_pk_fma_f32 v[158:159], v[246:247], v[208:209], v[82:83] op_sel_hi:[1,0,1]
    v_pk_mul_f32 v[160:161], v[152:153], v[210:211] op_sel_hi:[1,0] neg_lo:[0,1] neg_hi:[0,1]
    v_pk_mul_f32 v[162:163], v[154:155], v[210:211] op_sel_hi:[1,0] neg_lo:[0,1] neg_hi:[0,1]
    v_pk_mul_f32 v[164:165], v[156:157], v[210:211] op_sel_hi:[1,0] neg_lo:[0,1] neg_hi:[0,1]
    v_pk_mul_f32 v[166:167], v[158:159], v[210:211] op_sel_hi:[1,0] neg_lo:[0,1] neg_hi:[0,1]
    v_exp_f32 v160, v160
    v_exp_f32 v161, v161
    v_exp_f32 v162, v162
    v_exp_f32 v163, v163
    v_exp_f32 v164, v164
    v_exp_f32 v165, v165
    v_exp_f32 v166, v166
    v_exp_f32 v167, v167
    v_pk_fma_f32 v[160:161], v[160:161], v[210:211], v[210:211] op_sel:[0,1,1]
    v_pk_fma_f32 v[162:163], v[162:163], v[210:211], v[210:211] op_sel:[0,1,1]
    v_pk_fma_f32 v[164:165], v[164:165], v[210:211], v[210:211] op_sel:[0,1,1]
    v_pk_fma_f32 v[166:167], v[166:167], v[210:211], v[210:211] op_sel:[0,1,1]
    v_rcp_f32 v160, v160
    v_rcp_f32 v161, v161
    v_rcp_f32 v162, v162
    v_rcp_f32 v163, v163
    buffer_load_dwordx4 a[96:99], v254, s[36:39], s12 offen offset:0 sc1
    s_add_u32 s12, s12, 36864
    v_rcp_f32 v164, v164
    v_rcp_f32 v165, v165
    v_rcp_f32 v166, v166
    v_rcp_f32 v167, v167
    v_pk_mul_f32 v[152:153], v[152:153], v[160:161]
    v_pk_mul_f32 v[154:155], v[154:155], v[162:163]
    v_pk_mul_f32 v[156:157], v[156:157], v[164:165]
    v_pk_mul_f32 v[158:159], v[158:159], v[166:167]
    v_cvt_pk_bf16_f32 v144, v152, v153
    v_cvt_pk_bf16_f32 v145, v154, v155
    v_cvt_pk_bf16_f32 v146, v156, v157
    v_cvt_pk_bf16_f32 v147, v158, v159
    buffer_store_dwordx4 v[144:147], v254, s[36:39], s16 offen offset:0 sc1
    v_pk_fma_f32 v[128:129], v[188:189], v[208:209], v[96:97] op_sel_hi:[1,0,1]
    v_pk_fma_f32 v[130:131], v[190:191], v[208:209], v[98:99] op_sel_hi:[1,0,1]
    v_pk_fma_f32 v[132:133], v[192:193], v[208:209], v[112:113] op_sel_hi:[1,0,1]
    v_pk_fma_f32 v[134:135], v[194:195], v[208:209], v[114:115] op_sel_hi:[1,0,1]
    v_pk_mul_f32 v[136:137], v[128:129], v[210:211] op_sel_hi:[1,0] neg_lo:[0,1] neg_hi:[0,1]
    v_pk_mul_f32 v[138:139], v[130:131], v[210:211] op_sel_hi:[1,0] neg_lo:[0,1] neg_hi:[0,1]
    v_pk_mul_f32 v[140:141], v[132:133], v[210:211] op_sel_hi:[1,0] neg_lo:[0,1] neg_hi:[0,1]
    v_pk_mul_f32 v[142:143], v[134:135], v[210:211] op_sel_hi:[1,0] neg_lo:[0,1] neg_hi:[0,1]
    v_exp_f32 v136, v136
    v_exp_f32 v137, v137
    v_exp_f32 v138, v138
    v_exp_f32 v139, v139
    buffer_load_dwordx4 a[100:103], v254, s[36:39], s12 offen offset:0 sc1
    v_exp_f32 v140, v140
    v_exp_f32 v141, v141
    v_exp_f32 v142, v142
    v_exp_f32 v143, v143
    v_pk_fma_f32 v[136:137], v[136:137], v[210:211], v[210:211] op_sel:[0,1,1]
    v_pk_fma_f32 v[138:139], v[138:139], v[210:211], v[210:211] op_sel:[0,1,1]
    v_pk_fma_f32 v[140:141], v[140:141], v[210:211], v[210:211] op_sel:[0,1,1]
    v_pk_fma_f32 v[142:143], v[142:143], v[210:211], v[210:211] op_sel:[0,1,1]
    v_rcp_f32 v136, v136
    v_rcp_f32 v137, v137
    v_rcp_f32 v138, v138
    v_rcp_f32 v139, v139
    v_rcp_f32 v140, v140
    v_rcp_f32 v141, v141
    v_rcp_f32 v142, v142
    v_rcp_f32 v143, v143
    v_pk_mul_f32 v[128:129], v[128:129], v[136:137]
    v_pk_mul_f32 v[130:131], v[130:131], v[138:139]
    v_pk_mul_f32 v[132:133], v[132:133], v[140:141]
    v_pk_mul_f32 v[134:135], v[134:135], v[142:143]
    v_cvt_pk_bf16_f32 v148, v128, v129
    v_cvt_pk_bf16_f32 v149, v130, v131
    v_cvt_pk_bf16_f32 v150, v132, v133
    v_cvt_pk_bf16_f32 v151, v134, v135
    buffer_load_dwordx4 a[104:107], v254, s[36:39], s12 offen offset:1024 sc1
    buffer_store_dwordx4 v[148:151], v254, s[36:39], s16 offen offset:1024 sc1
    s_add_u32 s16, s16, 49152
    v_pk_fma_f32 v[152:153], v[240:241], v[212:213], v[68:69] op_sel_hi:[1,0,1]
    v_pk_fma_f32 v[154:155], v[242:243], v[212:213], v[70:71] op_sel_hi:[1,0,1]
    v_pk_fma_f32 v[156:157], v[244:245], v[212:213], v[84:85] op_sel_hi:[1,0,1]
    v_pk_fma_f32 v[158:159], v[246:247], v[212:213], v[86:87] op_sel_hi:[1,0,1]
    v_pk_mul_f32 v[160:161], v[152:153], v[214:215] op_sel_hi:[1,0] neg_lo:[0,1] neg_hi:[0,1]
    v_pk_mul_f32 v[162:163], v[154:155], v[214:215] op_sel_hi:[1,0] neg_lo:[0,1] neg_hi:[0,1]
    v_pk_mul_f32 v[164:165], v[156:157], v[214:215] op_sel_hi:[1,0] neg_lo:[0,1] neg_hi:[0,1]
    v_pk_mul_f32 v[166:167], v[158:159], v[214:215] op_sel_hi:[1,0] neg_lo:[0,1] neg_hi:[0,1]
    v_exp_f32 v160, v160
    v_exp_f32 v161, v161
    v_exp_f32 v162, v162
    v_exp_f32 v163, v163
    v_exp_f32 v164, v164
    v_exp_f32 v165, v165
    v_exp_f32 v166, v166
    v_exp_f32 v167, v167
    v_pk_fma_f32 v[160:161], v[160:161], v[214:215], v[214:215] op_sel:[0,1,1]
    v_pk_fma_f32 v[162:163], v[162:163], v[214:215], v[214:215] op_sel:[0,1,1]
    v_pk_fma_f32 v[164:165], v[164:165], v[214:215], v[214:215] op_sel:[0,1,1]
    v_pk_fma_f32 v[166:167], v[166:167], v[214:215], v[214:215] op_sel:[0,1,1]
    v_rcp_f32 v160, v160
    v_rcp_f32 v161, v161
    v_rcp_f32 v162, v162
    v_rcp_f32 v163, v163
    buffer_load_dwordx4 a[108:111], v254, s[36:39], s12 offen offset:2048 sc1
    v_rcp_f32 v164, v164
    v_rcp_f32 v165, v165
    v_rcp_f32 v166, v166
    v_rcp_f32 v167, v167
    v_pk_mul_f32 v[152:153], v[152:153], v[160:161]
    v_pk_mul_f32 v[154:155], v[154:155], v[162:163]
    v_pk_mul_f32 v[156:157], v[156:157], v[164:165]
    v_pk_mul_f32 v[158:159], v[158:159], v[166:167]
    v_cvt_pk_bf16_f32 v144, v152, v153
    v_cvt_pk_bf16_f32 v145, v154, v155
    v_cvt_pk_bf16_f32 v146, v156, v157
    v_cvt_pk_bf16_f32 v147, v158, v159
    buffer_store_dwordx4 v[144:147], v254, s[36:39], s16 offen offset:0 sc1
    v_pk_fma_f32 v[128:129], v[188:189], v[212:213], v[100:101] op_sel_hi:[1,0,1]
    v_pk_fma_f32 v[130:131], v[190:191], v[212:213], v[102:103] op_sel_hi:[1,0,1]
    v_pk_fma_f32 v[132:133], v[192:193], v[212:213], v[116:117] op_sel_hi:[1,0,1]
    v_pk_fma_f32 v[134:135], v[194:195], v[212:213], v[118:119] op_sel_hi:[1,0,1]
    v_pk_mul_f32 v[136:137], v[128:129], v[214:215] op_sel_hi:[1,0] neg_lo:[0,1] neg_hi:[0,1]
    v_pk_mul_f32 v[138:139], v[130:131], v[214:215] op_sel_hi:[1,0] neg_lo:[0,1] neg_hi:[0,1]
    v_pk_mul_f32 v[140:141], v[132:133], v[214:215] op_sel_hi:[1,0] neg_lo:[0,1] neg_hi:[0,1]
    v_pk_mul_f32 v[142:143], v[134:135], v[214:215] op_sel_hi:[1,0] neg_lo:[0,1] neg_hi:[0,1]
    v_exp_f32 v136, v136
    v_exp_f32 v137, v137
    v_exp_f32 v138, v138
    v_exp_f32 v139, v139
    buffer_load_dwordx4 a[112:115], v254, s[36:39], s12 offen offset:3072 sc1
    s_add_u32 s12, s12, 4096
    v_exp_f32 v140, v140
    v_exp_f32 v141, v141
    v_exp_f32 v142, v142
    v_exp_f32 v143, v143
    v_pk_fma_f32 v[136:137], v[136:137], v[214:215], v[214:215] op_sel:[0,1,1]
    v_pk_fma_f32 v[138:139], v[138:139], v[214:215], v[214:215] op_sel:[0,1,1]
    v_pk_fma_f32 v[140:141], v[140:141], v[214:215], v[214:215] op_sel:[0,1,1]
    v_pk_fma_f32 v[142:143], v[142:143], v[214:215], v[214:215] op_sel:[0,1,1]
    v_rcp_f32 v136, v136
    v_rcp_f32 v137, v137
    v_rcp_f32 v138, v138
    v_rcp_f32 v139, v139
    v_rcp_f32 v140, v140
    v_rcp_f32 v141, v141
    v_rcp_f32 v142, v142
    v_rcp_f32 v143, v143
    v_pk_mul_f32 v[128:129], v[128:129], v[136:137]
    v_pk_mul_f32 v[130:131], v[130:131], v[138:139]
    v_pk_mul_f32 v[132:133], v[132:133], v[140:141]
    v_pk_mul_f32 v[134:135], v[134:135], v[142:143]
    v_cvt_pk_bf16_f32 v148, v128, v129
    v_cvt_pk_bf16_f32 v149, v130, v131
    v_cvt_pk_bf16_f32 v150, v132, v133
    v_cvt_pk_bf16_f32 v151, v134, v135
    buffer_load_dwordx4 a[116:119], v254, s[36:39], s12 offen offset:0 sc1
    s_add_u32 s12, s12, 36864
    buffer_store_dwordx4 v[148:151], v254, s[36:39], s16 offen offset:1024 sc1
    s_add_u32 s16, s16, 49152
    v_pk_fma_f32 v[152:153], v[240:241], v[216:217], v[72:73] op_sel_hi:[1,0,1]
    v_pk_fma_f32 v[154:155], v[242:243], v[216:217], v[74:75] op_sel_hi:[1,0,1]
    v_pk_fma_f32 v[156:157], v[244:245], v[216:217], v[88:89] op_sel_hi:[1,0,1]
    v_pk_fma_f32 v[158:159], v[246:247], v[216:217], v[90:91] op_sel_hi:[1,0,1]
    v_pk_mul_f32 v[160:161], v[152:153], v[218:219] op_sel_hi:[1,0] neg_lo:[0,1] neg_hi:[0,1]
    v_pk_mul_f32 v[162:163], v[154:155], v[218:219] op_sel_hi:[1,0] neg_lo:[0,1] neg_hi:[0,1]
    v_pk_mul_f32 v[164:165], v[156:157], v[218:219] op_sel_hi:[1,0] neg_lo:[0,1] neg_hi:[0,1]
    v_pk_mul_f32 v[166:167], v[158:159], v[218:219] op_sel_hi:[1,0] neg_lo:[0,1] neg_hi:[0,1]
    v_exp_f32 v160, v160
    v_exp_f32 v161, v161
    v_exp_f32 v162, v162
    v_exp_f32 v163, v163
    v_exp_f32 v164, v164
    v_exp_f32 v165, v165
    v_exp_f32 v166, v166
    v_exp_f32 v167, v167
    v_pk_fma_f32 v[160:161], v[160:161], v[218:219], v[218:219] op_sel:[0,1,1]
    v_pk_fma_f32 v[162:163], v[162:163], v[218:219], v[218:219] op_sel:[0,1,1]
    v_pk_fma_f32 v[164:165], v[164:165], v[218:219], v[218:219] op_sel:[0,1,1]
    v_pk_fma_f32 v[166:167], v[166:167], v[218:219], v[218:219] op_sel:[0,1,1]
    v_rcp_f32 v160, v160
    v_rcp_f32 v161, v161
    v_rcp_f32 v162, v162
    v_rcp_f32 v163, v163
    buffer_load_dwordx4 a[120:123], v254, s[36:39], s12 offen offset:0 sc1
    v_rcp_f32 v164, v164
    v_rcp_f32 v165, v165
    v_rcp_f32 v166, v166
    v_rcp_f32 v167, v167
    v_pk_mul_f32 v[152:153], v[152:153], v[160:161]
    v_pk_mul_f32 v[154:155], v[154:155], v[162:163]
    v_pk_mul_f32 v[156:157], v[156:157], v[164:165]
    v_pk_mul_f32 v[158:159], v[158:159], v[166:167]
    v_cvt_pk_bf16_f32 v144, v152, v153
    v_cvt_pk_bf16_f32 v145, v154, v155
    v_cvt_pk_bf16_f32 v146, v156, v157
    v_cvt_pk_bf16_f32 v147, v158, v159
    buffer_store_dwordx4 v[144:147], v254, s[36:39], s16 offen offset:0 sc1
    v_pk_fma_f32 v[128:129], v[188:189], v[216:217], v[104:105] op_sel_hi:[1,0,1]
    v_pk_fma_f32 v[130:131], v[190:191], v[216:217], v[106:107] op_sel_hi:[1,0,1]
    v_pk_fma_f32 v[132:133], v[192:193], v[216:217], v[120:121] op_sel_hi:[1,0,1]
    v_pk_fma_f32 v[134:135], v[194:195], v[216:217], v[122:123] op_sel_hi:[1,0,1]
    v_pk_mul_f32 v[136:137], v[128:129], v[218:219] op_sel_hi:[1,0] neg_lo:[0,1] neg_hi:[0,1]
    v_pk_mul_f32 v[138:139], v[130:131], v[218:219] op_sel_hi:[1,0] neg_lo:[0,1] neg_hi:[0,1]
    v_pk_mul_f32 v[140:141], v[132:133], v[218:219] op_sel_hi:[1,0] neg_lo:[0,1] neg_hi:[0,1]
    v_pk_mul_f32 v[142:143], v[134:135], v[218:219] op_sel_hi:[1,0] neg_lo:[0,1] neg_hi:[0,1]
    v_exp_f32 v136, v136
    v_exp_f32 v137, v137
    v_exp_f32 v138, v138
    v_exp_f32 v139, v139
    buffer_load_dwordx4 a[124:127], v254, s[36:39], s12 offen offset:1024 sc1
    v_exp_f32 v140, v140
    v_exp_f32 v141, v141
    v_exp_f32 v142, v142
    v_exp_f32 v143, v143
    v_pk_fma_f32 v[136:137], v[136:137], v[218:219], v[218:219] op_sel:[0,1,1]
    v_pk_fma_f32 v[138:139], v[138:139], v[218:219], v[218:219] op_sel:[0,1,1]
    v_pk_fma_f32 v[140:141], v[140:141], v[218:219], v[218:219] op_sel:[0,1,1]
    v_pk_fma_f32 v[142:143], v[142:143], v[218:219], v[218:219] op_sel:[0,1,1]
    v_rcp_f32 v136, v136
    v_rcp_f32 v137, v137
    v_rcp_f32 v138, v138
    v_rcp_f32 v139, v139
    v_rcp_f32 v140, v140
    v_rcp_f32 v141, v141
    v_rcp_f32 v142, v142
    v_rcp_f32 v143, v143
    v_pk_mul_f32 v[128:129], v[128:129], v[136:137]
    v_pk_mul_f32 v[130:131], v[130:131], v[138:139]
    v_pk_mul_f32 v[132:133], v[132:133], v[140:141]
    v_pk_mul_f32 v[134:135], v[134:135], v[142:143]
    v_cvt_pk_bf16_f32 v148, v128, v129
    v_cvt_pk_bf16_f32 v149, v130, v131
    v_cvt_pk_bf16_f32 v150, v132, v133
    v_cvt_pk_bf16_f32 v151, v134, v135
    buffer_load_dwordx4 a[128:131], v254, s[36:39], s12 offen offset:2048 sc1
    buffer_store_dwordx4 v[148:151], v254, s[36:39], s16 offen offset:1024 sc1
    s_add_u32 s16, s16, 49152
    v_pk_fma_f32 v[152:153], v[240:241], v[220:221], v[76:77] op_sel_hi:[1,0,1]
    v_pk_fma_f32 v[154:155], v[242:243], v[220:221], v[78:79] op_sel_hi:[1,0,1]
    v_pk_fma_f32 v[156:157], v[244:245], v[220:221], v[92:93] op_sel_hi:[1,0,1]
    v_pk_fma_f32 v[158:159], v[246:247], v[220:221], v[94:95] op_sel_hi:[1,0,1]
    v_pk_mul_f32 v[160:161], v[152:153], v[222:223] op_sel_hi:[1,0] neg_lo:[0,1] neg_hi:[0,1]
    v_pk_mul_f32 v[162:163], v[154:155], v[222:223] op_sel_hi:[1,0] neg_lo:[0,1] neg_hi:[0,1]
    v_pk_mul_f32 v[164:165], v[156:157], v[222:223] op_sel_hi:[1,0] neg_lo:[0,1] neg_hi:[0,1]
    v_pk_mul_f32 v[166:167], v[158:159], v[222:223] op_sel_hi:[1,0] neg_lo:[0,1] neg_hi:[0,1]
    v_exp_f32 v160, v160
    v_exp_f32 v161, v161
    v_exp_f32 v162, v162
    v_exp_f32 v163, v163
    v_exp_f32 v164, v164
    v_exp_f32 v165, v165
    v_exp_f32 v166, v166
    v_exp_f32 v167, v167
    v_pk_fma_f32 v[160:161], v[160:161], v[222:223], v[222:223] op_sel:[0,1,1]
    v_pk_fma_f32 v[162:163], v[162:163], v[222:223], v[222:223] op_sel:[0,1,1]
    v_pk_fma_f32 v[164:165], v[164:165], v[222:223], v[222:223] op_sel:[0,1,1]
    v_pk_fma_f32 v[166:167], v[166:167], v[222:223], v[222:223] op_sel:[0,1,1]
    v_rcp_f32 v160, v160
    v_rcp_f32 v161, v161
    v_rcp_f32 v162, v162
    v_rcp_f32 v163, v163
    buffer_load_dwordx4 a[132:135], v254, s[36:39], s12 offen offset:3072 sc1
    s_add_u32 s12, s12, 4096
    v_rcp_f32 v164, v164
    v_rcp_f32 v165, v165
    v_rcp_f32 v166, v166
    v_rcp_f32 v167, v167
    v_pk_mul_f32 v[152:153], v[152:153], v[160:161]
    v_pk_mul_f32 v[154:155], v[154:155], v[162:163]
    v_pk_mul_f32 v[156:157], v[156:157], v[164:165]
    v_pk_mul_f32 v[158:159], v[158:159], v[166:167]
    v_cvt_pk_bf16_f32 v144, v152, v153
    v_cvt_pk_bf16_f32 v145, v154, v155
    v_cvt_pk_bf16_f32 v146, v156, v157
    v_cvt_pk_bf16_f32 v147, v158, v159
    buffer_store_dwordx4 v[144:147], v254, s[36:39], s16 offen offset:0 sc1
    v_pk_fma_f32 v[128:129], v[188:189], v[220:221], v[108:109] op_sel_hi:[1,0,1]
    v_pk_fma_f32 v[130:131], v[190:191], v[220:221], v[110:111] op_sel_hi:[1,0,1]
    v_pk_fma_f32 v[132:133], v[192:193], v[220:221], v[124:125] op_sel_hi:[1,0,1]
    v_pk_fma_f32 v[134:135], v[194:195], v[220:221], v[126:127] op_sel_hi:[1,0,1]
    v_pk_mul_f32 v[136:137], v[128:129], v[222:223] op_sel_hi:[1,0] neg_lo:[0,1] neg_hi:[0,1]
    v_pk_mul_f32 v[138:139], v[130:131], v[222:223] op_sel_hi:[1,0] neg_lo:[0,1] neg_hi:[0,1]
    v_pk_mul_f32 v[140:141], v[132:133], v[222:223] op_sel_hi:[1,0] neg_lo:[0,1] neg_hi:[0,1]
    v_pk_mul_f32 v[142:143], v[134:135], v[222:223] op_sel_hi:[1,0] neg_lo:[0,1] neg_hi:[0,1]
    v_exp_f32 v136, v136
    v_exp_f32 v137, v137
    v_exp_f32 v138, v138
    v_exp_f32 v139, v139
    buffer_load_dwordx4 a[136:139], v254, s[36:39], s12 offen offset:0 sc1
    s_add_u32 s12, s12, 36864
    v_exp_f32 v140, v140
    v_exp_f32 v141, v141
    v_exp_f32 v142, v142
    v_exp_f32 v143, v143
    v_pk_fma_f32 v[136:137], v[136:137], v[222:223], v[222:223] op_sel:[0,1,1]
    v_pk_fma_f32 v[138:139], v[138:139], v[222:223], v[222:223] op_sel:[0,1,1]
    v_pk_fma_f32 v[140:141], v[140:141], v[222:223], v[222:223] op_sel:[0,1,1]
    v_pk_fma_f32 v[142:143], v[142:143], v[222:223], v[222:223] op_sel:[0,1,1]
    v_rcp_f32 v136, v136
    v_rcp_f32 v137, v137
    v_rcp_f32 v138, v138
    v_rcp_f32 v139, v139
    v_rcp_f32 v140, v140
    v_rcp_f32 v141, v141
    v_rcp_f32 v142, v142
    v_rcp_f32 v143, v143
    v_pk_mul_f32 v[128:129], v[128:129], v[136:137]
    v_pk_mul_f32 v[130:131], v[130:131], v[138:139]
    v_pk_mul_f32 v[132:133], v[132:133], v[140:141]
    v_pk_mul_f32 v[134:135], v[134:135], v[142:143]
    v_cvt_pk_bf16_f32 v148, v128, v129
    v_cvt_pk_bf16_f32 v149, v130, v131
    v_cvt_pk_bf16_f32 v150, v132, v133
    v_cvt_pk_bf16_f32 v151, v134, v135
    buffer_load_dwordx4 a[140:143], v254, s[36:39], s12 offen offset:0 sc1
    buffer_store_dwordx4 v[148:151], v254, s[36:39], s16 offen offset:1024 sc1
    s_add_u32 s16, s16, 49152
    v_pk_fma_f32 v[152:153], v[228:229], v[208:209], v[16:17] op_sel_hi:[1,0,1]
    v_pk_fma_f32 v[154:155], v[230:231], v[208:209], v[18:19] op_sel_hi:[1,0,1]
    v_pk_fma_f32 v[156:157], v[232:233], v[208:209], v[32:33] op_sel_hi:[1,0,1]
    v_pk_fma_f32 v[158:159], v[234:235], v[208:209], v[34:35] op_sel_hi:[1,0,1]
    v_pk_mul_f32 v[160:161], v[152:153], v[210:211] op_sel_hi:[1,0]
    v_pk_mul_f32 v[162:163], v[154:155], v[210:211] op_sel_hi:[1,0]
    v_pk_mul_f32 v[164:165], v[156:157], v[210:211] op_sel_hi:[1,0]
    v_pk_mul_f32 v[166:167], v[158:159], v[210:211] op_sel_hi:[1,0]
    v_exp_f32_e64 v160, v160 clamp
    v_max_f32 v152, v224, v152
    v_exp_f32_e64 v161, v161 clamp
    v_max_f32 v153, v224, v153
    v_exp_f32_e64 v162, v162 clamp
    v_max_f32 v154, v224, v154
    v_exp_f32_e64 v163, v163 clamp
    v_max_f32 v155, v224, v155
    buffer_load_dwordx4 a[144:147], v254, s[36:39], s12 offen offset:1024 sc1
    v_exp_f32_e64 v164, v164 clamp
    v_max_f32 v156, v224, v156
    v_exp_f32_e64 v165, v165 clamp
    v_max_f32 v157, v224, v157
    v_exp_f32_e64 v166, v166 clamp
    v_max_f32 v158, v224, v158
    v_exp_f32_e64 v167, v167 clamp
    v_max_f32 v159, v224, v159
    v_pk_fma_f32 v[152:153], v[152:153], v[208:209], v[160:161] op_sel:[0,1,0]
    v_pk_fma_f32 v[154:155], v[154:155], v[208:209], v[162:163] op_sel:[0,1,0]
    v_pk_fma_f32 v[156:157], v[156:157], v[208:209], v[164:165] op_sel:[0,1,0]
    v_pk_fma_f32 v[158:159], v[158:159], v[208:209], v[166:167] op_sel:[0,1,0]
    v_cvt_pk_bf16_f32 v104, v152, v153
    v_cvt_pk_bf16_f32 v105, v154, v155
    v_cvt_pk_bf16_f32 v106, v156, v157
    v_cvt_pk_bf16_f32 v107, v158, v159
    buffer_load_dwordx4 a[148:151], v254, s[36:39], s12 offen offset:2048 sc1
    v_pk_fma_f32 v[128:129], v[228:229], v[212:213], v[20:21] op_sel_hi:[1,0,1]
    v_pk_fma_f32 v[130:131], v[230:231], v[212:213], v[22:23] op_sel_hi:[1,0,1]
    v_pk_fma_f32 v[132:133], v[232:233], v[212:213], v[36:37] op_sel_hi:[1,0,1]
    v_pk_fma_f32 v[134:135], v[234:235], v[212:213], v[38:39] op_sel_hi:[1,0,1]
    v_pk_mul_f32 v[136:137], v[128:129], v[214:215] op_sel_hi:[1,0]
    v_pk_mul_f32 v[138:139], v[130:131], v[214:215] op_sel_hi:[1,0]
    v_pk_mul_f32 v[140:141], v[132:133], v[214:215] op_sel_hi:[1,0]
    v_pk_mul_f32 v[142:143], v[134:135], v[214:215] op_sel_hi:[1,0]
    v_exp_f32_e64 v136, v136 clamp
    v_max_f32 v128, v225, v128
    v_exp_f32_e64 v137, v137 clamp
    v_max_f32 v129, v225, v129
    v_exp_f32_e64 v138, v138 clamp
    v_max_f32 v130, v225, v130
    v_exp_f32_e64 v139, v139 clamp
    v_max_f32 v131, v225, v131
    buffer_load_dwordx4 a[152:155], v254, s[36:39], s12 offen offset:3072 sc1
    s_add_u32 s12, s12, 4096
    v_exp_f32_e64 v140, v140 clamp
    v_max_f32 v132, v225, v132
    v_exp_f32_e64 v141, v141 clamp
    v_max_f32 v133, v225, v133
    v_exp_f32_e64 v142, v142 clamp
    v_max_f32 v134, v225, v134
    v_exp_f32_e64 v143, v143 clamp
    v_max_f32 v135, v225, v135
    v_pk_fma_f32 v[128:129], v[128:129], v[212:213], v[136:137] op_sel:[0,1,0]
    v_pk_fma_f32 v[130:131], v[130:131], v[212:213], v[138:139] op_sel:[0,1,0]
    v_pk_fma_f32 v[132:133], v[132:133], v[212:213], v[140:141] op_sel:[0,1,0]
    v_pk_fma_f32 v[134:135], v[134:135], v[212:213], v[142:143] op_sel:[0,1,0]
    v_cvt_pk_bf16_f32 v110, v128, v129
    v_cvt_pk_bf16_f32 v111, v130, v131
    v_cvt_pk_bf16_f32 v112, v132, v133
    v_cvt_pk_bf16_f32 v113, v134, v135
    buffer_load_dwordx4 a[156:159], v254, s[36:39], s12 offen offset:0 sc1
    s_add_u32 s12, s12, 36864
    v_pk_fma_f32 v[152:153], v[228:229], v[216:217], v[24:25] op_sel_hi:[1,0,1]
    v_pk_fma_f32 v[154:155], v[230:231], v[216:217], v[26:27] op_sel_hi:[1,0,1]
    v_pk_fma_f32 v[156:157], v[232:233], v[216:217], v[40:41] op_sel_hi:[1,0,1]
    v_pk_fma_f32 v[158:159], v[234:235], v[216:217], v[42:43] op_sel_hi:[1,0,1]
    v_pk_mul_f32 v[160:161], v[152:153], v[218:219] op_sel_hi:[1,0]
    v_pk_mul_f32 v[162:163], v[154:155], v[218:219] op_sel_hi:[1,0]
    v_pk_mul_f32 v[164:165], v[156:157], v[218:219] op_sel_hi:[1,0]
    v_pk_mul_f32 v[166:167], v[158:159], v[218:219] op_sel_hi:[1,0]
    v_exp_f32_e64 v160, v160 clamp
    v_max_f32 v152, v226, v152
    v_exp_f32_e64 v161, v161 clamp
    v_max_f32 v153, v226, v153
    v_exp_f32_e64 v162, v162 clamp
    v_max_f32 v154, v226, v154
    v_exp_f32_e64 v163, v163 clamp
    v_max_f32 v155, v226, v155
    buffer_load_dwordx4 a[160:163], v254, s[36:39], s12 offen offset:0 sc1
    v_exp_f32_e64 v164, v164 clamp
    v_max_f32 v156, v226, v156
    v_exp_f32_e64 v165, v165 clamp
    v_max_f32 v157, v226, v157
    v_exp_f32_e64 v166, v166 clamp
    v_max_f32 v158, v226, v158
    v_exp_f32_e64 v167, v167 clamp
    v_max_f32 v159, v226, v159
    v_pk_fma_f32 v[152:153], v[152:153], v[216:217], v[160:161] op_sel:[0,1,0]
    v_pk_fma_f32 v[154:155], v[154:155], v[216:217], v[162:163] op_sel:[0,1,0]
    v_pk_fma_f32 v[156:157], v[156:157], v[216:217], v[164:165] op_sel:[0,1,0]
    v_pk_fma_f32 v[158:159], v[158:159], v[216:217], v[166:167] op_sel:[0,1,0]
    v_cvt_pk_bf16_f32 v116, v152, v153
    v_cvt_pk_bf16_f32 v117, v154, v155
    v_cvt_pk_bf16_f32 v118, v156, v157
    v_cvt_pk_bf16_f32 v119, v158, v159
    buffer_load_dwordx4 a[164:167], v254, s[36:39], s12 offen offset:1024 sc1
    v_pk_fma_f32 v[128:129], v[228:229], v[220:221], v[28:29] op_sel_hi:[1,0,1]
    v_pk_fma_f32 v[130:131], v[230:231], v[220:221], v[30:31] op_sel_hi:[1,0,1]
    v_pk_fma_f32 v[132:133], v[232:233], v[220:221], v[44:45] op_sel_hi:[1,0,1]
    v_pk_fma_f32 v[134:135], v[234:235], v[220:221], v[46:47] op_sel_hi:[1,0,1]
    v_pk_mul_f32 v[136:137], v[128:129], v[222:223] op_sel_hi:[1,0]
    v_pk_mul_f32 v[138:139], v[130:131], v[222:223] op_sel_hi:[1,0]
    v_pk_mul_f32 v[140:141], v[132:133], v[222:223] op_sel_hi:[1,0]
    v_pk_mul_f32 v[142:143], v[134:135], v[222:223] op_sel_hi:[1,0]
    v_exp_f32_e64 v136, v136 clamp
    v_max_f32 v128, v227, v128
    v_exp_f32_e64 v137, v137 clamp
    v_max_f32 v129, v227, v129
    v_exp_f32_e64 v138, v138 clamp
    v_max_f32 v130, v227, v130
    v_exp_f32_e64 v139, v139 clamp
    v_max_f32 v131, v227, v131
    buffer_load_dwordx4 a[168:171], v254, s[36:39], s12 offen offset:2048 sc1
    v_exp_f32_e64 v140, v140 clamp
    v_max_f32 v132, v227, v132
    v_exp_f32_e64 v141, v141 clamp
    v_max_f32 v133, v227, v133
    v_exp_f32_e64 v142, v142 clamp
    v_max_f32 v134, v227, v134
    v_exp_f32_e64 v143, v143 clamp
    v_max_f32 v135, v227, v135
    v_pk_fma_f32 v[128:129], v[128:129], v[220:221], v[136:137] op_sel:[0,1,0]
    v_pk_fma_f32 v[130:131], v[130:131], v[220:221], v[138:139] op_sel:[0,1,0]
    v_pk_fma_f32 v[132:133], v[132:133], v[220:221], v[140:141] op_sel:[0,1,0]
    v_pk_fma_f32 v[134:135], v[134:135], v[220:221], v[142:143] op_sel:[0,1,0]
    v_cvt_pk_bf16_f32 v122, v128, v129
    v_cvt_pk_bf16_f32 v123, v130, v131
    v_cvt_pk_bf16_f32 v124, v132, v133
    v_cvt_pk_bf16_f32 v125, v134, v135
    buffer_load_dwordx4 a[172:175], v254, s[36:39], s12 offen offset:3072 sc1
    s_add_u32 s12, s12, 4096
    v_pk_fma_f32 v[152:153], v[236:237], v[208:209], v[48:49] op_sel_hi:[1,0,1]
    v_pk_fma_f32 v[154:155], v[238:239], v[208:209], v[50:51] op_sel_hi:[1,0,1]
    v_pk_fma_f32 v[156:157], v[236:237], v[212:213], v[52:53] op_sel_hi:[1,0,1]
    v_pk_fma_f32 v[158:159], v[238:239], v[212:213], v[54:55] op_sel_hi:[1,0,1]
    v_pk_mul_f32 v[160:161], v[152:153], v[210:211] op_sel_hi:[1,0]
    v_pk_mul_f32 v[162:163], v[154:155], v[210:211] op_sel_hi:[1,0]
    v_pk_mul_f32 v[164:165], v[156:157], v[214:215] op_sel_hi:[1,0]
    v_pk_mul_f32 v[166:167], v[158:159], v[214:215] op_sel_hi:[1,0]
    v_exp_f32_e64 v160, v160 clamp
    v_max_f32 v152, v224, v152
    v_exp_f32_e64 v161, v161 clamp
    v_max_f32 v153, v224, v153
    v_exp_f32_e64 v162, v162 clamp
    v_max_f32 v154, v224, v154
    v_exp_f32_e64 v163, v163 clamp
    v_max_f32 v155, v224, v155
    buffer_load_dwordx4 a[176:179], v254, s[36:39], s12 offen offset:0 sc1
    s_add_u32 s12, s12, 36864
    v_exp_f32_e64 v164, v164 clamp
    v_max_f32 v156, v225, v156
    v_exp_f32_e64 v165, v165 clamp
    v_max_f32 v157, v225, v157
    v_exp_f32_e64 v166, v166 clamp
    v_max_f32 v158, v225, v158
    v_exp_f32_e64 v167, v167 clamp
    v_max_f32 v159, v225, v159
    v_pk_fma_f32 v[152:153], v[152:153], v[208:209], v[160:161] op_sel:[0,1,0]
    v_pk_fma_f32 v[154:155], v[154:155], v[208:209], v[162:163] op_sel:[0,1,0]
    v_pk_fma_f32 v[156:157], v[156:157], v[212:213], v[164:165] op_sel:[0,1,0]
    v_pk_fma_f32 v[158:159], v[158:159], v[212:213], v[166:167] op_sel:[0,1,0]
    v_cvt_pk_bf16_f32 v108, v152, v153
    v_cvt_pk_bf16_f32 v109, v154, v155
    v_cvt_pk_bf16_f32 v114, v156, v157
    v_cvt_pk_bf16_f32 v115, v158, v159
    buffer_load_dwordx4 a[180:183], v254, s[36:39], s12 offen offset:0 sc1
    s_lshl_b32 s66, s51, 3
    s_add_u32 s66, s66, s52
    s_mul_i32 s66, s66, 256
    s_add_u32 s66, s66, 12947584
    s_waitcnt vmcnt(10)
    s_barrier
    buffer_store_dword v251, v252, s[36:39], s66 offen sc1
    v_pk_fma_f32 v[128:129], v[236:237], v[216:217], v[56:57] op_sel_hi:[1,0,1]
    v_pk_fma_f32 v[130:131], v[238:239], v[216:217], v[58:59] op_sel_hi:[1,0,1]
    v_pk_fma_f32 v[132:133], v[236:237], v[220:221], v[60:61] op_sel_hi:[1,0,1]
    v_pk_fma_f32 v[134:135], v[238:239], v[220:221], v[62:63] op_sel_hi:[1,0,1]
    v_pk_mul_f32 v[136:137], v[128:129], v[218:219] op_sel_hi:[1,0]
    v_pk_mul_f32 v[138:139], v[130:131], v[218:219] op_sel_hi:[1,0]
    v_pk_mul_f32 v[140:141], v[132:133], v[222:223] op_sel_hi:[1,0]
    v_pk_mul_f32 v[142:143], v[134:135], v[222:223] op_sel_hi:[1,0]
    v_exp_f32_e64 v136, v136 clamp
    v_max_f32 v128, v226, v128
    v_exp_f32_e64 v137, v137 clamp
    v_max_f32 v129, v226, v129
    v_exp_f32_e64 v138, v138 clamp
    v_max_f32 v130, v226, v130
    v_exp_f32_e64 v139, v139 clamp
    v_max_f32 v131, v226, v131
    buffer_load_dwordx4 a[184:187], v254, s[36:39], s12 offen offset:1024 sc1
    v_exp_f32_e64 v140, v140 clamp
    v_max_f32 v132, v227, v132
    v_exp_f32_e64 v141, v141 clamp
    v_max_f32 v133, v227, v133
    v_exp_f32_e64 v142, v142 clamp
    v_max_f32 v134, v227, v134
    v_exp_f32_e64 v143, v143 clamp
    v_max_f32 v135, v227, v135
    v_pk_fma_f32 v[128:129], v[128:129], v[216:217], v[136:137] op_sel:[0,1,0]
    v_pk_fma_f32 v[130:131], v[130:131], v[216:217], v[138:139] op_sel:[0,1,0]
    v_pk_fma_f32 v[132:133], v[132:133], v[220:221], v[140:141] op_sel:[0,1,0]
    v_pk_fma_f32 v[134:135], v[134:135], v[220:221], v[142:143] op_sel:[0,1,0]
    v_cvt_pk_bf16_f32 v120, v128, v129
    v_cvt_pk_bf16_f32 v121, v130, v131
    v_cvt_pk_bf16_f32 v126, v132, v133
    v_cvt_pk_bf16_f32 v127, v134, v135
    buffer_load_dwordx4 a[188:191], v254, s[36:39], s12 offen offset:2048 sc1
    v_mul_u32_u24 v12, 128, v1
    v_mov_b32 v13, 1073741824
    v_cmp_gt_u32 vcc, 16, v1
    s_lshl_b32 s68, s17, 2
    buffer_load_dwordx4 a[192:195], v254, s[36:39], s12 offen offset:3072 sc1
    s_add_u32 s12, s12, 4096
    s_nop 0
    v_cndmask_b32 v253, v13, v12, vcc
    v_cmp_gt_u32 vcc, 4, v1
    s_xor_b32 s69, s48, 0
    buffer_load_dwordx4 a[196:199], v254, s[36:39], s12 offen offset:0 sc1
    s_add_u32 s12, s12, 36864
    s_add_u32 s69, s69, s68
    s_mul_i32 s4, s69, 49152
    s_mul_i32 s8, s69, 20480
    s_xor_b32 s69, s48, 1
    buffer_load_dwordx4 a[200:203], v254, s[36:39], s12 offen offset:0 sc1
    s_add_u32 s69, s69, s68
    s_mul_i32 s5, s69, 49152
    s_mul_i32 s9, s69, 20480
    s_xor_b32 s69, s48, 2
    buffer_load_dwordx4 a[204:207], v254, s[36:39], s12 offen offset:1024 sc1
    s_add_u32 s69, s69, s68
    s_mul_i32 s6, s69, 49152
    s_mul_i32 s10, s69, 20480
    s_xor_b32 s69, s48, 3
    buffer_load_dwordx4 a[208:211], v254, s[36:39], s12 offen offset:2048 sc1
    s_add_u32 s69, s69, s68
    s_mul_i32 s7, s69, 49152
    s_mul_i32 s11, s69, 20480
    v_cndmask_b32 v255, v13, v12, vcc
    buffer_load_dwordx4 a[212:215], v254, s[36:39], s12 offen offset:3072 sc1
    s_add_u32 s12, s12, 4096
    s_mul_i32 s69, s48, 12288
    s_mul_i32 s68, s48, 5120
    s_add_u32 s68, s68, 6815744
    s_add_u32 s4, s4, s69
    buffer_load_dwordx4 a[216:219], v254, s[36:39], s12 offen offset:0 sc1
    s_add_u32 s12, s12, 36864
    s_add_u32 s8, s8, s68
    s_add_u32 s5, s5, s69
    s_add_u32 s9, s9, s68
    s_add_u32 s6, s6, s69
    buffer_load_dwordx4 a[220:223], v254, s[36:39], s12 offen offset:0 sc1
    s_add_u32 s10, s10, s68
    s_add_u32 s7, s7, s69
    s_add_u32 s11, s11, s68
    s_lshr_b32 s68, s17, 1
    buffer_load_dwordx4 a[224:227], v254, s[36:39], s12 offen offset:1024 sc1
    s_lshl_b32 s68, s68, 2
    s_add_u32 s68, s68, s48
    s_mul_i32 s68, s68, 512
    s_add_u32 s14, s68, 12947456
    buffer_load_dwordx4 a[228:231], v254, s[36:39], s12 offen offset:2048 sc1
    s_lshr_b32 s68, s68, 1
    s_add_u32 s15, s68, 13209600
    v_cmp_gt_u32 vcc, 2, v1
    s_nop 1
    buffer_load_dwordx4 a[232:235], v254, s[36:39], s12 offen offset:3072 sc1
    s_add_u32 s12, s12, 4096
    v_cndmask_b32 v250, v13, v12, vcc
    v_add_u32 v248, 4096, v254
    buffer_load_dwordx4 a[236:239], v254, s[36:39], s12 offen offset:0 sc1
    s_add_u32 s12, s12, 36864
    buffer_load_dword v2, v253, s[36:39], s57 offen sc1
    buffer_load_dword v3, v255, s[36:39], s14 offen sc1
    s_lshl_b32 s66, s52, 1
    s_add_u32 s66, s66, s50
    s_lshr_b32 s67, s66, 2
    s_and_b32 s68, s66, 3
    s_add_u32 s66, s66, s67
    s_lshl_b32 s66, s66, 10
    s_mul_i32 s67, s67, 5120
    s_lshl_b32 s68, s68, 8
    s_add_u32 s68, s68, s67
    s_add_u32 s68, s68, 4096
    v_cmp_gt_u32 vcc, 16, v1
    v_mov_b32 v15, 1073741824
    s_lshl_b32 s67, s51, 1
    s_add_u32 s67, s67, s49
    s_mul_i32 s67, s67, 81920
    s_add_u32 s67, s67, 6815744
    s_add_u32 s22, s67, s66
    s_add_u32 s23, s67, s68
    v_cndmask_b32 v15, v15, v254, vcc
    s_add_u32 m0, s60, 0
    s_nop 0
    buffer_load_dwordx4 v254, s[36:39], s13 offen offset:0 sc1 lds
    buffer_load_dwordx4 v254, s[36:39], s13 offen offset:1024 sc1 lds
    buffer_load_dwordx4 v254, s[36:39], s13 offen offset:2048 sc1 lds
    s_waitcnt vmcnt(3)
    v_cmp_eq_u32 vcc, s54, v2
    s_nop 0
    s_and_b32 s68, vcc_lo, 0xffff
    s_cmp_eq_u32 s68, 0xffff
    s_cbranch_scc1 L_t1_pk_ok
    s_mov_b32 s69, 0
L_t1_pk:
    s_sleep 4
    buffer_load_dword v2, v253, s[36:39], s57 offen sc1
    buffer_load_dword v3, v255, s[36:39], s14 offen sc1
    s_add_u32 s69, s69, 1
    s_waitcnt vmcnt(0)
    v_cmp_eq_u32 vcc, s54, v2
    s_nop 0
    s_and_b32 s68, vcc_lo, 0xffff
    s_cmp_eq_u32 s68, 0xffff
    s_cbranch_scc1 L_t1_pk_ok
    s_cmp_lt_u32 s69, 262144
    s_cbranch_scc1 L_t1_pk
L_t1_pk_ok:
    s_mov_b32 s66, m0
    s_mov_b32 m0, s71
    s_nop 0
    buffer_load_dwordx4 v254, s[36:39], s70 offen offset:0 sc1 lds
    buffer_load_dwordx4 v254, s[36:39], s70 offen offset:1024 sc1 lds
    buffer_load_dwordx4 v254, s[36:39], s70 offen offset:2048 sc1 lds
    buffer_load_dwordx4 v196, s[36:39], s70 offen offset:3072 sc1 lds
    s_mov_b32 m0, s66
    v_cmp_eq_u32 vcc, s54, v3
    s_nop 0
    s_and_b32 s68, vcc_lo, 10
    s_cmp_eq_u32 s68, 10
    s_cbranch_scc1 L_t1_ph_ok
    s_mov_b32 s69, 0
L_t1_ph:
    s_sleep 4
L_t1_ph_go:
    buffer_load_dword v3, v255, s[36:39], s14 offen offset:0 sc1
    s_add_u32 s69, s69, 1
    s_waitcnt vmcnt(0)
    v_cmp_eq_u32 vcc, s54, v3
    s_nop 0
    s_and_b32 s68, vcc_lo, 10
    s_cmp_eq_u32 s68, 10
    s_cbranch_scc1 L_t1_ph_ok
    s_cmp_lt_u32 s69, 262144
    s_cbranch_scc1 L_t1_ph
L_t1_ph_ok:
    s_and_b32 s68, vcc_lo, 5
    s_cmp_eq_u32 s68, 5
    s_cselect_b32 s56, s65, s14
    buffer_load_dwordx4 v[16:19], v254, s[36:39], s4 offen offset:0 sc1
    buffer_load_dwordx4 v[20:23], v254, s[36:39], s5 offen offset:0 sc1
    buffer_load_dwordx4 v[24:27], v254, s[36:39], s6 offen offset:0 sc1
    buffer_load_dwordx4 v[28:31], v254, s[36:39], s7 offen offset:0 sc1
    buffer_load_dwordx4 v[32:35], v254, s[36:39], s4 offen offset:1024 sc1
    buffer_load_dwordx4 v[36:39], v254, s[36:39], s5 offen offset:1024 sc1
    buffer_load_dwordx4 v[40:43], v254, s[36:39], s6 offen offset:1024 sc1
    buffer_load_dwordx4 v[44:47], v254, s[36:39], s7 offen offset:1024 sc1
    v_permlane16_swap_b32 v170, v172
    v_permlane16_swap_b32 v171, v173
    v_permlane16_swap_b32 v174, v176
    v_permlane16_swap_b32 v175, v177
    v_lshlrev_b32 v128, 16, v170
    v_and_b32 v129, 0xffff0000, v170
    v_lshlrev_b32 v130, 16, v171
    v_and_b32 v131, 0xffff0000, v171
    v_lshlrev_b32 v132, 16, v172
    v_and_b32 v133, 0xffff0000, v172
    v_lshlrev_b32 v134, 16, v173
    v_and_b32 v135, 0xffff0000, v173
    v_lshlrev_b32 v136, 16, v174
    v_and_b32 v137, 0xffff0000, v174
    v_lshlrev_b32 v138, 16, v175
    v_and_b32 v139, 0xffff0000, v175
    v_lshlrev_b32 v140, 16, v176
    v_and_b32 v141, 0xffff0000, v176
    v_lshlrev_b32 v142, 16, v177
    v_and_b32 v143, 0xffff0000, v177
    v_lshlrev_b32 v144, 16, v178
    v_and_b32 v145, 0xffff0000, v178
    v_lshlrev_b32 v146, 16, v179
    v_and_b32 v147, 0xffff0000, v179
    s_waitcnt vmcnt(8)
    ds_read_b128 v[208:211], v4
    ds_read_b128 v[212:215], v5
    ds_read_b128 v[216:219], v6
    ds_read_b128 v[220:223], v7
    ds_read_b128 v[224:227], v8
    ds_read_b128 v[228:231], v9
    ds_read_b128 v[232:235], v10
    ds_read_b128 v[236:239], v11
    buffer_load_dwordx4 v[48:51], v254, s[36:39], s4 offen offset:2048 sc1
    buffer_load_dwordx4 v[52:55], v254, s[36:39], s5 offen offset:2048 sc1
    s_waitcnt lgkmcnt(0)
    v_cvt_pk_bf16_f32 v80, v208, v209
    v_cvt_pk_bf16_f32 v81, v210, v211
    v_cvt_pk_bf16_f32 v82, v212, v213
    v_cvt_pk_bf16_f32 v83, v214, v215
    v_cvt_pk_bf16_f32 v84, v216, v217
    v_cvt_pk_bf16_f32 v85, v218, v219
    v_cvt_pk_bf16_f32 v86, v220, v221
    v_cvt_pk_bf16_f32 v87, v222, v223
    v_cvt_pk_bf16_f32 v88, v224, v225
    v_cvt_pk_bf16_f32 v89, v226, v227
    v_cvt_pk_bf16_f32 v90, v228, v229
    v_cvt_pk_bf16_f32 v91, v230, v231
    buffer_load_dwordx4 v[56:59], v254, s[36:39], s6 offen offset:2048 sc1
    v_cvt_pk_bf16_f32 v92, v232, v233
    v_cvt_pk_bf16_f32 v93, v234, v235
    v_cvt_pk_bf16_f32 v94, v236, v237
    v_cvt_pk_bf16_f32 v95, v238, v239
    v_mfma_f32_16x16x32_bf16 v[212:215], v[84:87], v[104:107], 0
    s_nop 0
    v_mfma_f32_16x16x32_bf16 v[220:223], v[92:95], v[106:109], 0
    v_mfma_f32_16x16x32_bf16 v[208:211], v[80:83], v[104:107], 0
    v_mfma_f32_16x16x32_bf16 v[216:219], v[88:91], v[106:109], 0
    v_mfma_f32_16x16x32_bf16 v[228:231], v[84:87], v[110:113], 0
    v_mfma_f32_16x16x32_bf16 v[236:239], v[92:95], v[112:115], 0
    v_mfma_f32_16x16x32_bf16 v[224:227], v[80:83], v[110:113], 0
    v_mfma_f32_16x16x32_bf16 v[232:235], v[88:91], v[112:115], 0
    buffer_load_dwordx4 v[60:63], v254, s[36:39], s7 offen offset:2048 sc1
    v_mov_b32 v96, v212
    s_nop 2
    v_mov_b32 v100, v228
    v_mov_b32 v97, v212
    v_mov_b32 v101, v228
    v_mov_b32 v98, v220
    v_mov_b32 v102, v236
    v_mov_b32 v99, v220
    v_mov_b32 v103, v236
    v_permlane16_swap_b32 v96, v97
    v_permlane16_swap_b32 v100, v101
    v_permlane16_swap_b32 v98, v99
    v_permlane16_swap_b32 v102, v103
    buffer_load_dwordx4 v[64:67], v254, s[36:39], s4 offen offset:3072 sc1
    v_add_f32 v96, 897988541, v97
    v_add_f32 v100, 897988541, v101
    v_add_f32 v98, 897988541, v99
    v_add_f32 v102, 897988541, v103
    v_rcp_f32 v96, v96
    v_rcp_f32 v100, v100
    v_rcp_f32 v98, v98
    v_rcp_f32 v102, v102
    v_pk_mul_f32 v[208:209], v[208:209], v[96:97] op_sel_hi:[1,0]
    v_pk_mul_f32 v[210:211], v[210:211], v[96:97] op_sel_hi:[1,0]
    v_pk_mul_f32 v[216:217], v[216:217], v[98:99] op_sel_hi:[1,0]
    v_pk_mul_f32 v[218:219], v[218:219], v[98:99] op_sel_hi:[1,0]
    buffer_load_dwordx4 v[68:71], v254, s[36:39], s5 offen offset:3072 sc1
    v_cvt_pk_bf16_f32 v240, v208, v209
    v_cvt_pk_bf16_f32 v241, v210, v211
    v_cvt_pk_bf16_f32 v242, v216, v217
    v_cvt_pk_bf16_f32 v243, v218, v219
    buffer_store_dwordx4 v[240:243], v254, s[36:39], s22 offen sc1
    v_pk_mul_f32 v[212:213], v[212:213], v[96:97] op_sel_hi:[1,0]
    v_pk_mul_f32 v[214:215], v[214:215], v[96:97] op_sel_hi:[1,0]
    v_pk_mul_f32 v[220:221], v[220:221], v[98:99] op_sel_hi:[1,0]
    v_pk_mul_f32 v[222:223], v[222:223], v[98:99] op_sel_hi:[1,0]
    v_cvt_pk_bf16_f32 v244, v212, v213
    v_cvt_pk_bf16_f32 v245, v214, v215
    v_cvt_pk_bf16_f32 v246, v220, v221
    buffer_load_dwordx4 v[72:75], v254, s[36:39], s6 offen offset:3072 sc1
    v_cvt_pk_bf16_f32 v247, v222, v223
    buffer_store_dwordx4 v[244:247], v15, s[36:39], s23 offen sc1
    s_add_u32 s22, s22, 20480
    s_add_u32 s23, s23, 20480
    v_mfma_f32_16x16x32_bf16 v[212:215], v[84:87], v[116:119], 0
    v_mfma_f32_16x16x32_bf16 v[220:223], v[92:95], v[118:121], 0
    v_mfma_f32_16x16x32_bf16 v[208:211], v[80:83], v[116:119], 0
    v_mfma_f32_16x16x32_bf16 v[216:219], v[88:91], v[118:121], 0
    v_pk_mul_f32 v[224:225], v[224:225], v[100:101] op_sel_hi:[1,0]
    v_pk_mul_f32 v[226:227], v[226:227], v[100:101] op_sel_hi:[1,0]
    v_pk_mul_f32 v[232:233], v[232:233], v[102:103] op_sel_hi:[1,0]
    v_pk_mul_f32 v[234:235], v[234:235], v[102:103] op_sel_hi:[1,0]
    buffer_load_dwordx4 v[76:79], v254, s[36:39], s7 offen offset:3072 sc1
    v_cvt_pk_bf16_f32 v4, v224, v225
    v_cvt_pk_bf16_f32 v5, v226, v227
    v_cvt_pk_bf16_f32 v6, v232, v233
    v_cvt_pk_bf16_f32 v7, v234, v235
    buffer_store_dwordx4 v[4:7], v254, s[36:39], s22 offen sc1
    v_pk_mul_f32 v[228:229], v[228:229], v[100:101] op_sel_hi:[1,0]
    v_pk_mul_f32 v[230:231], v[230:231], v[100:101] op_sel_hi:[1,0]
    v_pk_mul_f32 v[236:237], v[236:237], v[102:103] op_sel_hi:[1,0]
    v_pk_mul_f32 v[238:239], v[238:239], v[102:103] op_sel_hi:[1,0]
    v_cvt_pk_bf16_f32 v8, v228, v229
    v_cvt_pk_bf16_f32 v9, v230, v231
    v_cvt_pk_bf16_f32 v10, v236, v237
    s_add_u32 s4, s4, 4096
    s_add_u32 s5, s5, 4096
    s_add_u32 s6, s6, 4096
    s_add_u32 s7, s7, 4096
    v_cvt_pk_bf16_f32 v11, v238, v239
    buffer_store_dwordx4 v[8:11], v15, s[36:39], s23 offen sc1
    s_add_u32 s22, s22, 20480
    s_add_u32 s23, s23, 20480
    v_mfma_f32_16x16x32_bf16 v[228:231], v[84:87], v[122:125], 0
    v_mfma_f32_16x16x32_bf16 v[236:239], v[92:95], v[124:127], 0
    v_mfma_f32_16x16x32_bf16 v[224:227], v[80:83], v[122:125], 0
    v_mfma_f32_16x16x32_bf16 v[232:235], v[88:91], v[124:127], 0
    v_mov_b32 v96, v212
    s_nop 3
    v_mov_b32 v100, v228
    v_mov_b32 v97, v212
    v_mov_b32 v101, v228
    buffer_load_dwordx4 v254, s[36:39], s13 offen offset:3072 sc1 lds
    s_add_u32 s13, s13, 4096
    v_mov_b32 v98, v220
    v_mov_b32 v102, v236
    v_mov_b32 v99, v220
    v_mov_b32 v103, v236
    v_permlane16_swap_b32 v96, v97
    v_permlane16_swap_b32 v100, v101
    v_permlane16_swap_b32 v98, v99
    v_permlane16_swap_b32 v102, v103
    v_add_f32 v96, 897988541, v97
    v_add_f32 v100, 897988541, v101
    v_add_f32 v98, 897988541, v99
    v_add_f32 v102, 897988541, v103
    s_add_u32 m0, s60, 4096
    s_nop 0
    buffer_load_dwordx4 v254, s[36:39], s13 offen offset:0 sc1 lds
    s_add_u32 s13, s13, 36864
    v_rcp_f32 v96, v96
    v_rcp_f32 v100, v100
    v_rcp_f32 v98, v98
    v_rcp_f32 v102, v102
    v_pk_mul_f32 v[208:209], v[208:209], v[96:97] op_sel_hi:[1,0]
    v_pk_mul_f32 v[210:211], v[210:211], v[96:97] op_sel_hi:[1,0]
    v_pk_mul_f32 v[216:217], v[216:217], v[98:99] op_sel_hi:[1,0]
    v_pk_mul_f32 v[218:219], v[218:219], v[98:99] op_sel_hi:[1,0]
    v_cvt_pk_bf16_f32 v240, v208, v209
    v_cvt_pk_bf16_f32 v241, v210, v211
    v_cvt_pk_bf16_f32 v242, v216, v217
    v_cvt_pk_bf16_f32 v243, v218, v219
    s_add_u32 m0, s60, 5120
    s_nop 0
    buffer_load_dwordx4 v254, s[36:39], s13 offen offset:0 sc1 lds
    buffer_store_dwordx4 v[240:243], v254, s[36:39], s22 offen sc1
    v_pk_mul_f32 v[212:213], v[212:213], v[96:97] op_sel_hi:[1,0]
    v_pk_mul_f32 v[214:215], v[214:215], v[96:97] op_sel_hi:[1,0]
    v_pk_mul_f32 v[220:221], v[220:221], v[98:99] op_sel_hi:[1,0]
    v_pk_mul_f32 v[222:223], v[222:223], v[98:99] op_sel_hi:[1,0]
    v_cvt_pk_bf16_f32 v244, v212, v213
    v_cvt_pk_bf16_f32 v245, v214, v215
    v_cvt_pk_bf16_f32 v246, v220, v221
    v_cvt_pk_bf16_f32 v247, v222, v223
    buffer_store_dwordx4 v[244:247], v15, s[36:39], s23 offen sc1
    s_add_u32 s22, s22, 20480
    s_add_u32 s23, s23, 20480
    buffer_load_dwordx4 v254, s[36:39], s13 offen offset:1024 sc1 lds
    v_pk_mul_f32 v[224:225], v[224:225], v[100:101] op_sel_hi:[1,0]
    v_pk_mul_f32 v[226:227], v[226:227], v[100:101] op_sel_hi:[1,0]
    v_pk_mul_f32 v[232:233], v[232:233], v[102:103] op_sel_hi:[1,0]
    v_pk_mul_f32 v[234:235], v[234:235], v[102:103] op_sel_hi:[1,0]
    v_cvt_pk_bf16_f32 v4, v224, v225
    v_cvt_pk_bf16_f32 v5, v226, v227
    v_cvt_pk_bf16_f32 v6, v232, v233
    v_cvt_pk_bf16_f32 v7, v234, v235
    buffer_store_dwordx4 v[4:7], v254, s[36:39], s22 offen sc1
    v_pk_mul_f32 v[228:229], v[228:229], v[100:101] op_sel_hi:[1,0]
    v_pk_mul_f32 v[230:231], v[230:231], v[100:101] op_sel_hi:[1,0]
    v_pk_mul_f32 v[236:237], v[236:237], v[102:103] op_sel_hi:[1,0]
    buffer_load_dwordx4 v254, s[36:39], s13 offen offset:2048 sc1 lds
    v_pk_mul_f32 v[238:239], v[238:239], v[102:103] op_sel_hi:[1,0]
    v_cvt_pk_bf16_f32 v8, v228, v229
    v_cvt_pk_bf16_f32 v9, v230, v231
    v_cvt_pk_bf16_f32 v10, v236, v237
    v_cvt_pk_bf16_f32 v11, v238, v239
    buffer_store_dwordx4 v[8:11], v15, s[36:39], s23 offen sc1
    s_add_u32 s22, s22, 20480
    s_add_u32 s23, s23, 20480
    s_waitcnt vmcnt(25)
    v_mfma_f32_16x16x32_bf16 v[128:131], a[0:3], v[16:19], v[128:131]
    v_mfma_f32_16x16x32_bf16 v[132:135], a[4:7], v[16:19], v[132:135]
    v_mfma_f32_16x16x32_bf16 v[136:139], a[8:11], v[16:19], v[136:139]
    v_mfma_f32_16x16x32_bf16 v[140:143], a[12:15], v[16:19], v[140:143]
    v_mfma_f32_16x16x32_bf16 v[144:147], a[16:19], v[16:19], v[144:147]
    v_mfma_f32_16x16x32_bf16 v[148:151], a[0:3], v[20:23], 0
    v_mfma_f32_16x16x32_bf16 v[152:155], a[4:7], v[20:23], 0
    v_mfma_f32_16x16x32_bf16 v[156:159], a[8:11], v[20:23], 0
    v_mfma_f32_16x16x32_bf16 v[160:163], a[12:15], v[20:23], 0
    v_mfma_f32_16x16x32_bf16 v[164:167], a[16:19], v[20:23], 0
    v_mfma_f32_16x16x32_bf16 v[168:171], a[0:3], v[24:27], 0
    v_mfma_f32_16x16x32_bf16 v[172:175], a[4:7], v[24:27], 0
    v_mfma_f32_16x16x32_bf16 v[176:179], a[8:11], v[24:27], 0
    v_mfma_f32_16x16x32_bf16 v[180:183], a[12:15], v[24:27], 0
    v_mfma_f32_16x16x32_bf16 v[184:187], a[16:19], v[24:27], 0
    v_mfma_f32_16x16x32_bf16 v[188:191], a[0:3], v[28:31], 0
    v_mfma_f32_16x16x32_bf16 v[192:195], a[4:7], v[28:31], 0
    v_mfma_f32_16x16x32_bf16 v[196:199], a[8:11], v[28:31], 0
    v_mfma_f32_16x16x32_bf16 v[200:203], a[12:15], v[28:31], 0
    v_mfma_f32_16x16x32_bf16 v[204:207], a[16:19], v[28:31], 0
    s_waitcnt vmcnt(21)
    v_mfma_f32_16x16x32_bf16 v[128:131], a[20:23], v[32:35], v[128:131]
    buffer_load_dwordx4 v[16:19], v254, s[36:39], s4 offen offset:0 sc1
    v_mfma_f32_16x16x32_bf16 v[132:135], a[24:27], v[32:35], v[132:135]
    v_mfma_f32_16x16x32_bf16 v[136:139], a[28:31], v[32:35], v[136:139]
    v_mfma_f32_16x16x32_bf16 v[140:143], a[32:35], v[32:35], v[140:143]
    v_mfma_f32_16x16x32_bf16 v[144:147], a[36:39], v[32:35], v[144:147]
    buffer_load_dwordx4 v[20:23], v254, s[36:39], s5 offen offset:0 sc1
    v_mfma_f32_16x16x32_bf16 v[148:151], a[20:23], v[36:39], v[148:151]
    v_mfma_f32_16x16x32_bf16 v[152:155], a[24:27], v[36:39], v[152:155]
    v_mfma_f32_16x16x32_bf16 v[156:159], a[28:31], v[36:39], v[156:159]
    v_mfma_f32_16x16x32_bf16 v[160:163], a[32:35], v[36:39], v[160:163]
    buffer_load_dwordx4 v[24:27], v254, s[36:39], s6 offen offset:0 sc1
    v_mfma_f32_16x16x32_bf16 v[164:167], a[36:39], v[36:39], v[164:167]
    v_mfma_f32_16x16x32_bf16 v[168:171], a[20:23], v[40:43], v[168:171]
    v_mfma_f32_16x16x32_bf16 v[172:175], a[24:27], v[40:43], v[172:175]
    v_mfma_f32_16x16x32_bf16 v[176:179], a[28:31], v[40:43], v[176:179]
    buffer_load_dwordx4 v[28:31], v254, s[36:39], s7 offen offset:0 sc1
    v_mfma_f32_16x16x32_bf16 v[180:183], a[32:35], v[40:43], v[180:183]
    v_mfma_f32_16x16x32_bf16 v[184:187], a[36:39], v[40:43], v[184:187]
    v_mfma_f32_16x16x32_bf16 v[188:191], a[20:23], v[44:47], v[188:191]
    v_mfma_f32_16x16x32_bf16 v[192:195], a[24:27], v[44:47], v[192:195]
    v_mfma_f32_16x16x32_bf16 v[196:199], a[28:31], v[44:47], v[196:199]
    v_mfma_f32_16x16x32_bf16 v[200:203], a[32:35], v[44:47], v[200:203]
    v_mfma_f32_16x16x32_bf16 v[204:207], a[36:39], v[44:47], v[204:207]
    s_waitcnt vmcnt(21)
    v_mfma_f32_16x16x32_bf16 v[128:131], a[40:43], v[48:51], v[128:131]
    buffer_load_dwordx4 v[32:35], v254, s[36:39], s4 offen offset:1024 sc1
    v_mfma_f32_16x16x32_bf16 v[132:135], a[44:47], v[48:51], v[132:135]
    v_mfma_f32_16x16x32_bf16 v[136:139], a[48:51], v[48:51], v[136:139]
    v_mfma_f32_16x16x32_bf16 v[140:143], a[52:55], v[48:51], v[140:143]
    v_mfma_f32_16x16x32_bf16 v[144:147], a[56:59], v[48:51], v[144:147]
    buffer_load_dwordx4 v[36:39], v254, s[36:39], s5 offen offset:1024 sc1
    v_mfma_f32_16x16x32_bf16 v[148:151], a[40:43], v[52:55], v[148:151]
    v_mfma_f32_16x16x32_bf16 v[152:155], a[44:47], v[52:55], v[152:155]
    v_mfma_f32_16x16x32_bf16 v[156:159], a[48:51], v[52:55], v[156:159]
    v_mfma_f32_16x16x32_bf16 v[160:163], a[52:55], v[52:55], v[160:163]
    buffer_load_dwordx4 v[40:43], v254, s[36:39], s6 offen offset:1024 sc1
    v_mfma_f32_16x16x32_bf16 v[164:167], a[56:59], v[52:55], v[164:167]
    v_mfma_f32_16x16x32_bf16 v[168:171], a[40:43], v[56:59], v[168:171]
    v_mfma_f32_16x16x32_bf16 v[172:175], a[44:47], v[56:59], v[172:175]
    v_mfma_f32_16x16x32_bf16 v[176:179], a[48:51], v[56:59], v[176:179]
    buffer_load_dwordx4 v[44:47], v254, s[36:39], s7 offen offset:1024 sc1
    v_mfma_f32_16x16x32_bf16 v[180:183], a[52:55], v[56:59], v[180:183]
    v_mfma_f32_16x16x32_bf16 v[184:187], a[56:59], v[56:59], v[184:187]
    v_mfma_f32_16x16x32_bf16 v[188:191], a[40:43], v[60:63], v[188:191]
    v_mfma_f32_16x16x32_bf16 v[192:195], a[44:47], v[60:63], v[192:195]
    v_mfma_f32_16x16x32_bf16 v[196:199], a[48:51], v[60:63], v[196:199]
    v_mfma_f32_16x16x32_bf16 v[200:203], a[52:55], v[60:63], v[200:203]
    v_mfma_f32_16x16x32_bf16 v[204:207], a[56:59], v[60:63], v[204:207]
    s_waitcnt vmcnt(8)
    s_barrier
    s_lshl_b32 s68, s51, 3
    s_add_u32 s68, s68, s52
    s_mul_i32 s68, s68, 128
    s_add_u32 s68, s68, 13209600
    buffer_load_dwordx4 v[48:51], v254, s[36:39], s4 offen offset:2048 sc1
    buffer_load_dwordx4 v[52:55], v254, s[36:39], s5 offen offset:2048 sc1
    buffer_load_dwordx4 v[56:59], v254, s[36:39], s6 offen offset:2048 sc1
    buffer_load_dwordx4 v[60:63], v254, s[36:39], s7 offen offset:2048 sc1
    buffer_store_dword v251, v252, s[36:39], s68 offen sc1
    v_mfma_f32_16x16x32_bf16 v[128:131], a[60:63], v[64:67], v[128:131]
    buffer_load_dword v3, v255, s[36:39], s56 offen sc1
    v_mfma_f32_16x16x32_bf16 v[132:135], a[64:67], v[64:67], v[132:135]
    v_mfma_f32_16x16x32_bf16 v[136:139], a[68:71], v[64:67], v[136:139]
    v_mfma_f32_16x16x32_bf16 v[140:143], a[72:75], v[64:67], v[140:143]
    v_mfma_f32_16x16x32_bf16 v[144:147], a[76:79], v[64:67], v[144:147]
    buffer_load_dwordx4 v254, s[36:39], s13 offen offset:3072 sc1 lds
    v_mfma_f32_16x16x32_bf16 v[148:151], a[60:63], v[68:71], v[148:151]
    s_add_u32 s13, s13, 4096
    v_mfma_f32_16x16x32_bf16 v[152:155], a[64:67], v[68:71], v[152:155]
    s_add_u32 m0, s60, 9216
    v_mfma_f32_16x16x32_bf16 v[156:159], a[68:71], v[68:71], v[156:159]
    v_mfma_f32_16x16x32_bf16 v[160:163], a[72:75], v[68:71], v[160:163]
    buffer_load_dwordx4 v254, s[36:39], s13 offen offset:0 sc1 lds
    v_mfma_f32_16x16x32_bf16 v[164:167], a[76:79], v[68:71], v[164:167]
    s_add_u32 s13, s13, 36864
    v_mfma_f32_16x16x32_bf16 v[168:171], a[60:63], v[72:75], v[168:171]
    s_add_u32 m0, s60, 10240
    v_mfma_f32_16x16x32_bf16 v[172:175], a[64:67], v[72:75], v[172:175]
    v_mfma_f32_16x16x32_bf16 v[176:179], a[68:71], v[72:75], v[176:179]
    buffer_load_dwordx4 v254, s[36:39], s13 offen offset:0 sc1 lds
    v_mfma_f32_16x16x32_bf16 v[180:183], a[72:75], v[72:75], v[180:183]
    v_mfma_f32_16x16x32_bf16 v[184:187], a[76:79], v[72:75], v[184:187]
    v_mfma_f32_16x16x32_bf16 v[188:191], a[60:63], v[76:79], v[188:191]
    v_mfma_f32_16x16x32_bf16 v[192:195], a[64:67], v[76:79], v[192:195]
    v_mfma_f32_16x16x32_bf16 v[196:199], a[68:71], v[76:79], v[196:199]
    v_mfma_f32_16x16x32_bf16 v[200:203], a[72:75], v[76:79], v[200:203]
    v_mfma_f32_16x16x32_bf16 v[204:207], a[76:79], v[76:79], v[204:207]
    s_waitcnt vmcnt(13)
    v_mfma_f32_16x16x32_bf16 v[128:131], a[80:83], v[16:19], v[128:131]
    buffer_load_dwordx4 v[64:67], v254, s[36:39], s4 offen offset:3072 sc1
    v_mfma_f32_16x16x32_bf16 v[132:135], a[84:87], v[16:19], v[132:135]
    v_mfma_f32_16x16x32_bf16 v[136:139], a[88:91], v[16:19], v[136:139]
    buffer_load_dwordx4 v[68:71], v254, s[36:39], s5 offen offset:3072 sc1
    v_mfma_f32_16x16x32_bf16 v[140:143], a[92:95], v[16:19], v[140:143]
    v_mfma_f32_16x16x32_bf16 v[144:147], a[96:99], v[16:19], v[144:147]
    buffer_load_dwordx4 v[72:75], v254, s[36:39], s6 offen offset:3072 sc1
    v_mfma_f32_16x16x32_bf16 v[148:151], a[80:83], v[20:23], v[148:151]
    v_mfma_f32_16x16x32_bf16 v[152:155], a[84:87], v[20:23], v[152:155]
    buffer_load_dwordx4 v[76:79], v254, s[36:39], s7 offen offset:3072 sc1
    v_mfma_f32_16x16x32_bf16 v[156:159], a[88:91], v[20:23], v[156:159]
    s_add_u32 s4, s4, 4096
    v_mfma_f32_16x16x32_bf16 v[160:163], a[92:95], v[20:23], v[160:163]
    s_add_u32 s5, s5, 4096
    s_add_u32 s6, s6, 4096
    s_add_u32 s7, s7, 4096
    buffer_load_dwordx4 v254, s[36:39], s13 offen offset:1024 sc1 lds
    v_mfma_f32_16x16x32_bf16 v[164:167], a[96:99], v[20:23], v[164:167]
    v_mfma_f32_16x16x32_bf16 v[168:171], a[80:83], v[24:27], v[168:171]
    buffer_load_dwordx4 v254, s[36:39], s13 offen offset:2048 sc1 lds
    v_mfma_f32_16x16x32_bf16 v[172:175], a[84:87], v[24:27], v[172:175]
    v_mfma_f32_16x16x32_bf16 v[176:179], a[88:91], v[24:27], v[176:179]
    buffer_load_dwordx4 v254, s[36:39], s13 offen offset:3072 sc1 lds
    v_mfma_f32_16x16x32_bf16 v[180:183], a[92:95], v[24:27], v[180:183]
    s_add_u32 s13, s13, 4096
    v_mfma_f32_16x16x32_bf16 v[184:187], a[96:99], v[24:27], v[184:187]
    v_mfma_f32_16x16x32_bf16 v[188:191], a[80:83], v[28:31], v[188:191]
    v_mfma_f32_16x16x32_bf16 v[192:195], a[84:87], v[28:31], v[192:195]
    v_mfma_f32_16x16x32_bf16 v[196:199], a[88:91], v[28:31], v[196:199]
    v_mfma_f32_16x16x32_bf16 v[200:203], a[92:95], v[28:31], v[200:203]
    v_mfma_f32_16x16x32_bf16 v[204:207], a[96:99], v[28:31], v[204:207]
    s_cmp_eq_u32 s56, s65
    s_cbranch_scc1 L_t1_p0_ok
    s_waitcnt vmcnt(10)
    v_cmp_eq_u32 vcc, s54, v3
    s_nop 0
    s_and_b32 s68, vcc_lo, 5
    s_cmp_eq_u32 s68, 5
    s_cbranch_scc1 L_t1_p0_ok
    s_mov_b32 s69, 0
L_t1_p0:
    s_sleep 4
L_t1_p0_go:
    buffer_load_dword v3, v255, s[36:39], s14 offen offset:0 sc1
    s_add_u32 s69, s69, 1
    s_waitcnt vmcnt(0)
    v_cmp_eq_u32 vcc, s54, v3
    s_nop 0
    s_and_b32 s68, vcc_lo, 5
    s_cmp_eq_u32 s68, 5
    s_cbranch_scc1 L_t1_p0_ok
    s_cmp_lt_u32 s69, 262144
    s_cbranch_scc1 L_t1_p0
L_t1_p0_ok:
    s_waitcnt vmcnt(16)
    v_mfma_f32_16x16x32_bf16 v[128:131], a[100:103], v[32:35], v[128:131]
    buffer_load_dwordx4 v[16:19], v254, s[36:39], s4 offen offset:0 sc1
    v_mfma_f32_16x16x32_bf16 v[132:135], a[104:107], v[32:35], v[132:135]
    v_mfma_f32_16x16x32_bf16 v[136:139], a[108:111], v[32:35], v[136:139]
    buffer_load_dwordx4 v[20:23], v254, s[36:39], s5 offen offset:0 sc1
    v_mfma_f32_16x16x32_bf16 v[140:143], a[112:115], v[32:35], v[140:143]
    v_mfma_f32_16x16x32_bf16 v[144:147], a[116:119], v[32:35], v[144:147]
    buffer_load_dwordx4 v[24:27], v254, s[36:39], s6 offen offset:0 sc1
    v_mfma_f32_16x16x32_bf16 v[148:151], a[100:103], v[36:39], v[148:151]
    v_mfma_f32_16x16x32_bf16 v[152:155], a[104:107], v[36:39], v[152:155]
    buffer_load_dwordx4 v[28:31], v254, s[36:39], s7 offen offset:0 sc1
    v_mfma_f32_16x16x32_bf16 v[156:159], a[108:111], v[36:39], v[156:159]
    s_add_u32 m0, s60, 14336
    v_mfma_f32_16x16x32_bf16 v[160:163], a[112:115], v[36:39], v[160:163]
    buffer_load_dwordx4 v254, s[36:39], s13 offen offset:0 sc1 lds
    v_mfma_f32_16x16x32_bf16 v[164:167], a[116:119], v[36:39], v[164:167]
    s_add_u32 s13, s13, 36864
    v_mfma_f32_16x16x32_bf16 v[168:171], a[100:103], v[40:43], v[168:171]
    s_add_u32 m0, s60, 15360
    s_nop 0
    buffer_load_dwordx4 v254, s[36:39], s13 offen offset:0 sc1 lds
    v_mfma_f32_16x16x32_bf16 v[172:175], a[104:107], v[40:43], v[172:175]
    v_mfma_f32_16x16x32_bf16 v[176:179], a[108:111], v[40:43], v[176:179]
    buffer_load_dwordx4 v254, s[36:39], s13 offen offset:1024 sc1 lds
    v_mfma_f32_16x16x32_bf16 v[180:183], a[112:115], v[40:43], v[180:183]
    v_mfma_f32_16x16x32_bf16 v[184:187], a[116:119], v[40:43], v[184:187]
    v_mfma_f32_16x16x32_bf16 v[188:191], a[100:103], v[44:47], v[188:191]
    v_mfma_f32_16x16x32_bf16 v[192:195], a[104:107], v[44:47], v[192:195]
    v_mfma_f32_16x16x32_bf16 v[196:199], a[108:111], v[44:47], v[196:199]
    v_mfma_f32_16x16x32_bf16 v[200:203], a[112:115], v[44:47], v[200:203]
    v_mfma_f32_16x16x32_bf16 v[204:207], a[116:119], v[44:47], v[204:207]
    s_waitcnt vmcnt(19)
    v_mfma_f32_16x16x32_bf16 v[128:131], a[120:123], v[48:51], v[128:131]
    buffer_load_dwordx4 v[32:35], v254, s[36:39], s4 offen offset:1024 sc1
    v_mfma_f32_16x16x32_bf16 v[132:135], a[124:127], v[48:51], v[132:135]
    v_mfma_f32_16x16x32_bf16 v[136:139], a[128:131], v[48:51], v[136:139]
    buffer_load_dwordx4 v[36:39], v254, s[36:39], s5 offen offset:1024 sc1
    v_mfma_f32_16x16x32_bf16 v[140:143], a[132:135], v[48:51], v[140:143]
    v_mfma_f32_16x16x32_bf16 v[144:147], a[136:139], v[48:51], v[144:147]
    buffer_load_dwordx4 v[40:43], v254, s[36:39], s6 offen offset:1024 sc1
    v_mfma_f32_16x16x32_bf16 v[148:151], a[120:123], v[52:55], v[148:151]
    v_mfma_f32_16x16x32_bf16 v[152:155], a[124:127], v[52:55], v[152:155]
    buffer_load_dwordx4 v[44:47], v254, s[36:39], s7 offen offset:1024 sc1
    v_mfma_f32_16x16x32_bf16 v[156:159], a[128:131], v[52:55], v[156:159]
    v_mfma_f32_16x16x32_bf16 v[160:163], a[132:135], v[52:55], v[160:163]
    buffer_load_dwordx4 v254, s[36:39], s13 offen offset:2048 sc1 lds
    v_mfma_f32_16x16x32_bf16 v[164:167], a[136:139], v[52:55], v[164:167]
    v_mfma_f32_16x16x32_bf16 v[168:171], a[120:123], v[56:59], v[168:171]
    buffer_load_dwordx4 v254, s[36:39], s13 offen offset:3072 sc1 lds
    v_mfma_f32_16x16x32_bf16 v[172:175], a[124:127], v[56:59], v[172:175]
    s_add_u32 s13, s13, 4096
    v_mfma_f32_16x16x32_bf16 v[176:179], a[128:131], v[56:59], v[176:179]
    s_add_u32 m0, s60, 19456
    s_nop 0
    buffer_load_dwordx4 v254, s[36:39], s13 offen offset:0 sc1 lds
    v_mfma_f32_16x16x32_bf16 v[180:183], a[132:135], v[56:59], v[180:183]
    s_add_u32 s13, s13, 36864
    v_mfma_f32_16x16x32_bf16 v[184:187], a[136:139], v[56:59], v[184:187]
    v_mfma_f32_16x16x32_bf16 v[188:191], a[120:123], v[60:63], v[188:191]
    v_mfma_f32_16x16x32_bf16 v[192:195], a[124:127], v[60:63], v[192:195]
    v_mfma_f32_16x16x32_bf16 v[196:199], a[128:131], v[60:63], v[196:199]
    v_mfma_f32_16x16x32_bf16 v[200:203], a[132:135], v[60:63], v[200:203]
    v_mfma_f32_16x16x32_bf16 v[204:207], a[136:139], v[60:63], v[204:207]
    s_waitcnt vmcnt(17)
    v_mfma_f32_16x16x32_bf16 v[128:131], a[140:143], v[64:67], v[128:131]
    buffer_load_dword v3, v250, s[36:39], s15 offen sc1
    v_mfma_f32_16x16x32_bf16 v[132:135], a[144:147], v[64:67], v[132:135]
    v_mfma_f32_16x16x32_bf16 v[136:139], a[148:151], v[64:67], v[136:139]
    buffer_load_dwordx4 v[48:51], v254, s[36:39], s4 offen offset:2048 sc1
    v_mfma_f32_16x16x32_bf16 v[140:143], a[152:155], v[64:67], v[140:143]
    v_mfma_f32_16x16x32_bf16 v[144:147], a[156:159], v[64:67], v[144:147]
    buffer_load_dwordx4 v[52:55], v254, s[36:39], s5 offen offset:2048 sc1
    v_mfma_f32_16x16x32_bf16 v[148:151], a[140:143], v[68:71], v[148:151]
    v_mfma_f32_16x16x32_bf16 v[152:155], a[144:147], v[68:71], v[152:155]
    buffer_load_dwordx4 v[56:59], v254, s[36:39], s6 offen offset:2048 sc1
    v_mfma_f32_16x16x32_bf16 v[156:159], a[148:151], v[68:71], v[156:159]
    v_mfma_f32_16x16x32_bf16 v[160:163], a[152:155], v[68:71], v[160:163]
    buffer_load_dwordx4 v[60:63], v254, s[36:39], s7 offen offset:2048 sc1
    v_mfma_f32_16x16x32_bf16 v[164:167], a[156:159], v[68:71], v[164:167]
    s_add_u32 m0, s60, 20480
    v_mfma_f32_16x16x32_bf16 v[168:171], a[140:143], v[72:75], v[168:171]
    buffer_load_dwordx4 v254, s[36:39], s13 offen offset:0 sc1 lds
    v_mfma_f32_16x16x32_bf16 v[172:175], a[144:147], v[72:75], v[172:175]
    v_mfma_f32_16x16x32_bf16 v[176:179], a[148:151], v[72:75], v[176:179]
    buffer_load_dwordx4 v254, s[36:39], s13 offen offset:1024 sc1 lds
    v_mfma_f32_16x16x32_bf16 v[180:183], a[152:155], v[72:75], v[180:183]
    v_mfma_f32_16x16x32_bf16 v[184:187], a[156:159], v[72:75], v[184:187]
    buffer_load_dwordx4 v254, s[36:39], s13 offen offset:2048 sc1 lds
    v_mfma_f32_16x16x32_bf16 v[188:191], a[140:143], v[76:79], v[188:191]
    v_mfma_f32_16x16x32_bf16 v[192:195], a[144:147], v[76:79], v[192:195]
    v_mfma_f32_16x16x32_bf16 v[196:199], a[148:151], v[76:79], v[196:199]
    v_mfma_f32_16x16x32_bf16 v[200:203], a[152:155], v[76:79], v[200:203]
    v_mfma_f32_16x16x32_bf16 v[204:207], a[156:159], v[76:79], v[204:207]
    s_waitcnt vmcnt(18)
    v_mfma_f32_16x16x32_bf16 v[128:131], a[160:163], v[16:19], v[128:131]
    buffer_load_dwordx4 v[64:67], v254, s[36:39], s4 offen offset:3072 sc1
    v_mfma_f32_16x16x32_bf16 v[132:135], a[164:167], v[16:19], v[132:135]
    v_mfma_f32_16x16x32_bf16 v[136:139], a[168:171], v[16:19], v[136:139]
    v_mfma_f32_16x16x32_bf16 v[140:143], a[172:175], v[16:19], v[140:143]
    buffer_load_dwordx4 v[68:71], v254, s[36:39], s5 offen offset:3072 sc1
    v_mfma_f32_16x16x32_bf16 v[144:147], a[176:179], v[16:19], v[144:147]
    v_mfma_f32_16x16x32_bf16 v[148:151], a[160:163], v[20:23], v[148:151]
    v_mfma_f32_16x16x32_bf16 v[152:155], a[164:167], v[20:23], v[152:155]
    buffer_load_dwordx4 v[72:75], v254, s[36:39], s6 offen offset:3072 sc1
    v_mfma_f32_16x16x32_bf16 v[156:159], a[168:171], v[20:23], v[156:159]
    v_mfma_f32_16x16x32_bf16 v[160:163], a[172:175], v[20:23], v[160:163]
    v_mfma_f32_16x16x32_bf16 v[164:167], a[176:179], v[20:23], v[164:167]
    buffer_load_dwordx4 v[76:79], v254, s[36:39], s7 offen offset:3072 sc1
    v_mfma_f32_16x16x32_bf16 v[168:171], a[160:163], v[24:27], v[168:171]
    s_add_u32 s4, s4, 4096
    v_mfma_f32_16x16x32_bf16 v[172:175], a[164:167], v[24:27], v[172:175]
    s_add_u32 s5, s5, 4096
    v_mfma_f32_16x16x32_bf16 v[176:179], a[168:171], v[24:27], v[176:179]
    s_add_u32 s6, s6, 4096
    s_add_u32 s7, s7, 4096
    buffer_load_dwordx4 v254, s[36:39], s13 offen offset:3072 sc1 lds
    v_mfma_f32_16x16x32_bf16 v[180:183], a[172:175], v[24:27], v[180:183]
    s_add_u32 s13, s13, 4096
    v_mfma_f32_16x16x32_bf16 v[184:187], a[176:179], v[24:27], v[184:187]
    s_add_u32 m0, s60, 24576
    v_mfma_f32_16x16x32_bf16 v[188:191], a[160:163], v[28:31], v[188:191]
    buffer_load_dwordx4 v254, s[36:39], s13 offen offset:0 sc1 lds
    v_mfma_f32_16x16x32_bf16 v[192:195], a[164:167], v[28:31], v[192:195]
    s_add_u32 s13, s13, 36864
    v_mfma_f32_16x16x32_bf16 v[196:199], a[168:171], v[28:31], v[196:199]
    v_add_u32 v5, s60, v254
    v_mfma_f32_16x16x32_bf16 v[200:203], a[172:175], v[28:31], v[200:203]
    v_bfe_u32 v9, v1, 4, 1
    v_mul_u32_u24 v9, 24, v9
    v_add_u32 v9, v9, v249
    s_xor_b32 s66, s48, 1
    s_mul_i32 s66, s66, 25600
    s_add_u32 s66, s66, 51200
    v_add_u32 v6, s66, v254
    s_xor_b32 s66, s48, 2
    s_mul_i32 s66, s66, 25600
    s_add_u32 s66, s66, 56320
    v_add_u32 v7, s66, v254
    s_xor_b32 s66, s48, 3
    s_mul_i32 s66, s66, 25600
    s_add_u32 s66, s66, 61440
    v_add_u32 v8, s66, v254
    v_mfma_f32_16x16x32_bf16 v[204:207], a[176:179], v[28:31], v[204:207]
    s_waitcnt vmcnt(13)
    v_cmp_eq_u32 vcc, s54, v3
    s_nop 0
    s_and_b32 s68, vcc_lo, 3
    s_cmp_eq_u32 s68, 3
    s_cbranch_scc0 L_t1_olate
    v_mfma_f32_16x16x32_bf16 v[128:131], a[180:183], v[32:35], v[128:131]
    buffer_load_dwordx4 v[16:19], v254, s[36:39], s8 offen offset:0 sc1
    v_mfma_f32_16x16x32_bf16 v[132:135], a[184:187], v[32:35], v[132:135]
    v_mfma_f32_16x16x32_bf16 v[136:139], a[188:191], v[32:35], v[136:139]
    v_mfma_f32_16x16x32_bf16 v[140:143], a[192:195], v[32:35], v[140:143]
    v_mfma_f32_16x16x32_bf16 v[144:147], a[196:199], v[32:35], v[144:147]
    buffer_load_dwordx4 v[20:23], v254, s[36:39], s9 offen offset:0 sc1
    v_mfma_f32_16x16x32_bf16 v[148:151], a[180:183], v[36:39], v[148:151]
    v_mfma_f32_16x16x32_bf16 v[152:155], a[184:187], v[36:39], v[152:155]
    v_mfma_f32_16x16x32_bf16 v[156:159], a[188:191], v[36:39], v[156:159]
    v_mfma_f32_16x16x32_bf16 v[160:163], a[192:195], v[36:39], v[160:163]
    buffer_load_dwordx4 v[24:27], v254, s[36:39], s10 offen offset:0 sc1
    v_mfma_f32_16x16x32_bf16 v[164:167], a[196:199], v[36:39], v[164:167]
    v_mfma_f32_16x16x32_bf16 v[168:171], a[180:183], v[40:43], v[168:171]
    v_mfma_f32_16x16x32_bf16 v[172:175], a[184:187], v[40:43], v[172:175]
    v_mfma_f32_16x16x32_bf16 v[176:179], a[188:191], v[40:43], v[176:179]
    buffer_load_dwordx4 v[28:31], v254, s[36:39], s11 offen offset:0 sc1
    v_mfma_f32_16x16x32_bf16 v[180:183], a[192:195], v[40:43], v[180:183]
    v_mfma_f32_16x16x32_bf16 v[184:187], a[196:199], v[40:43], v[184:187]
    v_mfma_f32_16x16x32_bf16 v[188:191], a[180:183], v[44:47], v[188:191]
    v_mfma_f32_16x16x32_bf16 v[192:195], a[184:187], v[44:47], v[192:195]
    v_mfma_f32_16x16x32_bf16 v[196:199], a[188:191], v[44:47], v[196:199]
    v_mfma_f32_16x16x32_bf16 v[200:203], a[192:195], v[44:47], v[200:203]
    v_mfma_f32_16x16x32_bf16 v[204:207], a[196:199], v[44:47], v[204:207]
    s_waitcnt vmcnt(13)
    v_mfma_f32_16x16x32_bf16 v[128:131], a[200:203], v[48:51], v[128:131]
    buffer_load_dwordx4 v[32:35], v254, s[36:39], s8 offen offset:1024 sc1
    v_mfma_f32_16x16x32_bf16 v[132:135], a[204:207], v[48:51], v[132:135]
    v_mfma_f32_16x16x32_bf16 v[136:139], a[208:211], v[48:51], v[136:139]
    v_mfma_f32_16x16x32_bf16 v[140:143], a[212:215], v[48:51], v[140:143]
    v_mfma_f32_16x16x32_bf16 v[144:147], a[216:219], v[48:51], v[144:147]
    buffer_load_dwordx4 v[36:39], v254, s[36:39], s9 offen offset:1024 sc1
    v_mfma_f32_16x16x32_bf16 v[148:151], a[200:203], v[52:55], v[148:151]
    v_mfma_f32_16x16x32_bf16 v[152:155], a[204:207], v[52:55], v[152:155]
    v_mfma_f32_16x16x32_bf16 v[156:159], a[208:211], v[52:55], v[156:159]
    v_mfma_f32_16x16x32_bf16 v[160:163], a[212:215], v[52:55], v[160:163]
    buffer_load_dwordx4 v[40:43], v254, s[36:39], s10 offen offset:1024 sc1
    v_mfma_f32_16x16x32_bf16 v[164:167], a[216:219], v[52:55], v[164:167]
    v_mfma_f32_16x16x32_bf16 v[168:171], a[200:203], v[56:59], v[168:171]
    v_mfma_f32_16x16x32_bf16 v[172:175], a[204:207], v[56:59], v[172:175]
    v_mfma_f32_16x16x32_bf16 v[176:179], a[208:211], v[56:59], v[176:179]
    buffer_load_dwordx4 v[44:47], v254, s[36:39], s11 offen offset:1024 sc1
    v_mfma_f32_16x16x32_bf16 v[180:183], a[212:215], v[56:59], v[180:183]
    v_mfma_f32_16x16x32_bf16 v[184:187], a[216:219], v[56:59], v[184:187]
    v_mfma_f32_16x16x32_bf16 v[188:191], a[200:203], v[60:63], v[188:191]
    v_mfma_f32_16x16x32_bf16 v[192:195], a[204:207], v[60:63], v[192:195]
    v_mfma_f32_16x16x32_bf16 v[196:199], a[208:211], v[60:63], v[196:199]
    v_mfma_f32_16x16x32_bf16 v[200:203], a[212:215], v[60:63], v[200:203]
    v_mfma_f32_16x16x32_bf16 v[204:207], a[216:219], v[60:63], v[204:207]
    s_waitcnt vmcnt(8)
    v_mfma_f32_16x16x32_bf16 v[128:131], a[220:223], v[64:67], v[128:131]
    ds_read_b128 v[80:83], v5 offset:0
    ds_read_b128 v[84:87], v5 offset:1024
    ds_read_b128 v[88:91], v5 offset:2048
    ds_read_b128 v[92:95], v5 offset:3072
    ds_read_b128 v[96:99], v5 offset:4096
    buffer_load_dwordx4 v[48:51], v254, s[36:39], s8 offen offset:2048 sc1
    v_mfma_f32_16x16x32_bf16 v[132:135], a[224:227], v[64:67], v[132:135]
    v_mfma_f32_16x16x32_bf16 v[136:139], a[228:231], v[64:67], v[136:139]
    v_mfma_f32_16x16x32_bf16 v[140:143], a[232:235], v[64:67], v[140:143]
    v_mfma_f32_16x16x32_bf16 v[144:147], a[236:239], v[64:67], v[144:147]
    buffer_load_dwordx4 v[52:55], v254, s[36:39], s9 offen offset:2048 sc1
    v_mfma_f32_16x16x32_bf16 v[148:151], a[220:223], v[68:71], v[148:151]
    v_mfma_f32_16x16x32_bf16 v[152:155], a[224:227], v[68:71], v[152:155]
    v_mfma_f32_16x16x32_bf16 v[156:159], a[228:231], v[68:71], v[156:159]
    v_mfma_f32_16x16x32_bf16 v[160:163], a[232:235], v[68:71], v[160:163]
    buffer_load_dwordx4 v[56:59], v254, s[36:39], s10 offen offset:2048 sc1
    v_mfma_f32_16x16x32_bf16 v[164:167], a[236:239], v[68:71], v[164:167]
    v_mfma_f32_16x16x32_bf16 v[168:171], a[220:223], v[72:75], v[168:171]
    v_mfma_f32_16x16x32_bf16 v[172:175], a[224:227], v[72:75], v[172:175]
    v_mfma_f32_16x16x32_bf16 v[176:179], a[228:231], v[72:75], v[176:179]
    buffer_load_dwordx4 v[60:63], v254, s[36:39], s11 offen offset:2048 sc1
    v_mfma_f32_16x16x32_bf16 v[180:183], a[232:235], v[72:75], v[180:183]
    v_mfma_f32_16x16x32_bf16 v[184:187], a[236:239], v[72:75], v[184:187]
    v_mfma_f32_16x16x32_bf16 v[188:191], a[220:223], v[76:79], v[188:191]
    v_mfma_f32_16x16x32_bf16 v[192:195], a[224:227], v[76:79], v[192:195]
    v_mfma_f32_16x16x32_bf16 v[196:199], a[228:231], v[76:79], v[196:199]
    v_mfma_f32_16x16x32_bf16 v[200:203], a[232:235], v[76:79], v[200:203]
    v_mfma_f32_16x16x32_bf16 v[204:207], a[236:239], v[76:79], v[204:207]
    s_waitcnt vmcnt(8)
    s_waitcnt lgkmcnt(0)
    v_mfma_f32_16x16x32_bf16 v[128:131], v[80:83], v[16:19], v[128:131]
    ds_read_b128 v[100:103], v5 offset:5120
    ds_read_b128 v[104:107], v5 offset:6144
    ds_read_b128 v[108:111], v5 offset:7168
    ds_read_b128 v[112:115], v5 offset:8192
    ds_read_b128 v[116:119], v5 offset:9216
    buffer_load_dwordx4 v[64:67], v254, s[36:39], s8 offen offset:3072 sc1
    v_mfma_f32_16x16x32_bf16 v[132:135], v[84:87], v[16:19], v[132:135]
    v_mfma_f32_16x16x32_bf16 v[136:139], v[88:91], v[16:19], v[136:139]
    v_mfma_f32_16x16x32_bf16 v[140:143], v[92:95], v[16:19], v[140:143]
    v_mfma_f32_16x16x32_bf16 v[144:147], v[96:99], v[16:19], v[144:147]
    buffer_load_dwordx4 v[68:71], v254, s[36:39], s9 offen offset:3072 sc1
    v_mfma_f32_16x16x32_bf16 v[148:151], v[80:83], v[20:23], v[148:151]
    v_mfma_f32_16x16x32_bf16 v[152:155], v[84:87], v[20:23], v[152:155]
    v_mfma_f32_16x16x32_bf16 v[156:159], v[88:91], v[20:23], v[156:159]
    v_mfma_f32_16x16x32_bf16 v[160:163], v[92:95], v[20:23], v[160:163]
    buffer_load_dwordx4 v[72:75], v254, s[36:39], s10 offen offset:3072 sc1
    v_mfma_f32_16x16x32_bf16 v[164:167], v[96:99], v[20:23], v[164:167]
    v_mfma_f32_16x16x32_bf16 v[168:171], v[80:83], v[24:27], v[168:171]
    v_mfma_f32_16x16x32_bf16 v[172:175], v[84:87], v[24:27], v[172:175]
    v_mfma_f32_16x16x32_bf16 v[176:179], v[88:91], v[24:27], v[176:179]
    buffer_load_dwordx4 v[76:79], v254, s[36:39], s11 offen offset:3072 sc1
    v_mfma_f32_16x16x32_bf16 v[180:183], v[92:95], v[24:27], v[180:183]
    v_mfma_f32_16x16x32_bf16 v[184:187], v[96:99], v[24:27], v[184:187]
    v_mfma_f32_16x16x32_bf16 v[188:191], v[80:83], v[28:31], v[188:191]
    v_mfma_f32_16x16x32_bf16 v[192:195], v[84:87], v[28:31], v[192:195]
    v_mfma_f32_16x16x32_bf16 v[196:199], v[88:91], v[28:31], v[196:199]
    v_mfma_f32_16x16x32_bf16 v[200:203], v[92:95], v[28:31], v[200:203]
    v_mfma_f32_16x16x32_bf16 v[204:207], v[96:99], v[28:31], v[204:207]
    s_waitcnt vmcnt(8)
    s_waitcnt lgkmcnt(0)
    v_mfma_f32_16x16x32_bf16 v[128:131], v[100:103], v[32:35], v[128:131]
    ds_read_b128 v[80:83], v5 offset:10240
    ds_read_b128 v[84:87], v5 offset:11264
    ds_read_b128 v[88:91], v5 offset:12288
    ds_read_b128 v[92:95], v5 offset:13312
    ds_read_b128 v[96:99], v5 offset:14336
    buffer_load_dwordx4 v[208:211], v248, s[36:39], s8 offen offset:0 sc1
    v_mfma_f32_16x16x32_bf16 v[132:135], v[104:107], v[32:35], v[132:135]
    v_mfma_f32_16x16x32_bf16 v[136:139], v[108:111], v[32:35], v[136:139]
    v_mfma_f32_16x16x32_bf16 v[140:143], v[112:115], v[32:35], v[140:143]
    v_mfma_f32_16x16x32_bf16 v[144:147], v[116:119], v[32:35], v[144:147]
    buffer_load_dwordx4 v[212:215], v248, s[36:39], s9 offen offset:0 sc1
    v_mfma_f32_16x16x32_bf16 v[148:151], v[100:103], v[36:39], v[148:151]
    v_mfma_f32_16x16x32_bf16 v[152:155], v[104:107], v[36:39], v[152:155]
    v_mfma_f32_16x16x32_bf16 v[156:159], v[108:111], v[36:39], v[156:159]
    v_mfma_f32_16x16x32_bf16 v[160:163], v[112:115], v[36:39], v[160:163]
    buffer_load_dwordx4 v[216:219], v248, s[36:39], s10 offen offset:0 sc1
    v_mfma_f32_16x16x32_bf16 v[164:167], v[116:119], v[36:39], v[164:167]
    v_mfma_f32_16x16x32_bf16 v[168:171], v[100:103], v[40:43], v[168:171]
    v_mfma_f32_16x16x32_bf16 v[172:175], v[104:107], v[40:43], v[172:175]
    v_mfma_f32_16x16x32_bf16 v[176:179], v[108:111], v[40:43], v[176:179]
    buffer_load_dwordx4 v[220:223], v248, s[36:39], s11 offen offset:0 sc1
    v_mfma_f32_16x16x32_bf16 v[180:183], v[112:115], v[40:43], v[180:183]
    v_mfma_f32_16x16x32_bf16 v[184:187], v[116:119], v[40:43], v[184:187]
    v_mfma_f32_16x16x32_bf16 v[188:191], v[100:103], v[44:47], v[188:191]
    v_mfma_f32_16x16x32_bf16 v[192:195], v[104:107], v[44:47], v[192:195]
    v_mfma_f32_16x16x32_bf16 v[196:199], v[108:111], v[44:47], v[196:199]
    v_mfma_f32_16x16x32_bf16 v[200:203], v[112:115], v[44:47], v[200:203]
    v_mfma_f32_16x16x32_bf16 v[204:207], v[116:119], v[44:47], v[204:207]
L_t1_ojoin:
    s_waitcnt vmcnt(8)
    s_waitcnt lgkmcnt(0)
    v_mfma_f32_16x16x32_bf16 v[128:131], v[80:83], v[48:51], v[128:131]
    ds_read_b128 v[100:103], v5 offset:15360
    ds_read_b128 v[104:107], v5 offset:16384
    ds_read_b128 v[108:111], v5 offset:17408
    ds_read_b128 v[112:115], v5 offset:18432
    ds_read_b128 v[116:119], v5 offset:19456
    v_mfma_f32_16x16x32_bf16 v[132:135], v[84:87], v[48:51], v[132:135]
    v_mfma_f32_16x16x32_bf16 v[136:139], v[88:91], v[48:51], v[136:139]
    v_mfma_f32_16x16x32_bf16 v[140:143], v[92:95], v[48:51], v[140:143]
    v_mfma_f32_16x16x32_bf16 v[144:147], v[96:99], v[48:51], v[144:147]
    v_mfma_f32_16x16x32_bf16 v[148:151], v[80:83], v[52:55], v[148:151]
    v_mfma_f32_16x16x32_bf16 v[152:155], v[84:87], v[52:55], v[152:155]
    v_mfma_f32_16x16x32_bf16 v[156:159], v[88:91], v[52:55], v[156:159]
    v_mfma_f32_16x16x32_bf16 v[160:163], v[92:95], v[52:55], v[160:163]
    v_mfma_f32_16x16x32_bf16 v[164:167], v[96:99], v[52:55], v[164:167]
    v_mfma_f32_16x16x32_bf16 v[168:171], v[80:83], v[56:59], v[168:171]
    v_mfma_f32_16x16x32_bf16 v[172:175], v[84:87], v[56:59], v[172:175]
    v_mfma_f32_16x16x32_bf16 v[176:179], v[88:91], v[56:59], v[176:179]
    v_mfma_f32_16x16x32_bf16 v[180:183], v[92:95], v[56:59], v[180:183]
    v_mfma_f32_16x16x32_bf16 v[184:187], v[96:99], v[56:59], v[184:187]
    v_mfma_f32_16x16x32_bf16 v[188:191], v[80:83], v[60:63], v[188:191]
    v_mfma_f32_16x16x32_bf16 v[192:195], v[84:87], v[60:63], v[192:195]
    v_mfma_f32_16x16x32_bf16 v[196:199], v[88:91], v[60:63], v[196:199]
    v_mfma_f32_16x16x32_bf16 v[200:203], v[92:95], v[60:63], v[200:203]
    v_mfma_f32_16x16x32_bf16 v[204:207], v[96:99], v[60:63], v[204:207]
    s_waitcnt vmcnt(4)
    s_waitcnt lgkmcnt(0)
    v_mfma_f32_16x16x32_bf16 v[128:131], v[100:103], v[64:67], v[128:131]
    ds_read_b128 v[80:83], v5 offset:20480
    ds_read_b128 v[84:87], v5 offset:21504
    ds_read_b128 v[88:91], v5 offset:22528
    ds_read_b128 v[92:95], v5 offset:23552
    ds_read_b128 v[96:99], v5 offset:24576
    v_mfma_f32_16x16x32_bf16 v[132:135], v[104:107], v[64:67], v[132:135]
    v_mfma_f32_16x16x32_bf16 v[136:139], v[108:111], v[64:67], v[136:139]
    v_mfma_f32_16x16x32_bf16 v[140:143], v[112:115], v[64:67], v[140:143]
    v_mfma_f32_16x16x32_bf16 v[144:147], v[116:119], v[64:67], v[144:147]
    v_mfma_f32_16x16x32_bf16 v[148:151], v[100:103], v[68:71], v[148:151]
    v_mfma_f32_16x16x32_bf16 v[152:155], v[104:107], v[68:71], v[152:155]
    v_mfma_f32_16x16x32_bf16 v[156:159], v[108:111], v[68:71], v[156:159]
    v_mfma_f32_16x16x32_bf16 v[160:163], v[112:115], v[68:71], v[160:163]
    v_mfma_f32_16x16x32_bf16 v[164:167], v[116:119], v[68:71], v[164:167]
    v_mfma_f32_16x16x32_bf16 v[168:171], v[100:103], v[72:75], v[168:171]
    v_mfma_f32_16x16x32_bf16 v[172:175], v[104:107], v[72:75], v[172:175]
    v_mfma_f32_16x16x32_bf16 v[176:179], v[108:111], v[72:75], v[176:179]
    v_mfma_f32_16x16x32_bf16 v[180:183], v[112:115], v[72:75], v[180:183]
    v_mfma_f32_16x16x32_bf16 v[184:187], v[116:119], v[72:75], v[184:187]
    v_mfma_f32_16x16x32_bf16 v[188:191], v[100:103], v[76:79], v[188:191]
    v_mfma_f32_16x16x32_bf16 v[192:195], v[104:107], v[76:79], v[192:195]
    v_mfma_f32_16x16x32_bf16 v[196:199], v[108:111], v[76:79], v[196:199]
    v_mfma_f32_16x16x32_bf16 v[200:203], v[112:115], v[76:79], v[200:203]
    v_mfma_f32_16x16x32_bf16 v[204:207], v[116:119], v[76:79], v[204:207]
    s_waitcnt vmcnt(0)
    s_waitcnt lgkmcnt(0)
    v_mfma_f32_16x16x32_bf16 v[148:151], v[80:83], v[212:215], v[148:151]
    v_mfma_f32_16x16x32_bf16 v[152:155], v[84:87], v[212:215], v[152:155]
    v_mfma_f32_16x16x32_bf16 v[156:159], v[88:91], v[212:215], v[156:159]
    v_mfma_f32_16x16x32_bf16 v[160:163], v[92:95], v[212:215], v[160:163]
    v_mfma_f32_16x16x32_bf16 v[164:167], v[96:99], v[212:215], v[164:167]
    v_mfma_f32_16x16x32_bf16 v[168:171], v[80:83], v[216:219], v[168:171]
    v_mfma_f32_16x16x32_bf16 v[172:175], v[84:87], v[216:219], v[172:175]
    v_mfma_f32_16x16x32_bf16 v[176:179], v[88:91], v[216:219], v[176:179]
    s_nop 0
    ds_write_b128 v5, v[148:151] offset:0
    v_mfma_f32_16x16x32_bf16 v[180:183], v[92:95], v[216:219], v[180:183]
    ds_write_b128 v5, v[152:155] offset:1024
    v_mfma_f32_16x16x32_bf16 v[184:187], v[96:99], v[216:219], v[184:187]
    ds_write_b128 v5, v[156:159] offset:2048
    v_mfma_f32_16x16x32_bf16 v[188:191], v[80:83], v[220:223], v[188:191]
    ds_write_b128 v5, v[160:163] offset:3072
    v_mfma_f32_16x16x32_bf16 v[192:195], v[84:87], v[220:223], v[192:195]
    ds_write_b128 v5, v[164:167] offset:4096
    v_mfma_f32_16x16x32_bf16 v[196:199], v[88:91], v[220:223], v[196:199]
    ds_write_b128 v5, v[168:171] offset:5120
    v_mfma_f32_16x16x32_bf16 v[200:203], v[92:95], v[220:223], v[200:203]
    ds_write_b128 v5, v[172:175] offset:6144
    v_mfma_f32_16x16x32_bf16 v[204:207], v[96:99], v[220:223], v[204:207]
    ds_write_b128 v5, v[176:179] offset:7168
    v_mfma_f32_16x16x32_bf16 v[128:131], v[80:83], v[208:211], v[128:131]
    ds_write_b128 v5, v[180:183] offset:8192
    v_mfma_f32_16x16x32_bf16 v[132:135], v[84:87], v[208:211], v[132:135]
    ds_write_b128 v5, v[184:187] offset:9216
    v_mfma_f32_16x16x32_bf16 v[136:139], v[88:91], v[208:211], v[136:139]
    ds_write_b128 v5, v[188:191] offset:10240
    v_mfma_f32_16x16x32_bf16 v[140:143], v[92:95], v[208:211], v[140:143]
    ds_write_b128 v5, v[192:195] offset:11264
    v_mfma_f32_16x16x32_bf16 v[144:147], v[96:99], v[208:211], v[144:147]
    ds_write_b128 v5, v[196:199] offset:12288
    ds_write_b128 v5, v[200:203] offset:13312
    ds_write_b128 v5, v[204:207] offset:14336
    s_waitcnt lgkmcnt(0)
    s_barrier
    ds_read_b128 v[16:19], v6 offset:0
    ds_read_b128 v[20:23], v7 offset:0
    ds_read_b128 v[24:27], v8 offset:0
    ds_read_b128 v[28:31], v6 offset:1024
    ds_read_b128 v[32:35], v7 offset:1024
    ds_read_b128 v[36:39], v8 offset:1024
    ds_read_b128 v[40:43], v6 offset:2048
    ds_read_b128 v[44:47], v7 offset:2048
    ds_read_b128 v[48:51], v8 offset:2048
    ds_read_b128 v[52:55], v6 offset:3072
    ds_read_b128 v[56:59], v7 offset:3072
    ds_read_b128 v[60:63], v8 offset:3072
    ds_read_b128 v[64:67], v6 offset:4096
    ds_read_b128 v[68:71], v7 offset:4096
    ds_read_b128 v[72:75], v8 offset:4096
    s_waitcnt lgkmcnt(12)
    v_pk_add_f32 v[16:17], v[16:17], v[20:21]
    v_pk_add_f32 v[18:19], v[18:19], v[22:23]
    v_pk_add_f32 v[128:129], v[128:129], v[24:25]
    v_pk_add_f32 v[130:131], v[130:131], v[26:27]
    v_pk_add_f32 v[128:129], v[128:129], v[16:17]
    v_pk_add_f32 v[130:131], v[130:131], v[18:19]
    v_cvt_pk_bf16_f32 v16, v128, v129
    v_cvt_pk_bf16_f32 v17, v130, v131
    buffer_store_dwordx2 v[16:17], v249, s[44:47], 0 offen offset:0
    s_waitcnt lgkmcnt(9)
    v_pk_add_f32 v[28:29], v[28:29], v[32:33]
    v_pk_add_f32 v[30:31], v[30:31], v[34:35]
    v_pk_add_f32 v[132:133], v[132:133], v[36:37]
    v_pk_add_f32 v[134:135], v[134:135], v[38:39]
    v_pk_add_f32 v[132:133], v[132:133], v[28:29]
    v_pk_add_f32 v[134:135], v[134:135], v[30:31]
    v_cvt_pk_bf16_f32 v28, v132, v133
    v_cvt_pk_bf16_f32 v29, v134, v135
    buffer_store_dwordx2 v[28:29], v249, s[44:47], 0 offen offset:32
    s_waitcnt lgkmcnt(6)
    v_pk_add_f32 v[40:41], v[40:41], v[44:45]
    v_pk_add_f32 v[42:43], v[42:43], v[46:47]
    v_pk_add_f32 v[136:137], v[136:137], v[48:49]
    v_pk_add_f32 v[138:139], v[138:139], v[50:51]
    v_pk_add_f32 v[136:137], v[136:137], v[40:41]
    v_pk_add_f32 v[138:139], v[138:139], v[42:43]
    v_cvt_pk_bf16_f32 v40, v136, v137
    v_cvt_pk_bf16_f32 v41, v138, v139
    buffer_store_dwordx2 v[40:41], v249, s[44:47], 0 offen offset:64
    s_waitcnt lgkmcnt(3)
    v_pk_add_f32 v[52:53], v[52:53], v[56:57]
    v_pk_add_f32 v[54:55], v[54:55], v[58:59]
    v_pk_add_f32 v[140:141], v[140:141], v[60:61]
    v_pk_add_f32 v[142:143], v[142:143], v[62:63]
    v_pk_add_f32 v[140:141], v[140:141], v[52:53]
    v_pk_add_f32 v[142:143], v[142:143], v[54:55]
    v_cvt_pk_bf16_f32 v52, v140, v141
    v_cvt_pk_bf16_f32 v53, v142, v143
    buffer_store_dwordx2 v[52:53], v249, s[44:47], 0 offen offset:96
    s_waitcnt lgkmcnt(0)
    v_pk_add_f32 v[64:65], v[64:65], v[68:69]
    v_pk_add_f32 v[66:67], v[66:67], v[70:71]
    v_pk_add_f32 v[144:145], v[144:145], v[72:73]
    v_pk_add_f32 v[146:147], v[146:147], v[74:75]
    v_pk_add_f32 v[144:145], v[144:145], v[64:65]
    v_pk_add_f32 v[146:147], v[146:147], v[66:67]
    v_cvt_pk_bf16_f32 v64, v144, v145
    v_cvt_pk_bf16_f32 v65, v146, v147
    buffer_store_dwordx2 v[64:65], v249, s[44:47], 0 offen offset:128
    s_endpgm
L_t1_olate:
    v_mfma_f32_16x16x32_bf16 v[128:131], a[180:183], v[32:35], v[128:131]
    v_mfma_f32_16x16x32_bf16 v[132:135], a[184:187], v[32:35], v[132:135]
    v_mfma_f32_16x16x32_bf16 v[136:139], a[188:191], v[32:35], v[136:139]
    v_mfma_f32_16x16x32_bf16 v[140:143], a[192:195], v[32:35], v[140:143]
    v_mfma_f32_16x16x32_bf16 v[144:147], a[196:199], v[32:35], v[144:147]
    v_mfma_f32_16x16x32_bf16 v[148:151], a[180:183], v[36:39], v[148:151]
    v_mfma_f32_16x16x32_bf16 v[152:155], a[184:187], v[36:39], v[152:155]
    v_mfma_f32_16x16x32_bf16 v[156:159], a[188:191], v[36:39], v[156:159]
    v_mfma_f32_16x16x32_bf16 v[160:163], a[192:195], v[36:39], v[160:163]
    v_mfma_f32_16x16x32_bf16 v[164:167], a[196:199], v[36:39], v[164:167]
    v_mfma_f32_16x16x32_bf16 v[168:171], a[180:183], v[40:43], v[168:171]
    v_mfma_f32_16x16x32_bf16 v[172:175], a[184:187], v[40:43], v[172:175]
    v_mfma_f32_16x16x32_bf16 v[176:179], a[188:191], v[40:43], v[176:179]
    v_mfma_f32_16x16x32_bf16 v[180:183], a[192:195], v[40:43], v[180:183]
    v_mfma_f32_16x16x32_bf16 v[184:187], a[196:199], v[40:43], v[184:187]
    v_mfma_f32_16x16x32_bf16 v[188:191], a[180:183], v[44:47], v[188:191]
    v_mfma_f32_16x16x32_bf16 v[192:195], a[184:187], v[44:47], v[192:195]
    v_mfma_f32_16x16x32_bf16 v[196:199], a[188:191], v[44:47], v[196:199]
    v_mfma_f32_16x16x32_bf16 v[200:203], a[192:195], v[44:47], v[200:203]
    v_mfma_f32_16x16x32_bf16 v[204:207], a[196:199], v[44:47], v[204:207]
    s_waitcnt vmcnt(9)
    v_mfma_f32_16x16x32_bf16 v[128:131], a[200:203], v[48:51], v[128:131]
    v_mfma_f32_16x16x32_bf16 v[132:135], a[204:207], v[48:51], v[132:135]
    v_mfma_f32_16x16x32_bf16 v[136:139], a[208:211], v[48:51], v[136:139]
    v_mfma_f32_16x16x32_bf16 v[140:143], a[212:215], v[48:51], v[140:143]
    v_mfma_f32_16x16x32_bf16 v[144:147], a[216:219], v[48:51], v[144:147]
    v_mfma_f32_16x16x32_bf16 v[148:151], a[200:203], v[52:55], v[148:151]
    v_mfma_f32_16x16x32_bf16 v[152:155], a[204:207], v[52:55], v[152:155]
    v_mfma_f32_16x16x32_bf16 v[156:159], a[208:211], v[52:55], v[156:159]
    v_mfma_f32_16x16x32_bf16 v[160:163], a[212:215], v[52:55], v[160:163]
    v_mfma_f32_16x16x32_bf16 v[164:167], a[216:219], v[52:55], v[164:167]
    v_mfma_f32_16x16x32_bf16 v[168:171], a[200:203], v[56:59], v[168:171]
    v_mfma_f32_16x16x32_bf16 v[172:175], a[204:207], v[56:59], v[172:175]
    v_mfma_f32_16x16x32_bf16 v[176:179], a[208:211], v[56:59], v[176:179]
    v_mfma_f32_16x16x32_bf16 v[180:183], a[212:215], v[56:59], v[180:183]
    v_mfma_f32_16x16x32_bf16 v[184:187], a[216:219], v[56:59], v[184:187]
    v_mfma_f32_16x16x32_bf16 v[188:191], a[200:203], v[60:63], v[188:191]
    v_mfma_f32_16x16x32_bf16 v[192:195], a[204:207], v[60:63], v[192:195]
    v_mfma_f32_16x16x32_bf16 v[196:199], a[208:211], v[60:63], v[196:199]
    v_mfma_f32_16x16x32_bf16 v[200:203], a[212:215], v[60:63], v[200:203]
    v_mfma_f32_16x16x32_bf16 v[204:207], a[216:219], v[60:63], v[204:207]
    s_waitcnt vmcnt(0)
    v_mfma_f32_16x16x32_bf16 v[128:131], a[220:223], v[64:67], v[128:131]
    ds_read_b128 v[80:83], v5 offset:0
    ds_read_b128 v[84:87], v5 offset:1024
    ds_read_b128 v[88:91], v5 offset:2048
    ds_read_b128 v[92:95], v5 offset:3072
    ds_read_b128 v[96:99], v5 offset:4096
    v_mfma_f32_16x16x32_bf16 v[132:135], a[224:227], v[64:67], v[132:135]
    v_mfma_f32_16x16x32_bf16 v[136:139], a[228:231], v[64:67], v[136:139]
    v_mfma_f32_16x16x32_bf16 v[140:143], a[232:235], v[64:67], v[140:143]
    v_mfma_f32_16x16x32_bf16 v[144:147], a[236:239], v[64:67], v[144:147]
    v_mfma_f32_16x16x32_bf16 v[148:151], a[220:223], v[68:71], v[148:151]
    v_mfma_f32_16x16x32_bf16 v[152:155], a[224:227], v[68:71], v[152:155]
    v_mfma_f32_16x16x32_bf16 v[156:159], a[228:231], v[68:71], v[156:159]
    v_mfma_f32_16x16x32_bf16 v[160:163], a[232:235], v[68:71], v[160:163]
    v_mfma_f32_16x16x32_bf16 v[164:167], a[236:239], v[68:71], v[164:167]
    v_mfma_f32_16x16x32_bf16 v[168:171], a[220:223], v[72:75], v[168:171]
    v_mfma_f32_16x16x32_bf16 v[172:175], a[224:227], v[72:75], v[172:175]
    v_mfma_f32_16x16x32_bf16 v[176:179], a[228:231], v[72:75], v[176:179]
    v_mfma_f32_16x16x32_bf16 v[180:183], a[232:235], v[72:75], v[180:183]
    v_mfma_f32_16x16x32_bf16 v[184:187], a[236:239], v[72:75], v[184:187]
    v_mfma_f32_16x16x32_bf16 v[188:191], a[220:223], v[76:79], v[188:191]
    v_mfma_f32_16x16x32_bf16 v[192:195], a[224:227], v[76:79], v[192:195]
    v_mfma_f32_16x16x32_bf16 v[196:199], a[228:231], v[76:79], v[196:199]
    v_mfma_f32_16x16x32_bf16 v[200:203], a[232:235], v[76:79], v[200:203]
    v_mfma_f32_16x16x32_bf16 v[204:207], a[236:239], v[76:79], v[204:207]
    s_mov_b32 s69, 0
    s_branch L_t1_po_go
L_t1_po:
    s_sleep 4
L_t1_po_go:
    buffer_load_dword v3, v250, s[36:39], s15 offen offset:0 sc1
    s_add_u32 s69, s69, 1
    s_waitcnt vmcnt(0)
    v_cmp_eq_u32 vcc, s54, v3
    s_nop 0
    s_and_b32 s68, vcc_lo, 3
    s_cmp_eq_u32 s68, 3
    s_cbranch_scc1 L_t1_po_ok
    s_cmp_lt_u32 s69, 262144
    s_cbranch_scc1 L_t1_po
L_t1_po_ok:
    buffer_load_dwordx4 v[16:19], v254, s[36:39], s8 offen offset:0 sc1
    buffer_load_dwordx4 v[20:23], v254, s[36:39], s9 offen offset:0 sc1
    buffer_load_dwordx4 v[24:27], v254, s[36:39], s10 offen offset:0 sc1
    buffer_load_dwordx4 v[28:31], v254, s[36:39], s11 offen offset:0 sc1
    buffer_load_dwordx4 v[32:35], v254, s[36:39], s8 offen offset:1024 sc1
    buffer_load_dwordx4 v[36:39], v254, s[36:39], s9 offen offset:1024 sc1
    buffer_load_dwordx4 v[40:43], v254, s[36:39], s10 offen offset:1024 sc1
    buffer_load_dwordx4 v[44:47], v254, s[36:39], s11 offen offset:1024 sc1
    buffer_load_dwordx4 v[48:51], v254, s[36:39], s8 offen offset:2048 sc1
    buffer_load_dwordx4 v[52:55], v254, s[36:39], s9 offen offset:2048 sc1
    buffer_load_dwordx4 v[56:59], v254, s[36:39], s10 offen offset:2048 sc1
    buffer_load_dwordx4 v[60:63], v254, s[36:39], s11 offen offset:2048 sc1
    buffer_load_dwordx4 v[64:67], v254, s[36:39], s8 offen offset:3072 sc1
    buffer_load_dwordx4 v[68:71], v254, s[36:39], s9 offen offset:3072 sc1
    buffer_load_dwordx4 v[72:75], v254, s[36:39], s10 offen offset:3072 sc1
    buffer_load_dwordx4 v[76:79], v254, s[36:39], s11 offen offset:3072 sc1
    buffer_load_dwordx4 v[208:211], v248, s[36:39], s8 offen offset:0 sc1
    buffer_load_dwordx4 v[212:215], v248, s[36:39], s9 offen offset:0 sc1
    buffer_load_dwordx4 v[216:219], v248, s[36:39], s10 offen offset:0 sc1
    buffer_load_dwordx4 v[220:223], v248, s[36:39], s11 offen offset:0 sc1
    s_waitcnt vmcnt(16)
    s_waitcnt lgkmcnt(0)
    v_mfma_f32_16x16x32_bf16 v[128:131], v[80:83], v[16:19], v[128:131]
    ds_read_b128 v[100:103], v5 offset:5120
    ds_read_b128 v[104:107], v5 offset:6144
    ds_read_b128 v[108:111], v5 offset:7168
    ds_read_b128 v[112:115], v5 offset:8192
    ds_read_b128 v[116:119], v5 offset:9216
    v_mfma_f32_16x16x32_bf16 v[132:135], v[84:87], v[16:19], v[132:135]
    v_mfma_f32_16x16x32_bf16 v[136:139], v[88:91], v[16:19], v[136:139]
    v_mfma_f32_16x16x32_bf16 v[140:143], v[92:95], v[16:19], v[140:143]
    v_mfma_f32_16x16x32_bf16 v[144:147], v[96:99], v[16:19], v[144:147]
    v_mfma_f32_16x16x32_bf16 v[148:151], v[80:83], v[20:23], v[148:151]
    v_mfma_f32_16x16x32_bf16 v[152:155], v[84:87], v[20:23], v[152:155]
    v_mfma_f32_16x16x32_bf16 v[156:159], v[88:91], v[20:23], v[156:159]
    v_mfma_f32_16x16x32_bf16 v[160:163], v[92:95], v[20:23], v[160:163]
    v_mfma_f32_16x16x32_bf16 v[164:167], v[96:99], v[20:23], v[164:167]
    v_mfma_f32_16x16x32_bf16 v[168:171], v[80:83], v[24:27], v[168:171]
    v_mfma_f32_16x16x32_bf16 v[172:175], v[84:87], v[24:27], v[172:175]
    v_mfma_f32_16x16x32_bf16 v[176:179], v[88:91], v[24:27], v[176:179]
    v_mfma_f32_16x16x32_bf16 v[180:183], v[92:95], v[24:27], v[180:183]
    v_mfma_f32_16x16x32_bf16 v[184:187], v[96:99], v[24:27], v[184:187]
    v_mfma_f32_16x16x32_bf16 v[188:191], v[80:83], v[28:31], v[188:191]
    v_mfma_f32_16x16x32_bf16 v[192:195], v[84:87], v[28:31], v[192:195]
    v_mfma_f32_16x16x32_bf16 v[196:199], v[88:91], v[28:31], v[196:199]
    v_mfma_f32_16x16x32_bf16 v[200:203], v[92:95], v[28:31], v[200:203]
    v_mfma_f32_16x16x32_bf16 v[204:207], v[96:99], v[28:31], v[204:207]
    s_waitcnt vmcnt(12)
    s_waitcnt lgkmcnt(0)
    v_mfma_f32_16x16x32_bf16 v[128:131], v[100:103], v[32:35], v[128:131]
    ds_read_b128 v[80:83], v5 offset:10240
    ds_read_b128 v[84:87], v5 offset:11264
    ds_read_b128 v[88:91], v5 offset:12288
    ds_read_b128 v[92:95], v5 offset:13312
    ds_read_b128 v[96:99], v5 offset:14336
    v_mfma_f32_16x16x32_bf16 v[132:135], v[104:107], v[32:35], v[132:135]
    v_mfma_f32_16x16x32_bf16 v[136:139], v[108:111], v[32:35], v[136:139]
    v_mfma_f32_16x16x32_bf16 v[140:143], v[112:115], v[32:35], v[140:143]
    v_mfma_f32_16x16x32_bf16 v[144:147], v[116:119], v[32:35], v[144:147]
    v_mfma_f32_16x16x32_bf16 v[148:151], v[100:103], v[36:39], v[148:151]
    v_mfma_f32_16x16x32_bf16 v[152:155], v[104:107], v[36:39], v[152:155]
    v_mfma_f32_16x16x32_bf16 v[156:159], v[108:111], v[36:39], v[156:159]
    v_mfma_f32_16x16x32_bf16 v[160:163], v[112:115], v[36:39], v[160:163]
    v_mfma_f32_16x16x32_bf16 v[164:167], v[116:119], v[36:39], v[164:167]
    v_mfma_f32_16x16x32_bf16 v[168:171], v[100:103], v[40:43], v[168:171]
    v_mfma_f32_16x16x32_bf16 v[172:175], v[104:107], v[40:43], v[172:175]
    v_mfma_f32_16x16x32_bf16 v[176:179], v[108:111], v[40:43], v[176:179]
    v_mfma_f32_16x16x32_bf16 v[180:183], v[112:115], v[40:43], v[180:183]
    v_mfma_f32_16x16x32_bf16 v[184:187], v[116:119], v[40:43], v[184:187]
    v_mfma_f32_16x16x32_bf16 v[188:191], v[100:103], v[44:47], v[188:191]
    v_mfma_f32_16x16x32_bf16 v[192:195], v[104:107], v[44:47], v[192:195]
    v_mfma_f32_16x16x32_bf16 v[196:199], v[108:111], v[44:47], v[196:199]
    v_mfma_f32_16x16x32_bf16 v[200:203], v[112:115], v[44:47], v[200:203]
    v_mfma_f32_16x16x32_bf16 v[204:207], v[116:119], v[44:47], v[204:207]
    s_branch L_t1_ojoin
L_t1_slow:
    s_mov_b32 s69, 0
L_t1_slow2:
    buffer_load_dwordx4 v[2:5], v254, s[36:39], s19 offen sc1
    s_add_u32 s69, s69, 1
    s_waitcnt vmcnt(0)
    v_cmp_eq_u32 s[74:75], s54, v2
    v_cmp_eq_u32 vcc, s54, v3
    s_nop 0
    s_and_b64 s[74:75], s[74:75], vcc
    v_cmp_eq_u32 vcc, s54, v4
    s_nop 0
    s_and_b64 s[74:75], s[74:75], vcc
    v_cmp_eq_u32 vcc, s54, v5
    s_nop 0
    s_and_b64 s[74:75], s[74:75], vcc
    s_cmp_eq_u64 s[74:75], -1
    s_cbranch_scc1 L_t1_fast
    s_cmp_lt_u32 s69, 262144
    s_cbranch_scc1 L_t1_slow2
    s_branch L_t1_fast
L_t1_rlx:
    s_cmp_eq_u32 s100, 3
    s_cbranch_scc1 L_t1_rlx3
    s_cmp_eq_u32 s100, 2
    s_mov_b32 s100, 0
    s_cbranch_scc1 L_t1_rlx2
    s_waitcnt vmcnt(21) lgkmcnt(0)
    s_branch L_t1_back
L_t1_rlx3:
    s_mov_b32 s100, 0
    s_waitcnt vmcnt(14) lgkmcnt(0)
    s_branch L_t1_back
L_t1_rlx2:
    s_waitcnt vmcnt(21) lgkmcnt(0)
    s_branch L_t1_back
L_t1_exit:
    s_cmp_eq_u32 s65, 2
    s_cbranch_scc1 L_t1_h1
    s_cmp_eq_u32 s65, 4
    s_cbranch_scc1 L_t1_h2
    s_mov_b32 s65, 2
    s_mov_b32 s100, 1
    ds_read_b64_tr_b16 a[0:1], v13 offset:0
    ds_read_b64_tr_b16 a[2:3], v13 offset:2048
    ds_read_b64_tr_b16 a[4:5], v13 offset:4096
    ds_read_b64_tr_b16 a[6:7], v13 offset:6144
    ds_read_b64_tr_b16 a[8:9], v13 offset:8192
    ds_read_b64_tr_b16 a[10:11], v13 offset:10240
    ds_read_b64_tr_b16 a[12:13], v13 offset:12288
    ds_read_b64_tr_b16 a[14:15], v13 offset:14336
    ds_read_b64_tr_b16 a[16:17], v13 offset:16384
    ds_read_b64_tr_b16 a[18:19], v13 offset:18432
    v_readfirstlane_b32 s54, v207
    s_mul_i32 s54, s54, 0x9E3779B1
    s_add_u32 s54, s54, 0x7F4A7C15
    v_mov_b32 v251, s54
    s_cmp_eq_u32 s51, 0
    s_cselect_b32 s66, 0, 1073741824
    s_mul_i32 s67, s52, 7168
    s_add_u32 s67, s67, 12746752
    v_lshlrev_b32 v2, 4, v0
    v_add_u32 v2, s66, v2
    v_add_u32 v3, 4096, v2
    v_mov_b32 v4, 1073741824
    v_cmp_gt_u32 vcc, 192, v0
    v_mov_b64 v[228:229], 0
    v_mov_b64 v[230:231], 0
    v_cndmask_b32 v3, v4, v3, vcc
    buffer_store_dwordx4 v[228:231], v2, s[36:39], s67 offen sc1
    buffer_store_dwordx4 v[228:231], v3, s[36:39], s67 offen sc1
    s_mov_b32 s71, m0
    s_mov_b32 m0, s101
    s_cmp_eq_u32 s101, 160768
    s_cselect_b32 s69, 0, 1024
    s_waitcnt lgkmcnt(0)
    s_barrier
    buffer_load_dwordx4 v232, s[40:43], 0 offen lds
    s_add_u32 m0, m0, s69
    v_mfma_f32_16x16x32_bf16 a[20:23], v[240:243], a[0:3], 0
    buffer_load_dwordx4 v233, s[40:43], 0 offen lds
    s_add_u32 m0, m0, s69
    v_mfma_f32_16x16x32_bf16 a[20:23], v[240:243], a[4:7], a[20:23]
    buffer_load_dwordx4 v234, s[40:43], 0 offen lds
    s_add_u32 m0, m0, s69
    v_mfma_f32_16x16x32_bf16 a[20:23], v[240:243], a[8:11], a[20:23]
    buffer_load_dwordx4 v235, s[40:43], 0 offen lds
    s_add_u32 m0, m0, s69
    v_mfma_f32_16x16x32_bf16 a[20:23], v[240:243], a[12:15], a[20:23]
    buffer_load_dwordx4 v236, s[40:43], 0 offen lds
    s_add_u32 m0, m0, s69
    v_mfma_f32_16x16x32_bf16 a[20:23], v[240:243], a[16:19], a[20:23]
    buffer_load_dwordx4 v237, s[40:43], 0 offen lds
    s_add_u32 m0, m0, s69
    s_nop 0
    buffer_load_dwordx4 v238, s[40:43], 0 offen lds
    s_add_u32 m0, m0, s69
    s_nop 0
    buffer_load_dwordx4 v239, s[40:43], 0 offen lds
    s_add_u32 m0, m0, s69
    s_mov_b32 m0, s71
    ds_write_b32 v12, a20
    s_branch L_t1_loop
L_t1_h1:
    s_mov_b32 s65, 4
    s_mov_b32 s100, 2
    v_add_u32 v2, 159744, v254
    ds_read_b128 v[4:7], v2
    v_mov_b64 v[228:229], 0
    v_mov_b64 v[230:231], 0
    s_waitcnt vmcnt(11)
    v_xor_b32 v2, 0, v14
    ds_read_b64_tr_b16 a[24:25], v2
    ds_read_b64_tr_b16 a[26:27], v2 offset:4096
    v_xor_b32 v2, 32, v14
    ds_read_b64_tr_b16 a[28:29], v2
    ds_read_b64_tr_b16 a[30:31], v2 offset:4096
    v_xor_b32 v2, 64, v14
    ds_read_b64_tr_b16 a[32:33], v2
    ds_read_b64_tr_b16 a[34:35], v2 offset:4096
    v_xor_b32 v2, 96, v14
    ds_read_b64_tr_b16 a[36:37], v2
    ds_read_b64_tr_b16 a[38:39], v2 offset:4096
    v_xor_b32 v2, 128, v14
    ds_read_b64_tr_b16 a[40:41], v2
    ds_read_b64_tr_b16 a[42:43], v2 offset:4096
    v_xor_b32 v2, 160, v14
    ds_read_b64_tr_b16 a[44:45], v2
    ds_read_b64_tr_b16 a[46:47], v2 offset:4096
    v_xor_b32 v2, 192, v14
    ds_read_b64_tr_b16 a[48:49], v2
    ds_read_b64_tr_b16 a[50:51], v2 offset:4096
    v_xor_b32 v2, 224, v14
    ds_read_b64_tr_b16 a[52:53], v2
    ds_read_b64_tr_b16 a[54:55], v2 offset:4096
    v_dot2_f32_bf16 v228, v208, v240, v228
    v_dot2_f32_bf16 v230, v208, v208, v230
    v_dot2_f32_bf16 v229, v209, v240, v229
    v_dot2_f32_bf16 v231, v209, v209, v231
    v_dot2_f32_bf16 v228, v210, v240, v228
    v_dot2_f32_bf16 v230, v210, v210, v230
    v_dot2_f32_bf16 v229, v211, v240, v229
    v_dot2_f32_bf16 v231, v211, v211, v231
    v_dot2_f32_bf16 v228, v212, v240, v228
    v_dot2_f32_bf16 v230, v212, v212, v230
    s_waitcnt lgkmcnt(14)
    buffer_store_dwordx4 a[24:27], v15, s[36:39], s22 offen offset:0 sc1
    v_dot2_f32_bf16 v229, v213, v240, v229
    v_dot2_f32_bf16 v231, v213, v213, v231
    v_dot2_f32_bf16 v228, v214, v240, v228
    v_dot2_f32_bf16 v230, v214, v214, v230
    s_waitcnt lgkmcnt(12)
    buffer_store_dwordx4 a[28:31], v15, s[36:39], s22 offen offset:1024 sc1
    v_dot2_f32_bf16 v229, v215, v240, v229
    v_dot2_f32_bf16 v231, v215, v215, v231
    v_dot2_f32_bf16 v228, v216, v240, v228
    v_dot2_f32_bf16 v230, v216, v216, v230
    s_waitcnt lgkmcnt(10)
    buffer_store_dwordx4 a[32:35], v15, s[36:39], s22 offen offset:2048 sc1
    v_dot2_f32_bf16 v229, v217, v240, v229
    v_dot2_f32_bf16 v231, v217, v217, v231
    v_dot2_f32_bf16 v228, v218, v240, v228
    v_dot2_f32_bf16 v230, v218, v218, v230
    s_waitcnt lgkmcnt(8)
    buffer_store_dwordx4 a[36:39], v15, s[36:39], s22 offen offset:3072 sc1
    v_dot2_f32_bf16 v229, v219, v240, v229
    v_dot2_f32_bf16 v231, v219, v219, v231
    v_dot2_f32_bf16 v228, v220, v240, v228
    v_dot2_f32_bf16 v230, v220, v220, v230
    s_waitcnt lgkmcnt(6)
    buffer_store_dwordx4 a[40:43], v15, s[36:39], s23 offen offset:0 sc1
    v_dot2_f32_bf16 v229, v221, v240, v229
    v_dot2_f32_bf16 v231, v221, v221, v231
    v_dot2_f32_bf16 v228, v222, v240, v228
    v_dot2_f32_bf16 v230, v222, v222, v230
    s_waitcnt lgkmcnt(4)
    buffer_store_dwordx4 a[44:47], v15, s[36:39], s23 offen offset:1024 sc1
    v_dot2_f32_bf16 v229, v223, v240, v229
    v_dot2_f32_bf16 v231, v223, v223, v231
    v_dot2_f32_bf16 v228, v224, v240, v228
    v_dot2_f32_bf16 v230, v224, v224, v230
    s_waitcnt lgkmcnt(2)
    buffer_store_dwordx4 a[48:51], v15, s[36:39], s23 offen offset:2048 sc1
    v_dot2_f32_bf16 v229, v225, v240, v229
    v_dot2_f32_bf16 v231, v225, v225, v231
    v_dot2_f32_bf16 v228, v226, v240, v228
    v_dot2_f32_bf16 v230, v226, v226, v230
    s_waitcnt lgkmcnt(0)
    buffer_store_dwordx4 a[52:55], v15, s[36:39], s23 offen offset:3072 sc1
    v_dot2_f32_bf16 v229, v227, v240, v229
    v_dot2_f32_bf16 v231, v227, v227, v231
    s_nop 1
    v_add_f32 v228, v228, v229
    v_add_f32 v230, v230, v231
    s_nop 0
    v_add_f32_dpp v228, v228, v228 row_ror:8 row_mask:0xf bank_mask:0xf
    v_add_f32_dpp v230, v230, v230 row_ror:8 row_mask:0xf bank_mask:0xf
    s_nop 0
    v_add_f32_dpp v228, v228, v228 row_ror:4 row_mask:0xf bank_mask:0xf
    v_add_f32_dpp v230, v230, v230 row_ror:4 row_mask:0xf bank_mask:0xf
    s_nop 0
    v_add_f32_dpp v228, v228, v228 row_ror:2 row_mask:0xf bank_mask:0xf
    v_add_f32_dpp v230, v230, v230 row_ror:2 row_mask:0xf bank_mask:0xf
    s_nop 0
    v_add_f32_dpp v228, v228, v228 row_ror:1 row_mask:0xf bank_mask:0xf
    v_add_f32_dpp v230, v230, v230 row_ror:1 row_mask:0xf bank_mask:0xf
    v_mul_f32 v208, 3133983949, v228
    v_mul_f32 v230, 986500301, v230
    v_fma_f32 v230, -v208, v208, v230
    v_max_f32 v230, 0, v230
    v_add_f32 v230, 925353388, v230
    v_rsq_f32 v209, v230
    s_nop 0
    v_mul_f32 v210, 1069066811, v209
    v_mul_f32 v211, v230, v209
    buffer_store_dwordx4 v[208:211], v11, s[36:39], 0 offen sc1
    buffer_store_dwordx4 v[4:7], v247, s[36:39], 0 offen sc1
    s_branch L_t1_loop
L_t1_h2:
    s_lshl_b32 s66, s2, 2
    s_add_u32 s66, s66, 12943360
    s_mov_b32 s65, 7
    buffer_store_dword v251, v252, s[36:39], s66 offen sc1
    s_branch L_t1_loop
L_end:
    s_endpgm
.section .rodata,"a"
.p2align 6
.amdhsa_kernel parallel_sum__linear_attn_block__dense_activation_silu__prompt_kernel
  .amdhsa_next_free_vgpr 512
  .amdhsa_next_free_sgpr 102
  .amdhsa_accum_offset 256
  .amdhsa_group_segment_fixed_size 0
  .amdhsa_kernarg_size 72
  .amdhsa_user_sgpr_count 2
  .amdhsa_user_sgpr_kernarg_segment_ptr 1
  .amdhsa_system_sgpr_workgroup_id_x 1
  .amdhsa_float_denorm_mode_32 3
.end_amdhsa_kernel
```
